```python
import torch

def _softmax(x, axis=-1):
    return torch.softmax(x, dim=axis)

def _gelu(x):
    return torch.nn.functional.gelu(x, approximate='tanh')

def _silu(x):
    return torch.nn.functional.silu(x)

def _sigmoid(x):
    return torch.sigmoid(x)

def _layernorm(x, axis=-1, eps=1e-05):
    m = x.mean(dim=axis, keepdim=True)
    v = x.var(dim=axis, keepdim=True, unbiased=False)
    return (x - m) / torch.sqrt(v + eps)

def _scatter_add(tgt, idx, src, axis=0):
    return tgt.clone().index_add_(axis, idx, src)

def _segment_sum(src, seg, n):
    out = torch.zeros((n,) + src.shape[1:], dtype=src.dtype)
    return out.index_add_(0, seg, src)

def _pad(x, pw):
    flat = tuple((v for pair in reversed(pw) for v in pair))
    return torch.nn.functional.pad(x, flat)
kernel_name = 'gated_mix__memory_aug_recurrent_mem_tr__swiglu_ffn__prompt'

def setup_inputs():

    _w = lambda a: (lambda t: t.to(torch.bfloat16) if t.is_floating_point() else t)(torch.as_tensor(a))

    def _A_setup():
        B, S, Dm = (1, 2048, 448)
        H, Dh = (16, 256)
        M, seg = (8, 32)
        seg = min(seg, S)
        S = S // seg * seg
        return {'x': _w((lambda *s: torch.randn(*s, dtype=torch.bfloat16) * 0.05)(B, S, Dm)), 'mem0': _w((lambda *s: torch.randn(*s, dtype=torch.bfloat16) * 0.4)(B, M, Dm)), 'Wq': _w((lambda *s: torch.randn(*s, dtype=torch.bfloat16) * 6.4)(Dm, H, Dh) * Dm ** (-0.5)), 'Wk': _w((lambda *s: torch.randn(*s, dtype=torch.bfloat16) * 6.4)(Dm, H, Dh) * Dm ** (-0.5)), 'Wv': _w((lambda *s: torch.randn(*s, dtype=torch.bfloat16) * 0.4)(Dm, H, Dh) * Dm ** (-0.5)), 'Wo': _w((lambda *s: torch.randn(*s, dtype=torch.bfloat16) * 0.4)(H, Dh, Dm) * (H * Dh) ** (-0.5)), 'seg_len': seg}
    _A_in = _A_setup()

    def _B_setup():
        B, S, D, F = (1, 2048, 448, 1792)
        return {'x': _w((lambda *s: torch.randn(*s, dtype=torch.bfloat16) * 0.05)(B, S, D)), 'w_gate': _w((lambda *s: torch.randn(*s, dtype=torch.bfloat16) * 0.05)(D, F)), 'w_up': _w((lambda *s: torch.randn(*s, dtype=torch.bfloat16) * 0.05)(D, F)), 'w_down': _w((lambda *s: torch.randn(*s, dtype=torch.bfloat16) * 0.05)(F, D))}
    _B_in = _B_setup()
    return {'A_x': _A_in['x'], 'A_mem0': _A_in['mem0'], 'A_Wq': _A_in['Wq'], 'A_Wk': _A_in['Wk'], 'A_Wv': _A_in['Wv'], 'A_Wo': _A_in['Wo'], 'A_seg_len': _A_in['seg_len'], 'B_x': _B_in['x'], 'B_w_gate': _B_in['w_gate'], 'B_w_up': _B_in['w_up'], 'B_w_down': _B_in['w_down'], 'gate_w': _w((lambda *s: torch.randn(*s, dtype=torch.bfloat16) * 0.05)(448) * 16.0)}

def reference(A_x, A_mem0, A_Wq, A_Wk, A_Wv, A_Wo, A_seg_len, B_x, B_w_gate, B_w_up, B_w_down, gate_w):

    def _A_ref(x, mem0, Wq, Wk, Wv, Wo, seg_len):
        B, S, Dm = x.shape
        H, Dh = (Wq.shape[1], Wq.shape[2])
        M = mem0.shape[1]
        scale = Dh ** (-0.5)
        n_seg = S // seg_len
        L = M + seg_len
        idx = torch.arange(L)
        mask = (idx[:, None] < M) | (idx[:, None] >= idx[None, :])
        mem = mem0
        outs = []
        for s in range(n_seg):
            xs = x[:, s * seg_len:(s + 1) * seg_len, :].clone()
            h = torch.concatenate([mem, xs], axis=1)
            q = torch.einsum('btd,dhe->bhte', h, Wq)
            k = torch.einsum('btd,dhe->bhte', h, Wk)
            v = torch.einsum('btd,dhe->bhte', h, Wv)
            scores = torch.einsum('bhqe,bhke->bhqk', q, k) * scale
            scores = torch.where(mask[None, None], scores, -1000000000.0)
            p = _softmax(scores, axis=-1)
            o = torch.einsum('bhqk,bhke->bhqe', p, v)
            o = torch.einsum('bhte,hed->btd', o, Wo)
            mem = o[:, :M, :].clone()
            outs.append(o[:, M:, :])
        return torch.concatenate(outs, axis=1)

    def _B_ref(x, w_gate, w_up, w_down):
        g = _silu(x @ w_gate)
        u = x @ w_up
        return g * u @ w_down
    x = A_x
    g = _sigmoid((x * gate_w).sum(-1, keepdims=True))
    a = _A_ref(x, A_mem0, A_Wq, A_Wk, A_Wv, A_Wo, A_seg_len)
    b = _B_ref(x, B_w_gate, B_w_up, B_w_down)
    return g * a + (1 - g) * b
```

```asm
; @launch grid=(256,1,1) block=(256,1,1) lds=155648
.amdgcn_target "amdgcn-amd-amdhsa--gfx950"
.text
.globl gated_mix__memory_aug_recurrent_mem_tr__swiglu_ffn__prompt_kernel
.p2align 8
.type gated_mix__memory_aug_recurrent_mem_tr__swiglu_ffn__prompt_kernel,@function
gated_mix__memory_aug_recurrent_mem_tr__swiglu_ffn__prompt_kernel:
    s_cmp_ge_u32 s2, 256
    s_cbranch_scc1 quit
    s_load_dwordx8 s[64:71], s[0:1], 0
    s_load_dwordx4 s[72:75], s[0:1], 32
    s_load_dwordx2 s[76:77], s[0:1], 88
    s_load_dwordx4 s[52:55], s[0:1], 104
    v_lshrrev_b32 v1, 6, v0
    v_and_b32 v0, 63, v0
    v_readfirstlane_b32 s3, v1
    s_getpc_b64 s[32:33]
pcref:
    s_lshr_b32 s31, s2, 3
    s_lshl_b32 s31, s31, 2
    s_add_u32 s31, s31, s3
    s_and_b32 s31, s31, 7
    s_lshl_b32 s31, s31, 13
    v_lshl_add_u32 v252, v0, 7, s31
    v_min_u32 v252, codeend-pcref-4, v252
    global_load_dword v253, v252, s[32:33]
    s_waitcnt lgkmcnt(0)
    s_mov_b32 s8, s54
    s_mov_b32 s9, s55
    s_mov_b32 s10, 0x8000000
    s_mov_b32 s11, 0x20000
    s_mov_b32 s44, s52
    s_mov_b32 s45, s53
    s_mov_b32 s46, 0x100
    s_mov_b32 s47, 0x20000
    s_mov_b32 s60, s72
    s_mov_b32 s61, s73
    s_mov_b32 s62, 0x380000
    s_mov_b32 s63, 0x20000
    s_mov_b32 s16, s74
    s_mov_b32 s17, s75
    s_mov_b32 s18, 0x380000
    s_mov_b32 s19, 0x20000
    s_mov_b32 s36, s68
    s_mov_b32 s37, s69
    s_mov_b32 s38, 0x380000
    s_mov_b32 s39, 0x20000
    s_mov_b32 s56, s70
    s_mov_b32 s57, s71
    s_mov_b32 s58, 0x380000
    s_mov_b32 s59, 0x20000
    s_mov_b32 s20, s64
    s_mov_b32 s21, s65
    s_mov_b32 s22, 0x1c0000
    s_mov_b32 s23, 0x20000
    s_mov_b32 s24, s76
    s_mov_b32 s25, s77
    s_mov_b32 s26, 0x380
    s_mov_b32 s27, 0x20000
    s_mov_b32 s40, s66
    s_mov_b32 s41, s67
    s_mov_b32 s42, 0x1c00
    s_mov_b32 s43, 0x20000
    s_sub_u32 s13, s2, 4
    s_and_b32 s13, s13, 7
    s_lshr_b32 s53, s2, 3
    s_mov_b32 s12, 0
    v_mov_b32 v18, 0
    s_cmp_ge_u32 s13, 2
    s_cbranch_scc1 plain
    s_getreg_b32 s12, hwreg(HW_REG_XCC_ID)
    s_and_b32 s12, s12, 1
    s_cmp_eq_u32 s3, 0
    s_cbranch_scc0 cl_1
    s_lshl_b32 s31, 1, s53
    s_lshl_b32 s32, s12, 2
    v_mov_b32 v18, s31
    s_mov_b64 exec, 1
    buffer_atomic_or v18, off, s[44:47], s32 offset:240 sc0
    s_mov_b64 exec, -1
cl_1:
    s_cmp_eq_u32 s12, 1
    s_mov_b32 s12, 1
    s_cbranch_scc0 dofold
    s_waitcnt vmcnt(0)
    v_mov_b32 v19, 149504
    s_cmp_eq_u32 s3, 0
    s_cbranch_scc0 cs_2
    v_readfirstlane_b32 s31, v18
    s_nop 1
    v_mov_b32 v18, s31
    ds_write_b32 v19, v18
    s_waitcnt lgkmcnt(0)
cs_2:
    s_barrier
    ds_read_b32 v18, v19
    s_waitcnt lgkmcnt(0)
    v_readfirstlane_b32 s31, v18
    s_bitcmp1_b32 s31, s53
    s_cbranch_scc0 die0
    s_mov_b32 s12, 0
    s_branch dofold
plain:
    s_sub_u32 s31, s13, 1
    s_lshl_b32 s31, s31, 5
    s_add_u32 s53, s53, s31
dofold:
    s_mul_i32 s4, s53, 4682
    s_lshr_b32 s4, s4, 16
    s_mul_i32 s31, s4, 14
    s_sub_u32 s31, s53, s31
    s_and_b32 s6, s31, 1
    s_lshr_b32 s7, s31, 1
    v_and_b32 v2, 15, v0
    v_lshrrev_b32 v3, 4, v0
    v_lshlrev_b32 v1, 4, v0
    v_lshrrev_b32 v4, 5, v0
    v_and_b32 v5, 31, v0
    v_xor_b32 v5, v5, v4
    s_and_b32 s31, s3, 1
    s_lshl_b32 s30, s31, 3
    v_xor_b32 v5, s30, v5
    v_lshlrev_b32 v5, 4, v5
    v_lshl_add_u32 v4, v4, 13, v5
    s_lshl_b32 s28, s7, 2
    s_add_u32 s28, s28, s3
    s_lshl_b32 s28, s28, 17
    s_lshl_b32 s29, s4, 9
    s_add_u32 s28, s28, s29
    s_lshl_b32 s48, s3, 13
    s_lshl_b32 s31, s6, 12
    s_xor_b32 s54, s48, s31
    s_lshl_b32 s31, s6, 16
    s_xor_b32 s55, s28, s31
    s_lshl_b32 s31, s6, 6
    v_xor_b32 v17, s31, v4
    s_mul_i32 s35, s4, 229376
    s_mul_i32 s31, s3, 64*896
    s_add_u32 s35, s35, s31
    s_mul_i32 s31, s6, 448
    s_add_u32 s35, s35, s31
    s_mul_i32 s49, s3, 28672
    s_add_u32 s49, s49, 32768
    s_mul_i32 s50, s6, 224
    s_mul_i32 s31, s3, 56
    s_add_u32 s50, s50, s31
    s_lshl_b32 s50, s50, 13
    s_add_u32 s50, s50, s29
    s_bitcmp1_b32 s7, 0
    s_cbranch_scc1 fa_3
    v_xor_b32 v5, 0, v17
    s_xor_b32 m0, s54, 0
    s_xor_b32 s33, s55, 0
    buffer_load_dwordx4 v5, s[60:63], s33 offen lds
    v_xor_b32 v5, 32, v17
    s_xor_b32 m0, s54, 1024
    s_xor_b32 s33, s55, 16384
    buffer_load_dwordx4 v5, s[60:63], s33 offen lds
    v_xor_b32 v5, 0, v17
    s_xor_b32 m0, s54, 2048
    s_xor_b32 s33, s55, 32768
    buffer_load_dwordx4 v5, s[60:63], s33 offen lds
    v_xor_b32 v5, 32, v17
    s_xor_b32 m0, s54, 3072
    s_xor_b32 s33, s55, 49152
    buffer_load_dwordx4 v5, s[60:63], s33 offen lds
    s_movk_i32 s31, 2341
    s_movk_i32 s32, 896
    v_add_u32 v5, 0, v0
    v_mul_u32_u24 v6, s31, v5
    v_lshrrev_b32 v6, 16, v6
    v_mul_u32_u24 v13, 28, v6
    v_sub_u32 v13, v5, v13
    v_mul_u32_u24 v6, s32, v6
    v_lshl_add_u32 v20, v13, 4, v6
    v_add_u32 v5, 64, v0
    v_mul_u32_u24 v6, s31, v5
    v_lshrrev_b32 v6, 16, v6
    v_mul_u32_u24 v13, 28, v6
    v_sub_u32 v13, v5, v13
    v_mul_u32_u24 v6, s32, v6
    v_lshl_add_u32 v21, v13, 4, v6
    v_add_u32 v5, 128, v0
    v_mul_u32_u24 v6, s31, v5
    v_lshrrev_b32 v6, 16, v6
    v_mul_u32_u24 v13, 28, v6
    v_sub_u32 v13, v5, v13
    v_mul_u32_u24 v6, s32, v6
    v_lshl_add_u32 v22, v13, 4, v6
    v_add_u32 v5, 192, v0
    v_mul_u32_u24 v6, s31, v5
    v_lshrrev_b32 v6, 16, v6
    v_mul_u32_u24 v13, 28, v6
    v_sub_u32 v13, v5, v13
    v_mul_u32_u24 v6, s32, v6
    v_lshl_add_u32 v23, v13, 4, v6
    v_add_u32 v5, 256, v0
    v_mul_u32_u24 v6, s31, v5
    v_lshrrev_b32 v6, 16, v6
    v_mul_u32_u24 v13, 28, v6
    v_sub_u32 v13, v5, v13
    v_mul_u32_u24 v6, s32, v6
    v_lshl_add_u32 v24, v13, 4, v6
    v_add_u32 v5, 320, v0
    v_mul_u32_u24 v6, s31, v5
    v_lshrrev_b32 v6, 16, v6
    v_mul_u32_u24 v13, 28, v6
    v_sub_u32 v13, v5, v13
    v_mul_u32_u24 v6, s32, v6
    v_lshl_add_u32 v25, v13, 4, v6
    v_add_u32 v5, 384, v0
    v_mul_u32_u24 v6, s31, v5
    v_lshrrev_b32 v6, 16, v6
    v_mul_u32_u24 v13, 28, v6
    v_sub_u32 v13, v5, v13
    v_mul_u32_u24 v6, s32, v6
    v_lshl_add_u32 v26, v13, 4, v6
    s_lshr_b32 s31, s7, 1
    s_add_u32 s31, s31, 0
    s_and_b32 s31, s31, 3
    s_mul_i32 s32, s31, 14336
    s_add_u32 s32, s32, s35
    s_mul_i32 s31, s31, 7168
    s_add_u32 s31, s31, s49
    s_add_u32 m0, s31, 0
    s_nop 0
    buffer_load_dwordx4 v20, s[16:19], s32 offen lds
    s_add_u32 m0, s31, 1024
    s_nop 0
    buffer_load_dwordx4 v21, s[16:19], s32 offen lds
    s_add_u32 m0, s31, 2048
    s_nop 0
    buffer_load_dwordx4 v22, s[16:19], s32 offen lds
    s_add_u32 m0, s31, 3072
    s_nop 0
    buffer_load_dwordx4 v23, s[16:19], s32 offen lds
    s_add_u32 m0, s31, 4096
    s_nop 0
    buffer_load_dwordx4 v24, s[16:19], s32 offen lds
    s_add_u32 m0, s31, 5120
    s_nop 0
    buffer_load_dwordx4 v25, s[16:19], s32 offen lds
    s_add_u32 m0, s31, 6144
    s_nop 0
    buffer_load_dwordx4 v26, s[16:19], s32 offen lds
    s_lshl_b32 s31, s3, 6
    v_add_u32 v240, s31, v0
    v_lshrrev_b32 v225, 3, v240
    v_and_b32 v224, 7, v0
    s_movk_i32 s31, 896
    v_mul_u32_u24 v226, s31, v224
    v_lshlrev_b32 v230, 4, v225
    v_add_u32 v226, v226, v230
    v_cmp_gt_u32 vcc, 192, v240
    v_mov_b32 v227, 0x7000000
    v_lshlrev_b32 v228, 4, v240
    v_cndmask_b32 v227, v227, v226, vcc
    s_mul_i32 s30, s2, 7168
    buffer_load_dwordx4 v[208:211], v226, s[20:23], s30 offen
    buffer_load_dwordx4 v[212:215], v227, s[20:23], s30 offen offset:512
    buffer_load_dwordx4 v[216:219], v230, s[24:27], 0 offen
    buffer_load_dwordx4 v[220:223], v230, s[24:27], 0 offen offset:512
    s_lshr_b32 s31, s7, 1
    s_add_u32 s31, s31, 1
    s_and_b32 s31, s31, 3
    s_mul_i32 s32, s31, 14336
    s_add_u32 s32, s32, s35
    s_mul_i32 s31, s31, 7168
    s_add_u32 s31, s31, s49
    s_add_u32 m0, s31, 0
    s_nop 0
    buffer_load_dwordx4 v20, s[16:19], s32 offen lds
    s_add_u32 m0, s31, 1024
    s_nop 0
    buffer_load_dwordx4 v21, s[16:19], s32 offen lds
    s_add_u32 m0, s31, 2048
    s_nop 0
    buffer_load_dwordx4 v22, s[16:19], s32 offen lds
    s_add_u32 m0, s31, 3072
    s_nop 0
    buffer_load_dwordx4 v23, s[16:19], s32 offen lds
    s_add_u32 m0, s31, 4096
    s_nop 0
    buffer_load_dwordx4 v24, s[16:19], s32 offen lds
    s_add_u32 m0, s31, 5120
    s_nop 0
    buffer_load_dwordx4 v25, s[16:19], s32 offen lds
    s_add_u32 m0, s31, 6144
    s_nop 0
    buffer_load_dwordx4 v26, s[16:19], s32 offen lds
    s_lshr_b32 s31, s7, 1
    s_add_u32 s31, s31, 2
    s_and_b32 s31, s31, 3
    s_mul_i32 s32, s31, 14336
    s_add_u32 s32, s32, s35
    s_mul_i32 s31, s31, 7168
    s_add_u32 s31, s31, s49
    s_add_u32 m0, s31, 0
    s_nop 0
    buffer_load_dwordx4 v20, s[16:19], s32 offen lds
    s_add_u32 m0, s31, 1024
    s_nop 0
    buffer_load_dwordx4 v21, s[16:19], s32 offen lds
    s_add_u32 m0, s31, 2048
    s_nop 0
    buffer_load_dwordx4 v22, s[16:19], s32 offen lds
    s_add_u32 m0, s31, 3072
    s_nop 0
    buffer_load_dwordx4 v23, s[16:19], s32 offen lds
    s_add_u32 m0, s31, 4096
    s_nop 0
    buffer_load_dwordx4 v24, s[16:19], s32 offen lds
    s_add_u32 m0, s31, 5120
    s_nop 0
    buffer_load_dwordx4 v25, s[16:19], s32 offen lds
    s_add_u32 m0, s31, 6144
    s_nop 0
    buffer_load_dwordx4 v26, s[16:19], s32 offen lds
    s_lshr_b32 s31, s7, 1
    s_add_u32 s31, s31, 3
    s_and_b32 s31, s31, 3
    s_mul_i32 s32, s31, 14336
    s_add_u32 s32, s32, s35
    s_mul_i32 s31, s31, 7168
    s_add_u32 s31, s31, s49
    s_add_u32 m0, s31, 0
    s_nop 0
    buffer_load_dwordx4 v20, s[16:19], s32 offen lds
    s_add_u32 m0, s31, 1024
    s_nop 0
    buffer_load_dwordx4 v21, s[16:19], s32 offen lds
    s_add_u32 m0, s31, 2048
    s_nop 0
    buffer_load_dwordx4 v22, s[16:19], s32 offen lds
    s_add_u32 m0, s31, 3072
    s_nop 0
    buffer_load_dwordx4 v23, s[16:19], s32 offen lds
    s_add_u32 m0, s31, 4096
    s_nop 0
    buffer_load_dwordx4 v24, s[16:19], s32 offen lds
    s_add_u32 m0, s31, 5120
    s_nop 0
    buffer_load_dwordx4 v25, s[16:19], s32 offen lds
    s_add_u32 m0, s31, 6144
    s_nop 0
    buffer_load_dwordx4 v26, s[16:19], s32 offen lds
    v_xor_b32 v5, 64, v17
    s_xor_b32 m0, s54, 4096
    s_xor_b32 s33, s55, 65536
    buffer_load_dwordx4 v5, s[60:63], s33 offen lds
    v_xor_b32 v5, 96, v17
    s_xor_b32 m0, s54, 5120
    s_xor_b32 s33, s55, 81920
    buffer_load_dwordx4 v5, s[60:63], s33 offen lds
    v_xor_b32 v5, 64, v17
    s_xor_b32 m0, s54, 6144
    s_xor_b32 s33, s55, 98304
    buffer_load_dwordx4 v5, s[60:63], s33 offen lds
    v_xor_b32 v5, 96, v17
    s_xor_b32 m0, s54, 7168
    s_xor_b32 s33, s55, 114688
    buffer_load_dwordx4 v5, s[60:63], s33 offen lds
    buffer_load_dword v16, off, s[44:47], 0 offset:252 sc1
    s_lshr_b32 s51, s3, 1
    s_and_b32 s52, s3, 1
    v_xor_b32 v6, v3, v2
    v_lshlrev_b32 v6, 4, v6
    v_lshrrev_b32 v7, 2, v2
    v_lshlrev_b32 v7, 3, v7
    v_and_b32 v8, 3, v0
    v_add_u32 v7, v7, v8
    v_lshl_add_u32 v7, v7, 9, v6
    s_lshl_b32 s30, s51, 14
    v_add_u32 v7, s30, v7
    v_lshl_add_u32 v9, v2, 9, v6
    s_mul_i32 s30, s52, 57344
    s_add_u32 s30, s30, 32768
    v_add_u32 v9, s30, v9
    v_lshrrev_b32 v10, 2, v2
    v_lshl_add_u32 v10, v3, 3, v10
    s_movk_i32 s30, 448
    v_mul_u32_u24 v10, s30, v10
    v_lshl_add_u32 v10, v8, 3, v10
    s_mul_i32 s30, s52, 224
    s_add_u32 s30, s30, 32768
    v_add_u32 v10, s30, v10
    s_waitcnt vmcnt(0)
    v_mov_b32 v19, 149504
    s_cmp_eq_u32 s3, 0
    s_cbranch_scc0 cs_5
    v_readfirstlane_b32 s31, v18
    s_nop 1
    v_mov_b32 v18, s31
    ds_write_b32 v19, v18
    s_waitcnt lgkmcnt(0)
cs_5:
    s_barrier
    s_cmp_eq_u32 s12, 0
    s_cbranch_scc1 ck_6
    ds_read_b32 v18, v19
    s_waitcnt lgkmcnt(0)
    v_readfirstlane_b32 s31, v18
    s_bitcmp1_b32 s31, s53
    s_cbranch_scc1 die0
ck_6:
    v_bfe_u32 v5, v0, 2, 3
    v_lshlrev_b32 v5, 13, v5
    v_lshl_add_u32 v5, v8, 7, v5
    s_lshl_b32 s30, s6, 16
    s_add_u32 s30, s30, s28
    buffer_load_dword v14, v5, s[36:39], s30 offen
    v_xor_b32 v11, 0, v7
    ds_read_b128 v[104:107], v11 offset:0
    ds_read_b128 v[108:111], v11 offset:2048
    v_add_u32 v12, 0, v10
    ds_read_b64_tr_b16 v[168:169], v12 offset:0
    ds_read_b64_tr_b16 v[170:171], v12 offset:1792
    ds_read_b64_tr_b16 v[172:173], v12 offset:32
    ds_read_b64_tr_b16 v[174:175], v12 offset:1824
    ds_read_b64_tr_b16 v[176:177], v12 offset:64
    ds_read_b64_tr_b16 v[178:179], v12 offset:1856
    ds_read_b64_tr_b16 v[180:181], v12 offset:96
    ds_read_b64_tr_b16 v[182:183], v12 offset:1888
    ds_read_b64_tr_b16 v[184:185], v12 offset:128
    ds_read_b64_tr_b16 v[186:187], v12 offset:1920
    v_xor_b32 v11, 64, v7
    ds_read_b128 v[112:115], v11 offset:0
    ds_read_b128 v[116:119], v11 offset:2048
    ds_read_b64_tr_b16 v[188:189], v12 offset:160
    ds_read_b64_tr_b16 v[190:191], v12 offset:1952
    s_waitcnt lgkmcnt(12)
    v_mfma_f32_16x16x32_bf16 v[48:51], v[104:107], v[168:171], 0
    v_mfma_f32_16x16x32_bf16 v[52:55], v[108:111], v[168:171], 0
    ds_read_b64_tr_b16 v[192:193], v12 offset:192
    ds_read_b64_tr_b16 v[194:195], v12 offset:1984
    s_waitcnt lgkmcnt(12)
    v_mfma_f32_16x16x32_bf16 v[56:59], v[104:107], v[172:175], 0
    v_mfma_f32_16x16x32_bf16 v[60:63], v[108:111], v[172:175], 0
    v_add_u32 v12, 14336, v10
    ds_read_b64_tr_b16 v[196:197], v12 offset:0
    ds_read_b64_tr_b16 v[198:199], v12 offset:1792
    s_waitcnt lgkmcnt(12)
    v_mfma_f32_16x16x32_bf16 v[64:67], v[104:107], v[176:179], 0
    v_mfma_f32_16x16x32_bf16 v[68:71], v[108:111], v[176:179], 0
    ds_read_b64_tr_b16 v[168:169], v12 offset:32
    ds_read_b64_tr_b16 v[170:171], v12 offset:1824
    s_waitcnt lgkmcnt(12)
    v_mfma_f32_16x16x32_bf16 v[72:75], v[104:107], v[180:183], 0
    v_mfma_f32_16x16x32_bf16 v[76:79], v[108:111], v[180:183], 0
    ds_read_b64_tr_b16 v[172:173], v12 offset:64
    ds_read_b64_tr_b16 v[174:175], v12 offset:1856
    s_waitcnt lgkmcnt(12)
    v_mfma_f32_16x16x32_bf16 v[80:83], v[104:107], v[184:187], 0
    v_mfma_f32_16x16x32_bf16 v[84:87], v[108:111], v[184:187], 0
    ds_read_b64_tr_b16 v[176:177], v12 offset:96
    ds_read_b64_tr_b16 v[178:179], v12 offset:1888
    s_waitcnt lgkmcnt(10)
    v_mfma_f32_16x16x32_bf16 v[88:91], v[104:107], v[188:191], 0
    v_mfma_f32_16x16x32_bf16 v[92:95], v[108:111], v[188:191], 0
    ds_read_b64_tr_b16 v[180:181], v12 offset:128
    ds_read_b64_tr_b16 v[182:183], v12 offset:1920
    s_waitcnt lgkmcnt(10)
    v_mfma_f32_16x16x32_bf16 v[96:99], v[104:107], v[192:195], 0
    v_mfma_f32_16x16x32_bf16 v[100:103], v[108:111], v[192:195], 0
    v_xor_b32 v11, 128, v7
    ds_read_b128 v[104:107], v11 offset:0
    ds_read_b128 v[108:111], v11 offset:2048
    ds_read_b64_tr_b16 v[184:185], v12 offset:160
    ds_read_b64_tr_b16 v[186:187], v12 offset:1952
    s_waitcnt lgkmcnt(12)
    v_mfma_f32_16x16x32_bf16 v[48:51], v[112:115], v[196:199], v[48:51]
    v_mfma_f32_16x16x32_bf16 v[52:55], v[116:119], v[196:199], v[52:55]
    ds_read_b64_tr_b16 v[188:189], v12 offset:192
    ds_read_b64_tr_b16 v[190:191], v12 offset:1984
    s_waitcnt lgkmcnt(12)
    v_mfma_f32_16x16x32_bf16 v[56:59], v[112:115], v[168:171], v[56:59]
    v_mfma_f32_16x16x32_bf16 v[60:63], v[116:119], v[168:171], v[60:63]
    v_add_u32 v12, 28672, v10
    ds_read_b64_tr_b16 v[192:193], v12 offset:0
    ds_read_b64_tr_b16 v[194:195], v12 offset:1792
    s_waitcnt lgkmcnt(12)
    v_mfma_f32_16x16x32_bf16 v[64:67], v[112:115], v[172:175], v[64:67]
    v_mfma_f32_16x16x32_bf16 v[68:71], v[116:119], v[172:175], v[68:71]
    ds_read_b64_tr_b16 v[196:197], v12 offset:32
    ds_read_b64_tr_b16 v[198:199], v12 offset:1824
    s_waitcnt lgkmcnt(12)
    v_mfma_f32_16x16x32_bf16 v[72:75], v[112:115], v[176:179], v[72:75]
    v_mfma_f32_16x16x32_bf16 v[76:79], v[116:119], v[176:179], v[76:79]
    ds_read_b64_tr_b16 v[168:169], v12 offset:64
    ds_read_b64_tr_b16 v[170:171], v12 offset:1856
    s_waitcnt lgkmcnt(12)
    v_mfma_f32_16x16x32_bf16 v[80:83], v[112:115], v[180:183], v[80:83]
    v_mfma_f32_16x16x32_bf16 v[84:87], v[116:119], v[180:183], v[84:87]
    ds_read_b64_tr_b16 v[172:173], v12 offset:96
    ds_read_b64_tr_b16 v[174:175], v12 offset:1888
    s_waitcnt lgkmcnt(10)
    v_mfma_f32_16x16x32_bf16 v[88:91], v[112:115], v[184:187], v[88:91]
    v_mfma_f32_16x16x32_bf16 v[92:95], v[116:119], v[184:187], v[92:95]
    ds_read_b64_tr_b16 v[176:177], v12 offset:128
    ds_read_b64_tr_b16 v[178:179], v12 offset:1920
    s_waitcnt lgkmcnt(10)
    v_mfma_f32_16x16x32_bf16 v[96:99], v[112:115], v[188:191], v[96:99]
    v_mfma_f32_16x16x32_bf16 v[100:103], v[116:119], v[188:191], v[100:103]
    v_xor_b32 v11, 192, v7
    ds_read_b128 v[112:115], v11 offset:0
    ds_read_b128 v[116:119], v11 offset:2048
    ds_read_b64_tr_b16 v[180:181], v12 offset:160
    ds_read_b64_tr_b16 v[182:183], v12 offset:1952
    s_waitcnt lgkmcnt(12)
    v_mfma_f32_16x16x32_bf16 v[48:51], v[104:107], v[192:195], v[48:51]
    v_mfma_f32_16x16x32_bf16 v[52:55], v[108:111], v[192:195], v[52:55]
    ds_read_b64_tr_b16 v[184:185], v12 offset:192
    ds_read_b64_tr_b16 v[186:187], v12 offset:1984
    s_waitcnt lgkmcnt(12)
    v_mfma_f32_16x16x32_bf16 v[56:59], v[104:107], v[196:199], v[56:59]
    v_mfma_f32_16x16x32_bf16 v[60:63], v[108:111], v[196:199], v[60:63]
    v_add_u32 v12, 43008, v10
    ds_read_b64_tr_b16 v[188:189], v12 offset:0
    ds_read_b64_tr_b16 v[190:191], v12 offset:1792
    s_waitcnt lgkmcnt(12)
    v_mfma_f32_16x16x32_bf16 v[64:67], v[104:107], v[168:171], v[64:67]
    v_mfma_f32_16x16x32_bf16 v[68:71], v[108:111], v[168:171], v[68:71]
    ds_read_b64_tr_b16 v[192:193], v12 offset:32
    ds_read_b64_tr_b16 v[194:195], v12 offset:1824
    s_waitcnt lgkmcnt(12)
    v_mfma_f32_16x16x32_bf16 v[72:75], v[104:107], v[172:175], v[72:75]
    v_mfma_f32_16x16x32_bf16 v[76:79], v[108:111], v[172:175], v[76:79]
    ds_read_b64_tr_b16 v[196:197], v12 offset:64
    ds_read_b64_tr_b16 v[198:199], v12 offset:1856
    s_waitcnt lgkmcnt(12)
    v_mfma_f32_16x16x32_bf16 v[80:83], v[104:107], v[176:179], v[80:83]
    v_mfma_f32_16x16x32_bf16 v[84:87], v[108:111], v[176:179], v[84:87]
    ds_read_b64_tr_b16 v[168:169], v12 offset:96
    ds_read_b64_tr_b16 v[170:171], v12 offset:1888
    s_waitcnt lgkmcnt(10)
    v_mfma_f32_16x16x32_bf16 v[88:91], v[104:107], v[180:183], v[88:91]
    v_mfma_f32_16x16x32_bf16 v[92:95], v[108:111], v[180:183], v[92:95]
    ds_read_b64_tr_b16 v[172:173], v12 offset:128
    ds_read_b64_tr_b16 v[174:175], v12 offset:1920
    s_waitcnt lgkmcnt(10)
    v_mfma_f32_16x16x32_bf16 v[96:99], v[104:107], v[184:187], v[96:99]
    v_mfma_f32_16x16x32_bf16 v[100:103], v[108:111], v[184:187], v[100:103]
    v_xor_b32 v11, 256, v7
    ds_read_b128 v[104:107], v11 offset:0
    ds_read_b128 v[108:111], v11 offset:2048
    ds_read_b64_tr_b16 v[176:177], v12 offset:160
    ds_read_b64_tr_b16 v[178:179], v12 offset:1952
    s_waitcnt lgkmcnt(12)
    v_mfma_f32_16x16x32_bf16 v[48:51], v[112:115], v[188:191], v[48:51]
    v_mfma_f32_16x16x32_bf16 v[52:55], v[116:119], v[188:191], v[52:55]
    ds_read_b64_tr_b16 v[180:181], v12 offset:192
    ds_read_b64_tr_b16 v[182:183], v12 offset:1984
    s_waitcnt lgkmcnt(12)
    v_mfma_f32_16x16x32_bf16 v[56:59], v[112:115], v[192:195], v[56:59]
    v_mfma_f32_16x16x32_bf16 v[60:63], v[116:119], v[192:195], v[60:63]
    v_add_u32 v12, 57344, v10
    ds_read_b64_tr_b16 v[184:185], v12 offset:0
    ds_read_b64_tr_b16 v[186:187], v12 offset:1792
    s_waitcnt lgkmcnt(12)
    v_mfma_f32_16x16x32_bf16 v[64:67], v[112:115], v[196:199], v[64:67]
    v_mfma_f32_16x16x32_bf16 v[68:71], v[116:119], v[196:199], v[68:71]
    ds_read_b64_tr_b16 v[188:189], v12 offset:32
    ds_read_b64_tr_b16 v[190:191], v12 offset:1824
    s_waitcnt lgkmcnt(12)
    v_mfma_f32_16x16x32_bf16 v[72:75], v[112:115], v[168:171], v[72:75]
    v_mfma_f32_16x16x32_bf16 v[76:79], v[116:119], v[168:171], v[76:79]
    ds_read_b64_tr_b16 v[192:193], v12 offset:64
    ds_read_b64_tr_b16 v[194:195], v12 offset:1856
    s_waitcnt lgkmcnt(12)
    v_mfma_f32_16x16x32_bf16 v[80:83], v[112:115], v[172:175], v[80:83]
    v_mfma_f32_16x16x32_bf16 v[84:87], v[116:119], v[172:175], v[84:87]
    ds_read_b64_tr_b16 v[196:197], v12 offset:96
    ds_read_b64_tr_b16 v[198:199], v12 offset:1888
    s_waitcnt lgkmcnt(10)
    v_mfma_f32_16x16x32_bf16 v[88:91], v[112:115], v[176:179], v[88:91]
    v_mfma_f32_16x16x32_bf16 v[92:95], v[116:119], v[176:179], v[92:95]
    ds_read_b64_tr_b16 v[168:169], v12 offset:128
    ds_read_b64_tr_b16 v[170:171], v12 offset:1920
    s_waitcnt lgkmcnt(10)
    v_mfma_f32_16x16x32_bf16 v[96:99], v[112:115], v[180:183], v[96:99]
    v_mfma_f32_16x16x32_bf16 v[100:103], v[116:119], v[180:183], v[100:103]
    v_xor_b32 v11, 320, v7
    ds_read_b128 v[112:115], v11 offset:0
    ds_read_b128 v[116:119], v11 offset:2048
    ds_read_b64_tr_b16 v[172:173], v12 offset:160
    ds_read_b64_tr_b16 v[174:175], v12 offset:1952
    s_waitcnt lgkmcnt(12)
    v_mfma_f32_16x16x32_bf16 v[48:51], v[104:107], v[184:187], v[48:51]
    v_mfma_f32_16x16x32_bf16 v[52:55], v[108:111], v[184:187], v[52:55]
    ds_read_b64_tr_b16 v[176:177], v12 offset:192
    ds_read_b64_tr_b16 v[178:179], v12 offset:1984
    s_waitcnt lgkmcnt(12)
    v_mfma_f32_16x16x32_bf16 v[56:59], v[104:107], v[188:191], v[56:59]
    v_mfma_f32_16x16x32_bf16 v[60:63], v[108:111], v[188:191], v[60:63]
    v_add_u32 v12, 71680, v10
    ds_read_b64_tr_b16 v[180:181], v12 offset:0
    ds_read_b64_tr_b16 v[182:183], v12 offset:1792
    s_waitcnt lgkmcnt(12)
    v_mfma_f32_16x16x32_bf16 v[64:67], v[104:107], v[192:195], v[64:67]
    v_mfma_f32_16x16x32_bf16 v[68:71], v[108:111], v[192:195], v[68:71]
    ds_read_b64_tr_b16 v[184:185], v12 offset:32
    ds_read_b64_tr_b16 v[186:187], v12 offset:1824
    s_waitcnt lgkmcnt(12)
    v_mfma_f32_16x16x32_bf16 v[72:75], v[104:107], v[196:199], v[72:75]
    v_mfma_f32_16x16x32_bf16 v[76:79], v[108:111], v[196:199], v[76:79]
    ds_read_b64_tr_b16 v[188:189], v12 offset:64
    ds_read_b64_tr_b16 v[190:191], v12 offset:1856
    s_waitcnt lgkmcnt(12)
    v_mfma_f32_16x16x32_bf16 v[80:83], v[104:107], v[168:171], v[80:83]
    v_mfma_f32_16x16x32_bf16 v[84:87], v[108:111], v[168:171], v[84:87]
    ds_read_b64_tr_b16 v[192:193], v12 offset:96
    ds_read_b64_tr_b16 v[194:195], v12 offset:1888
    s_waitcnt lgkmcnt(10)
    v_mfma_f32_16x16x32_bf16 v[88:91], v[104:107], v[172:175], v[88:91]
    v_mfma_f32_16x16x32_bf16 v[92:95], v[108:111], v[172:175], v[92:95]
    ds_read_b64_tr_b16 v[196:197], v12 offset:128
    ds_read_b64_tr_b16 v[198:199], v12 offset:1920
    s_waitcnt lgkmcnt(10)
    v_mfma_f32_16x16x32_bf16 v[96:99], v[104:107], v[176:179], v[96:99]
    v_mfma_f32_16x16x32_bf16 v[100:103], v[108:111], v[176:179], v[100:103]
    v_xor_b32 v11, 384, v7
    ds_read_b128 v[104:107], v11 offset:0
    ds_read_b128 v[108:111], v11 offset:2048
    ds_read_b64_tr_b16 v[168:169], v12 offset:160
    ds_read_b64_tr_b16 v[170:171], v12 offset:1952
    s_waitcnt lgkmcnt(12)
    v_mfma_f32_16x16x32_bf16 v[48:51], v[112:115], v[180:183], v[48:51]
    v_mfma_f32_16x16x32_bf16 v[52:55], v[116:119], v[180:183], v[52:55]
    ds_read_b64_tr_b16 v[172:173], v12 offset:192
    ds_read_b64_tr_b16 v[174:175], v12 offset:1984
    s_waitcnt lgkmcnt(12)
    v_mfma_f32_16x16x32_bf16 v[56:59], v[112:115], v[184:187], v[56:59]
    v_mfma_f32_16x16x32_bf16 v[60:63], v[116:119], v[184:187], v[60:63]
    v_add_u32 v12, 86016, v10
    ds_read_b64_tr_b16 v[176:177], v12 offset:0
    ds_read_b64_tr_b16 v[178:179], v12 offset:1792
    s_waitcnt lgkmcnt(12)
    v_mfma_f32_16x16x32_bf16 v[64:67], v[112:115], v[188:191], v[64:67]
    v_mfma_f32_16x16x32_bf16 v[68:71], v[116:119], v[188:191], v[68:71]
    ds_read_b64_tr_b16 v[180:181], v12 offset:32
    ds_read_b64_tr_b16 v[182:183], v12 offset:1824
    s_waitcnt lgkmcnt(12)
    v_mfma_f32_16x16x32_bf16 v[72:75], v[112:115], v[192:195], v[72:75]
    v_mfma_f32_16x16x32_bf16 v[76:79], v[116:119], v[192:195], v[76:79]
    ds_read_b64_tr_b16 v[184:185], v12 offset:64
    ds_read_b64_tr_b16 v[186:187], v12 offset:1856
    s_waitcnt lgkmcnt(12)
    v_mfma_f32_16x16x32_bf16 v[80:83], v[112:115], v[196:199], v[80:83]
    v_mfma_f32_16x16x32_bf16 v[84:87], v[116:119], v[196:199], v[84:87]
    ds_read_b64_tr_b16 v[188:189], v12 offset:96
    ds_read_b64_tr_b16 v[190:191], v12 offset:1888
    s_waitcnt lgkmcnt(10)
    v_mfma_f32_16x16x32_bf16 v[88:91], v[112:115], v[168:171], v[88:91]
    v_mfma_f32_16x16x32_bf16 v[92:95], v[116:119], v[168:171], v[92:95]
    ds_read_b64_tr_b16 v[192:193], v12 offset:128
    ds_read_b64_tr_b16 v[194:195], v12 offset:1920
    s_waitcnt lgkmcnt(10)
    v_mfma_f32_16x16x32_bf16 v[96:99], v[112:115], v[172:175], v[96:99]
    v_mfma_f32_16x16x32_bf16 v[100:103], v[116:119], v[172:175], v[100:103]
    v_xor_b32 v11, 448, v7
    ds_read_b128 v[112:115], v11 offset:0
    ds_read_b128 v[116:119], v11 offset:2048
    ds_read_b64_tr_b16 v[196:197], v12 offset:160
    ds_read_b64_tr_b16 v[198:199], v12 offset:1952
    s_waitcnt lgkmcnt(12)
    v_mfma_f32_16x16x32_bf16 v[48:51], v[104:107], v[176:179], v[48:51]
    v_mfma_f32_16x16x32_bf16 v[52:55], v[108:111], v[176:179], v[52:55]
    ds_read_b64_tr_b16 v[168:169], v12 offset:192
    ds_read_b64_tr_b16 v[170:171], v12 offset:1984
    s_waitcnt lgkmcnt(12)
    v_mfma_f32_16x16x32_bf16 v[56:59], v[104:107], v[180:183], v[56:59]
    v_mfma_f32_16x16x32_bf16 v[60:63], v[108:111], v[180:183], v[60:63]
    v_add_u32 v12, 100352, v10
    ds_read_b64_tr_b16 v[172:173], v12 offset:0
    ds_read_b64_tr_b16 v[174:175], v12 offset:1792
    s_waitcnt lgkmcnt(12)
    v_mfma_f32_16x16x32_bf16 v[64:67], v[104:107], v[184:187], v[64:67]
    v_mfma_f32_16x16x32_bf16 v[68:71], v[108:111], v[184:187], v[68:71]
    ds_read_b64_tr_b16 v[176:177], v12 offset:32
    ds_read_b64_tr_b16 v[178:179], v12 offset:1824
    s_waitcnt lgkmcnt(12)
    v_mfma_f32_16x16x32_bf16 v[72:75], v[104:107], v[188:191], v[72:75]
    v_mfma_f32_16x16x32_bf16 v[76:79], v[108:111], v[188:191], v[76:79]
    ds_read_b64_tr_b16 v[180:181], v12 offset:64
    ds_read_b64_tr_b16 v[182:183], v12 offset:1856
    s_waitcnt lgkmcnt(12)
    v_mfma_f32_16x16x32_bf16 v[80:83], v[104:107], v[192:195], v[80:83]
    v_mfma_f32_16x16x32_bf16 v[84:87], v[108:111], v[192:195], v[84:87]
    ds_read_b64_tr_b16 v[184:185], v12 offset:96
    ds_read_b64_tr_b16 v[186:187], v12 offset:1888
    s_waitcnt lgkmcnt(10)
    v_mfma_f32_16x16x32_bf16 v[88:91], v[104:107], v[196:199], v[88:91]
    v_mfma_f32_16x16x32_bf16 v[92:95], v[108:111], v[196:199], v[92:95]
    ds_read_b64_tr_b16 v[188:189], v12 offset:128
    ds_read_b64_tr_b16 v[190:191], v12 offset:1920
    s_waitcnt lgkmcnt(10)
    v_mfma_f32_16x16x32_bf16 v[96:99], v[104:107], v[168:171], v[96:99]
    v_mfma_f32_16x16x32_bf16 v[100:103], v[108:111], v[168:171], v[100:103]
    ds_read_b64_tr_b16 v[192:193], v12 offset:160
    ds_read_b64_tr_b16 v[194:195], v12 offset:1952
    s_waitcnt lgkmcnt(10)
    v_mfma_f32_16x16x32_bf16 v[48:51], v[112:115], v[172:175], v[48:51]
    v_mfma_f32_16x16x32_bf16 v[52:55], v[116:119], v[172:175], v[52:55]
    ds_read_b64_tr_b16 v[196:197], v12 offset:192
    ds_read_b64_tr_b16 v[198:199], v12 offset:1984
    s_waitcnt lgkmcnt(10)
    v_mfma_f32_16x16x32_bf16 v[56:59], v[112:115], v[176:179], v[56:59]
    v_mfma_f32_16x16x32_bf16 v[60:63], v[116:119], v[176:179], v[60:63]
    s_waitcnt lgkmcnt(8)
    v_mfma_f32_16x16x32_bf16 v[64:67], v[112:115], v[180:183], v[64:67]
    v_mfma_f32_16x16x32_bf16 v[68:71], v[116:119], v[180:183], v[68:71]
    s_waitcnt lgkmcnt(6)
    v_mfma_f32_16x16x32_bf16 v[72:75], v[112:115], v[184:187], v[72:75]
    v_mfma_f32_16x16x32_bf16 v[76:79], v[116:119], v[184:187], v[76:79]
    s_waitcnt lgkmcnt(4)
    v_mfma_f32_16x16x32_bf16 v[80:83], v[112:115], v[188:191], v[80:83]
    v_mfma_f32_16x16x32_bf16 v[84:87], v[116:119], v[188:191], v[84:87]
    s_waitcnt lgkmcnt(2)
    v_mfma_f32_16x16x32_bf16 v[88:91], v[112:115], v[192:195], v[88:91]
    v_mfma_f32_16x16x32_bf16 v[92:95], v[116:119], v[192:195], v[92:95]
    s_waitcnt lgkmcnt(0)
    v_mfma_f32_16x16x32_bf16 v[96:99], v[112:115], v[196:199], v[96:99]
    v_mfma_f32_16x16x32_bf16 v[100:103], v[116:119], v[196:199], v[100:103]
    s_mul_i32 s30, s4, 28
    s_mul_i32 s31, s6, 14
    s_add_u32 s30, s30, s31
    s_mul_i32 s31, s52, 7
    s_add_u32 s30, s30, s31
    s_mul_i32 s30, s30, 14
    s_lshl_b32 s31, s7, 1
    s_add_u32 s30, s30, s31
    s_add_u32 s30, s30, s51
    s_lshl_b32 s30, s30, 10
    s_add_u32 s30, s30, 0x620000
    s_mov_b32 s31, 0x3db8aa3b
    v_cvt_pk_bf16_f32 v136, v48, v49
    v_cvt_pk_bf16_f32 v137, v50, v51
    v_cvt_pk_bf16_f32 v138, v52, v53
    v_cvt_pk_bf16_f32 v139, v54, v55
    buffer_store_dwordx4 v[136:139], v1, s[8:11], s30 offen sc1
    s_add_u32 s30, s30, 14336
    v_cvt_pk_bf16_f32 v140, v56, v57
    v_cvt_pk_bf16_f32 v141, v58, v59
    v_cvt_pk_bf16_f32 v142, v60, v61
    v_cvt_pk_bf16_f32 v143, v62, v63
    buffer_store_dwordx4 v[140:143], v1, s[8:11], s30 offen sc1
    s_add_u32 s30, s30, 14336
    v_cvt_pk_bf16_f32 v144, v64, v65
    v_cvt_pk_bf16_f32 v145, v66, v67
    v_cvt_pk_bf16_f32 v146, v68, v69
    v_cvt_pk_bf16_f32 v147, v70, v71
    buffer_store_dwordx4 v[144:147], v1, s[8:11], s30 offen sc1
    s_add_u32 s30, s30, 14336
    v_cvt_pk_bf16_f32 v148, v72, v73
    v_cvt_pk_bf16_f32 v149, v74, v75
    v_cvt_pk_bf16_f32 v150, v76, v77
    v_cvt_pk_bf16_f32 v151, v78, v79
    buffer_store_dwordx4 v[148:151], v1, s[8:11], s30 offen sc1
    s_add_u32 s30, s30, 14336
    v_cvt_pk_bf16_f32 v152, v80, v81
    v_cvt_pk_bf16_f32 v153, v82, v83
    v_cvt_pk_bf16_f32 v154, v84, v85
    v_cvt_pk_bf16_f32 v155, v86, v87
    buffer_store_dwordx4 v[152:155], v1, s[8:11], s30 offen sc1
    s_add_u32 s30, s30, 14336
    v_cvt_pk_bf16_f32 v156, v88, v89
    v_cvt_pk_bf16_f32 v157, v90, v91
    v_cvt_pk_bf16_f32 v158, v92, v93
    v_cvt_pk_bf16_f32 v159, v94, v95
    buffer_store_dwordx4 v[156:159], v1, s[8:11], s30 offen sc1
    s_add_u32 s30, s30, 14336
    v_cvt_pk_bf16_f32 v160, v96, v97
    v_cvt_pk_bf16_f32 v161, v98, v99
    v_cvt_pk_bf16_f32 v162, v100, v101
    v_cvt_pk_bf16_f32 v163, v102, v103
    buffer_store_dwordx4 v[160:163], v1, s[8:11], s30 offen sc1
    s_lshr_b32 s32, s2, 1
    s_mul_i32 s32, s32, 14336
    s_and_b32 s30, s2, 1
    s_lshl_b32 s30, s30, 7
    s_add_u32 s32, s32, s30
    s_add_u32 s32, s32, 0xc40000
    s_add_u32 s30, s32, 8192
    v_cmp_gt_u32 vcc, 192, v240
    v_lshlrev_b32 v233, 8, v225
    v_lshl_add_u32 v233, v224, 4, v233
    v_mov_b32 v232, 0x8000000
    v_cndmask_b32 v232, v232, v233, vcc
    buffer_store_dwordx4 v[208:211], v233, s[8:11], s32 offen sc1
    buffer_store_dwordx4 v[212:215], v232, s[8:11], s30 offen sc1
    v_mov_b32 v234, 0
    v_dot2_f32_bf16 v234, v208, v216, v234
    v_dot2_f32_bf16 v234, v209, v217, v234
    v_dot2_f32_bf16 v234, v210, v218, v234
    v_dot2_f32_bf16 v234, v211, v219, v234
    v_dot2_f32_bf16 v234, v212, v220, v234
    v_dot2_f32_bf16 v234, v213, v221, v234
    v_dot2_f32_bf16 v234, v214, v222, v234
    v_dot2_f32_bf16 v234, v215, v223, v234
    v_lshlrev_b32 v232, 7, v224
    v_lshl_add_u32 v232, v225, 2, v232
    v_add_u32 v232, 147456, v232
    s_nop 0
    ds_write_b32 v232, v234
    s_waitcnt lgkmcnt(0)
    s_barrier
    s_cmp_eq_u32 s3, 3
    s_cbranch_scc0 ng_7
    v_lshlrev_b32 v232, 4, v0
    v_add_u32 v232, 147456, v232
    ds_read_b128 v[236:239], v232
    s_waitcnt lgkmcnt(0)
    v_add_f32 v233, v236, v237
    v_add_f32 v238, v238, v239
    v_add_f32 v233, v233, v238
    s_nop 1
    v_add_f32_dpp v233, v233, v233 quad_perm:[1,0,3,2] row_mask:0xf bank_mask:0xf
    s_nop 1
    v_add_f32_dpp v233, v233, v233 quad_perm:[2,3,0,1] row_mask:0xf bank_mask:0xf
    s_nop 1
    v_add_f32_dpp v233, v233, v233 row_half_mirror row_mask:0xf bank_mask:0xf
    v_mul_f32 v233, 0xbfb8aa3b, v233
    v_exp_f32 v233, v233
    s_nop 0
    v_add_f32 v233, 1.0, v233
    v_rcp_f32 v233, v233
    v_lshrrev_b32 v232, 3, v0
    v_lshlrev_b32 v232, 2, v232
    s_lshl_b32 s30, s2, 5
    s_add_u32 s30, s30, 0xe10000
    buffer_store_dword v233, v232, s[8:11], s30 offen sc1
ng_7:
    v_cmp_eq_u32 vcc, 0, v16
    s_cbranch_vccz js_8
    v_mov_b32 v243, 252
    s_mov_b32 s14, 0
ww_9:
    buffer_load_dword v16, v243, s[44:47], 0 offen sc1
    s_waitcnt vmcnt(0)
    v_cmp_eq_u32 vcc, 0, v16
    s_cbranch_vccz wk_10
    s_sleep 3
    s_add_u32 s14, s14, 1
    s_cmp_lt_u32 s14, 400000
    s_cbranch_scc1 ww_9
    s_endpgm
wk_10:
js_8:
    v_readfirstlane_b32 s5, v16
    s_waitcnt vmcnt(0)
    s_barrier
    s_cmp_eq_u32 s3, 0
    s_cbranch_scc0 sf_11
    s_lshl_b32 s31, s53, 2
    s_add_u32 s31, s31, 0xf81000
    v_mov_b32 v244, 1
    buffer_store_dword v244, off, s[8:11], s31 sc1
    s_add_u32 s31, s31, -2048
    buffer_store_dword v244, off, s[8:11], s31 sc1
sf_11:
    v_xor_b32 v5, 0, v17
    s_xor_b32 m0, s54, 0
    s_xor_b32 s33, s55, 0
    buffer_load_dwordx4 v5, s[36:39], s33 offen lds
    v_xor_b32 v5, 32, v17
    s_xor_b32 m0, s54, 1024
    s_xor_b32 s33, s55, 16384
    buffer_load_dwordx4 v5, s[36:39], s33 offen lds
    v_xor_b32 v5, 0, v17
    s_xor_b32 m0, s54, 2048
    s_xor_b32 s33, s55, 32768
    buffer_load_dwordx4 v5, s[36:39], s33 offen lds
    v_xor_b32 v5, 32, v17
    s_xor_b32 m0, s54, 3072
    s_xor_b32 s33, s55, 49152
    buffer_load_dwordx4 v5, s[36:39], s33 offen lds
    s_add_u32 s31, s7, 0
    s_cmp_ge_u32 s31, 7
    s_cselect_b32 s32, 7, 0
    s_sub_u32 s31, s31, s32
    s_lshl_b32 s32, s31, 16
    s_add_u32 s32, s32, s50
    s_and_b32 s30, s31, 1
    s_lshl_b32 s30, s30, 7
    v_xor_b32 v6, s30, v4
    s_lshl_b32 s31, s31, 12
    s_add_u32 s31, s31, s49
    v_xor_b32 v5, 0, v6
    s_add_u32 m0, s31, 0
    s_nop 0
    buffer_load_dwordx4 v5, s[56:59], s32 offen lds
    s_add_u32 s32, s32, 16384
    v_xor_b32 v5, 32, v6
    s_add_u32 m0, s31, 1024
    s_nop 0
    buffer_load_dwordx4 v5, s[56:59], s32 offen lds
    s_add_u32 s32, s32, 16384
    v_xor_b32 v5, 64, v6
    s_add_u32 m0, s31, 2048
    s_nop 0
    buffer_load_dwordx4 v5, s[56:59], s32 offen lds
    s_add_u32 s32, s32, 16384
    v_xor_b32 v5, 96, v6
    s_add_u32 m0, s31, 3072
    s_nop 0
    buffer_load_dwordx4 v5, s[56:59], s32 offen lds
    s_add_u32 s31, s7, 1
    s_cmp_ge_u32 s31, 7
    s_cselect_b32 s32, 7, 0
    s_sub_u32 s31, s31, s32
    s_lshl_b32 s32, s31, 16
    s_add_u32 s32, s32, s50
    s_and_b32 s30, s31, 1
    s_lshl_b32 s30, s30, 7
    v_xor_b32 v6, s30, v4
    s_lshl_b32 s31, s31, 12
    s_add_u32 s31, s31, s49
    v_xor_b32 v5, 0, v6
    s_add_u32 m0, s31, 0
    s_nop 0
    buffer_load_dwordx4 v5, s[56:59], s32 offen lds
    s_add_u32 s32, s32, 16384
    v_xor_b32 v5, 32, v6
    s_add_u32 m0, s31, 1024
    s_nop 0
    buffer_load_dwordx4 v5, s[56:59], s32 offen lds
    s_add_u32 s32, s32, 16384
    v_xor_b32 v5, 64, v6
    s_add_u32 m0, s31, 2048
    s_nop 0
    buffer_load_dwordx4 v5, s[56:59], s32 offen lds
    s_add_u32 s32, s32, 16384
    v_xor_b32 v5, 96, v6
    s_add_u32 m0, s31, 3072
    s_nop 0
    buffer_load_dwordx4 v5, s[56:59], s32 offen lds
    s_add_u32 s31, s7, 2
    s_cmp_ge_u32 s31, 7
    s_cselect_b32 s32, 7, 0
    s_sub_u32 s31, s31, s32
    s_lshl_b32 s32, s31, 16
    s_add_u32 s32, s32, s50
    s_and_b32 s30, s31, 1
    s_lshl_b32 s30, s30, 7
    v_xor_b32 v6, s30, v4
    s_lshl_b32 s31, s31, 12
    s_add_u32 s31, s31, s49
    v_xor_b32 v5, 0, v6
    s_add_u32 m0, s31, 0
    s_nop 0
    buffer_load_dwordx4 v5, s[56:59], s32 offen lds
    s_add_u32 s32, s32, 16384
    v_xor_b32 v5, 32, v6
    s_add_u32 m0, s31, 1024
    s_nop 0
    buffer_load_dwordx4 v5, s[56:59], s32 offen lds
    s_add_u32 s32, s32, 16384
    v_xor_b32 v5, 64, v6
    s_add_u32 m0, s31, 2048
    s_nop 0
    buffer_load_dwordx4 v5, s[56:59], s32 offen lds
    s_add_u32 s32, s32, 16384
    v_xor_b32 v5, 96, v6
    s_add_u32 m0, s31, 3072
    s_nop 0
    buffer_load_dwordx4 v5, s[56:59], s32 offen lds
    s_add_u32 s31, s7, 3
    s_cmp_ge_u32 s31, 7
    s_cselect_b32 s32, 7, 0
    s_sub_u32 s31, s31, s32
    s_lshl_b32 s32, s31, 16
    s_add_u32 s32, s32, s50
    s_and_b32 s30, s31, 1
    s_lshl_b32 s30, s30, 7
    v_xor_b32 v6, s30, v4
    s_lshl_b32 s31, s31, 12
    s_add_u32 s31, s31, s49
    v_xor_b32 v5, 0, v6
    s_add_u32 m0, s31, 0
    s_nop 0
    buffer_load_dwordx4 v5, s[56:59], s32 offen lds
    s_add_u32 s32, s32, 16384
    v_xor_b32 v5, 32, v6
    s_add_u32 m0, s31, 1024
    s_nop 0
    buffer_load_dwordx4 v5, s[56:59], s32 offen lds
    s_add_u32 s32, s32, 16384
    v_xor_b32 v5, 64, v6
    s_add_u32 m0, s31, 2048
    s_nop 0
    buffer_load_dwordx4 v5, s[56:59], s32 offen lds
    s_add_u32 s32, s32, 16384
    v_xor_b32 v5, 96, v6
    s_add_u32 m0, s31, 3072
    s_nop 0
    buffer_load_dwordx4 v5, s[56:59], s32 offen lds
    s_add_u32 s31, s7, 4
    s_cmp_ge_u32 s31, 7
    s_cselect_b32 s32, 7, 0
    s_sub_u32 s31, s31, s32
    s_lshl_b32 s32, s31, 16
    s_add_u32 s32, s32, s50
    s_and_b32 s30, s31, 1
    s_lshl_b32 s30, s30, 7
    v_xor_b32 v6, s30, v4
    s_lshl_b32 s31, s31, 12
    s_add_u32 s31, s31, s49
    v_xor_b32 v5, 0, v6
    s_add_u32 m0, s31, 0
    s_nop 0
    buffer_load_dwordx4 v5, s[56:59], s32 offen lds
    s_add_u32 s32, s32, 16384
    v_xor_b32 v5, 32, v6
    s_add_u32 m0, s31, 1024
    s_nop 0
    buffer_load_dwordx4 v5, s[56:59], s32 offen lds
    s_add_u32 s32, s32, 16384
    v_xor_b32 v5, 64, v6
    s_add_u32 m0, s31, 2048
    s_nop 0
    buffer_load_dwordx4 v5, s[56:59], s32 offen lds
    s_add_u32 s32, s32, 16384
    v_xor_b32 v5, 96, v6
    s_add_u32 m0, s31, 3072
    s_nop 0
    buffer_load_dwordx4 v5, s[56:59], s32 offen lds
    s_add_u32 s31, s7, 5
    s_cmp_ge_u32 s31, 7
    s_cselect_b32 s32, 7, 0
    s_sub_u32 s31, s31, s32
    s_lshl_b32 s32, s31, 16
    s_add_u32 s32, s32, s50
    s_and_b32 s30, s31, 1
    s_lshl_b32 s30, s30, 7
    v_xor_b32 v6, s30, v4
    s_lshl_b32 s31, s31, 12
    s_add_u32 s31, s31, s49
    v_xor_b32 v5, 0, v6
    s_add_u32 m0, s31, 0
    s_nop 0
    buffer_load_dwordx4 v5, s[56:59], s32 offen lds
    s_add_u32 s32, s32, 16384
    v_xor_b32 v5, 32, v6
    s_add_u32 m0, s31, 1024
    s_nop 0
    buffer_load_dwordx4 v5, s[56:59], s32 offen lds
    s_add_u32 s32, s32, 16384
    v_xor_b32 v5, 64, v6
    s_add_u32 m0, s31, 2048
    s_nop 0
    buffer_load_dwordx4 v5, s[56:59], s32 offen lds
    s_add_u32 s32, s32, 16384
    v_xor_b32 v5, 96, v6
    s_add_u32 m0, s31, 3072
    s_nop 0
    buffer_load_dwordx4 v5, s[56:59], s32 offen lds
    s_add_u32 s31, s7, 6
    s_cmp_ge_u32 s31, 7
    s_cselect_b32 s32, 7, 0
    s_sub_u32 s31, s31, s32
    s_lshl_b32 s32, s31, 16
    s_add_u32 s32, s32, s50
    s_and_b32 s30, s31, 1
    s_lshl_b32 s30, s30, 7
    v_xor_b32 v6, s30, v4
    s_lshl_b32 s31, s31, 12
    s_add_u32 s31, s31, s49
    v_xor_b32 v5, 0, v6
    s_add_u32 m0, s31, 0
    s_nop 0
    buffer_load_dwordx4 v5, s[56:59], s32 offen lds
    s_add_u32 s32, s32, 16384
    v_xor_b32 v5, 32, v6
    s_add_u32 m0, s31, 1024
    s_nop 0
    buffer_load_dwordx4 v5, s[56:59], s32 offen lds
    s_add_u32 s32, s32, 16384
    v_xor_b32 v5, 64, v6
    s_add_u32 m0, s31, 2048
    s_nop 0
    buffer_load_dwordx4 v5, s[56:59], s32 offen lds
    s_add_u32 s32, s32, 16384
    v_xor_b32 v5, 96, v6
    s_add_u32 m0, s31, 3072
    s_nop 0
    buffer_load_dwordx4 v5, s[56:59], s32 offen lds
    v_xor_b32 v5, 64, v17
    s_xor_b32 m0, s54, 4096
    s_xor_b32 s33, s55, 65536
    buffer_load_dwordx4 v5, s[36:39], s33 offen lds
    v_xor_b32 v5, 96, v17
    s_xor_b32 m0, s54, 5120
    s_xor_b32 s33, s55, 81920
    buffer_load_dwordx4 v5, s[36:39], s33 offen lds
    v_xor_b32 v5, 64, v17
    s_xor_b32 m0, s54, 6144
    s_xor_b32 s33, s55, 98304
    buffer_load_dwordx4 v5, s[36:39], s33 offen lds
    v_xor_b32 v5, 96, v17
    s_xor_b32 m0, s54, 7168
    s_xor_b32 s33, s55, 114688
    buffer_load_dwordx4 v5, s[36:39], s33 offen lds
    s_waitcnt vmcnt(0)
    s_barrier
    v_xor_b32 v11, 0, v7
    ds_read_b128 v[104:107], v11 offset:0
    ds_read_b128 v[108:111], v11 offset:2048
    v_xor_b32 v12, 0, v9
    ds_read_b128 v[168:171], v12 offset:0
    ds_read_b128 v[172:175], v12 offset:8192
    ds_read_b128 v[176:179], v12 offset:16384
    ds_read_b128 v[180:183], v12 offset:24576
    ds_read_b128 v[184:187], v12 offset:32768
    v_xor_b32 v11, 64, v7
    ds_read_b128 v[112:115], v11 offset:0
    ds_read_b128 v[116:119], v11 offset:2048
    ds_read_b128 v[188:191], v12 offset:40960
    s_waitcnt lgkmcnt(7)
    v_mfma_f32_16x16x32_bf16 v[48:51], v[104:107], v[168:171], 0
    v_mfma_f32_16x16x32_bf16 v[52:55], v[108:111], v[168:171], 0
    ds_read_b128 v[192:195], v12 offset:49152
    s_waitcnt lgkmcnt(7)
    v_mfma_f32_16x16x32_bf16 v[56:59], v[104:107], v[172:175], 0
    v_mfma_f32_16x16x32_bf16 v[60:63], v[108:111], v[172:175], 0
    v_xor_b32 v12, 64, v9
    ds_read_b128 v[196:199], v12 offset:0
    s_waitcnt lgkmcnt(7)
    v_mfma_f32_16x16x32_bf16 v[64:67], v[104:107], v[176:179], 0
    v_mfma_f32_16x16x32_bf16 v[68:71], v[108:111], v[176:179], 0
    ds_read_b128 v[168:171], v12 offset:8192
    s_waitcnt lgkmcnt(7)
    v_mfma_f32_16x16x32_bf16 v[72:75], v[104:107], v[180:183], 0
    v_mfma_f32_16x16x32_bf16 v[76:79], v[108:111], v[180:183], 0
    ds_read_b128 v[172:175], v12 offset:16384
    s_waitcnt lgkmcnt(7)
    v_mfma_f32_16x16x32_bf16 v[80:83], v[104:107], v[184:187], 0
    v_mfma_f32_16x16x32_bf16 v[84:87], v[108:111], v[184:187], 0
    ds_read_b128 v[176:179], v12 offset:24576
    s_waitcnt lgkmcnt(5)
    v_mfma_f32_16x16x32_bf16 v[88:91], v[104:107], v[188:191], 0
    v_mfma_f32_16x16x32_bf16 v[92:95], v[108:111], v[188:191], 0
    ds_read_b128 v[180:183], v12 offset:32768
    s_waitcnt lgkmcnt(5)
    v_mfma_f32_16x16x32_bf16 v[96:99], v[104:107], v[192:195], 0
    v_mfma_f32_16x16x32_bf16 v[100:103], v[108:111], v[192:195], 0
    v_xor_b32 v11, 128, v7
    ds_read_b128 v[104:107], v11 offset:0
    ds_read_b128 v[108:111], v11 offset:2048
    ds_read_b128 v[184:187], v12 offset:40960
    s_waitcnt lgkmcnt(7)
    v_mfma_f32_16x16x32_bf16 v[48:51], v[112:115], v[196:199], v[48:51]
    v_mfma_f32_16x16x32_bf16 v[52:55], v[116:119], v[196:199], v[52:55]
    ds_read_b128 v[188:191], v12 offset:49152
    s_waitcnt lgkmcnt(7)
    v_mfma_f32_16x16x32_bf16 v[56:59], v[112:115], v[168:171], v[56:59]
    v_mfma_f32_16x16x32_bf16 v[60:63], v[116:119], v[168:171], v[60:63]
    v_xor_b32 v12, 128, v9
    ds_read_b128 v[192:195], v12 offset:0
    s_waitcnt lgkmcnt(7)
    v_mfma_f32_16x16x32_bf16 v[64:67], v[112:115], v[172:175], v[64:67]
    v_mfma_f32_16x16x32_bf16 v[68:71], v[116:119], v[172:175], v[68:71]
    ds_read_b128 v[196:199], v12 offset:8192
    s_waitcnt lgkmcnt(7)
    v_mfma_f32_16x16x32_bf16 v[72:75], v[112:115], v[176:179], v[72:75]
    v_mfma_f32_16x16x32_bf16 v[76:79], v[116:119], v[176:179], v[76:79]
    ds_read_b128 v[168:171], v12 offset:16384
    s_waitcnt lgkmcnt(7)
    v_mfma_f32_16x16x32_bf16 v[80:83], v[112:115], v[180:183], v[80:83]
    v_mfma_f32_16x16x32_bf16 v[84:87], v[116:119], v[180:183], v[84:87]
    ds_read_b128 v[172:175], v12 offset:24576
    s_waitcnt lgkmcnt(5)
    v_mfma_f32_16x16x32_bf16 v[88:91], v[112:115], v[184:187], v[88:91]
    v_mfma_f32_16x16x32_bf16 v[92:95], v[116:119], v[184:187], v[92:95]
    ds_read_b128 v[176:179], v12 offset:32768
    s_waitcnt lgkmcnt(5)
    v_mfma_f32_16x16x32_bf16 v[96:99], v[112:115], v[188:191], v[96:99]
    v_mfma_f32_16x16x32_bf16 v[100:103], v[116:119], v[188:191], v[100:103]
    v_xor_b32 v11, 192, v7
    ds_read_b128 v[112:115], v11 offset:0
    ds_read_b128 v[116:119], v11 offset:2048
    ds_read_b128 v[180:183], v12 offset:40960
    s_waitcnt lgkmcnt(7)
    v_mfma_f32_16x16x32_bf16 v[48:51], v[104:107], v[192:195], v[48:51]
    v_mfma_f32_16x16x32_bf16 v[52:55], v[108:111], v[192:195], v[52:55]
    ds_read_b128 v[184:187], v12 offset:49152
    s_waitcnt lgkmcnt(7)
    v_mfma_f32_16x16x32_bf16 v[56:59], v[104:107], v[196:199], v[56:59]
    v_mfma_f32_16x16x32_bf16 v[60:63], v[108:111], v[196:199], v[60:63]
    v_xor_b32 v12, 192, v9
    ds_read_b128 v[188:191], v12 offset:0
    s_waitcnt lgkmcnt(7)
    v_mfma_f32_16x16x32_bf16 v[64:67], v[104:107], v[168:171], v[64:67]
    v_mfma_f32_16x16x32_bf16 v[68:71], v[108:111], v[168:171], v[68:71]
    ds_read_b128 v[192:195], v12 offset:8192
    s_waitcnt lgkmcnt(7)
    v_mfma_f32_16x16x32_bf16 v[72:75], v[104:107], v[172:175], v[72:75]
    v_mfma_f32_16x16x32_bf16 v[76:79], v[108:111], v[172:175], v[76:79]
    ds_read_b128 v[196:199], v12 offset:16384
    s_waitcnt lgkmcnt(7)
    v_mfma_f32_16x16x32_bf16 v[80:83], v[104:107], v[176:179], v[80:83]
    v_mfma_f32_16x16x32_bf16 v[84:87], v[108:111], v[176:179], v[84:87]
    ds_read_b128 v[168:171], v12 offset:24576
    s_waitcnt lgkmcnt(5)
    v_mfma_f32_16x16x32_bf16 v[88:91], v[104:107], v[180:183], v[88:91]
    v_mfma_f32_16x16x32_bf16 v[92:95], v[108:111], v[180:183], v[92:95]
    ds_read_b128 v[172:175], v12 offset:32768
    s_waitcnt lgkmcnt(5)
    v_mfma_f32_16x16x32_bf16 v[96:99], v[104:107], v[184:187], v[96:99]
    v_mfma_f32_16x16x32_bf16 v[100:103], v[108:111], v[184:187], v[100:103]
    v_xor_b32 v11, 256, v7
    ds_read_b128 v[104:107], v11 offset:0
    ds_read_b128 v[108:111], v11 offset:2048
    ds_read_b128 v[176:179], v12 offset:40960
    s_waitcnt lgkmcnt(7)
    v_mfma_f32_16x16x32_bf16 v[48:51], v[112:115], v[188:191], v[48:51]
    v_mfma_f32_16x16x32_bf16 v[52:55], v[116:119], v[188:191], v[52:55]
    ds_read_b128 v[180:183], v12 offset:49152
    s_waitcnt lgkmcnt(7)
    v_mfma_f32_16x16x32_bf16 v[56:59], v[112:115], v[192:195], v[56:59]
    v_mfma_f32_16x16x32_bf16 v[60:63], v[116:119], v[192:195], v[60:63]
    v_xor_b32 v12, 256, v9
    ds_read_b128 v[184:187], v12 offset:0
    s_waitcnt lgkmcnt(7)
    v_mfma_f32_16x16x32_bf16 v[64:67], v[112:115], v[196:199], v[64:67]
    v_mfma_f32_16x16x32_bf16 v[68:71], v[116:119], v[196:199], v[68:71]
    ds_read_b128 v[188:191], v12 offset:8192
    s_waitcnt lgkmcnt(7)
    v_mfma_f32_16x16x32_bf16 v[72:75], v[112:115], v[168:171], v[72:75]
    v_mfma_f32_16x16x32_bf16 v[76:79], v[116:119], v[168:171], v[76:79]
    ds_read_b128 v[192:195], v12 offset:16384
    s_waitcnt lgkmcnt(7)
    v_mfma_f32_16x16x32_bf16 v[80:83], v[112:115], v[172:175], v[80:83]
    v_mfma_f32_16x16x32_bf16 v[84:87], v[116:119], v[172:175], v[84:87]
    ds_read_b128 v[196:199], v12 offset:24576
    s_waitcnt lgkmcnt(5)
    v_mfma_f32_16x16x32_bf16 v[88:91], v[112:115], v[176:179], v[88:91]
    v_mfma_f32_16x16x32_bf16 v[92:95], v[116:119], v[176:179], v[92:95]
    ds_read_b128 v[168:171], v12 offset:32768
    s_waitcnt lgkmcnt(5)
    v_mfma_f32_16x16x32_bf16 v[96:99], v[112:115], v[180:183], v[96:99]
    v_mfma_f32_16x16x32_bf16 v[100:103], v[116:119], v[180:183], v[100:103]
    v_xor_b32 v11, 320, v7
    ds_read_b128 v[112:115], v11 offset:0
    ds_read_b128 v[116:119], v11 offset:2048
    ds_read_b128 v[172:175], v12 offset:40960
    s_waitcnt lgkmcnt(7)
    v_mfma_f32_16x16x32_bf16 v[48:51], v[104:107], v[184:187], v[48:51]
    v_mfma_f32_16x16x32_bf16 v[52:55], v[108:111], v[184:187], v[52:55]
    ds_read_b128 v[176:179], v12 offset:49152
    s_waitcnt lgkmcnt(7)
    v_mfma_f32_16x16x32_bf16 v[56:59], v[104:107], v[188:191], v[56:59]
    v_mfma_f32_16x16x32_bf16 v[60:63], v[108:111], v[188:191], v[60:63]
    v_xor_b32 v12, 320, v9
    ds_read_b128 v[180:183], v12 offset:0
    s_waitcnt lgkmcnt(7)
    v_mfma_f32_16x16x32_bf16 v[64:67], v[104:107], v[192:195], v[64:67]
    v_mfma_f32_16x16x32_bf16 v[68:71], v[108:111], v[192:195], v[68:71]
    ds_read_b128 v[184:187], v12 offset:8192
    s_waitcnt lgkmcnt(7)
    v_mfma_f32_16x16x32_bf16 v[72:75], v[104:107], v[196:199], v[72:75]
    v_mfma_f32_16x16x32_bf16 v[76:79], v[108:111], v[196:199], v[76:79]
    ds_read_b128 v[188:191], v12 offset:16384
    s_waitcnt lgkmcnt(7)
    v_mfma_f32_16x16x32_bf16 v[80:83], v[104:107], v[168:171], v[80:83]
    v_mfma_f32_16x16x32_bf16 v[84:87], v[108:111], v[168:171], v[84:87]
    ds_read_b128 v[192:195], v12 offset:24576
    s_waitcnt lgkmcnt(5)
    v_mfma_f32_16x16x32_bf16 v[88:91], v[104:107], v[172:175], v[88:91]
    v_mfma_f32_16x16x32_bf16 v[92:95], v[108:111], v[172:175], v[92:95]
    ds_read_b128 v[196:199], v12 offset:32768
    s_waitcnt lgkmcnt(5)
    v_mfma_f32_16x16x32_bf16 v[96:99], v[104:107], v[176:179], v[96:99]
    v_mfma_f32_16x16x32_bf16 v[100:103], v[108:111], v[176:179], v[100:103]
    v_xor_b32 v11, 384, v7
    ds_read_b128 v[104:107], v11 offset:0
    ds_read_b128 v[108:111], v11 offset:2048
    ds_read_b128 v[168:171], v12 offset:40960
    s_waitcnt lgkmcnt(7)
    v_mfma_f32_16x16x32_bf16 v[48:51], v[112:115], v[180:183], v[48:51]
    v_mfma_f32_16x16x32_bf16 v[52:55], v[116:119], v[180:183], v[52:55]
    ds_read_b128 v[172:175], v12 offset:49152
    s_waitcnt lgkmcnt(7)
    v_mfma_f32_16x16x32_bf16 v[56:59], v[112:115], v[184:187], v[56:59]
    v_mfma_f32_16x16x32_bf16 v[60:63], v[116:119], v[184:187], v[60:63]
    v_xor_b32 v12, 384, v9
    ds_read_b128 v[176:179], v12 offset:0
    s_waitcnt lgkmcnt(7)
    v_mfma_f32_16x16x32_bf16 v[64:67], v[112:115], v[188:191], v[64:67]
    v_mfma_f32_16x16x32_bf16 v[68:71], v[116:119], v[188:191], v[68:71]
    ds_read_b128 v[180:183], v12 offset:8192
    s_waitcnt lgkmcnt(7)
    v_mfma_f32_16x16x32_bf16 v[72:75], v[112:115], v[192:195], v[72:75]
    v_mfma_f32_16x16x32_bf16 v[76:79], v[116:119], v[192:195], v[76:79]
    ds_read_b128 v[184:187], v12 offset:16384
    s_waitcnt lgkmcnt(7)
    v_mfma_f32_16x16x32_bf16 v[80:83], v[112:115], v[196:199], v[80:83]
    v_mfma_f32_16x16x32_bf16 v[84:87], v[116:119], v[196:199], v[84:87]
    ds_read_b128 v[188:191], v12 offset:24576
    s_waitcnt lgkmcnt(5)
    v_mfma_f32_16x16x32_bf16 v[88:91], v[112:115], v[168:171], v[88:91]
    v_mfma_f32_16x16x32_bf16 v[92:95], v[116:119], v[168:171], v[92:95]
    ds_read_b128 v[192:195], v12 offset:32768
    s_waitcnt lgkmcnt(5)
    v_mfma_f32_16x16x32_bf16 v[96:99], v[112:115], v[172:175], v[96:99]
    v_mfma_f32_16x16x32_bf16 v[100:103], v[116:119], v[172:175], v[100:103]
    v_xor_b32 v11, 448, v7
    ds_read_b128 v[112:115], v11 offset:0
    ds_read_b128 v[116:119], v11 offset:2048
    ds_read_b128 v[196:199], v12 offset:40960
    s_waitcnt lgkmcnt(7)
    v_mfma_f32_16x16x32_bf16 v[48:51], v[104:107], v[176:179], v[48:51]
    v_mfma_f32_16x16x32_bf16 v[52:55], v[108:111], v[176:179], v[52:55]
    ds_read_b128 v[168:171], v12 offset:49152
    s_waitcnt lgkmcnt(7)
    v_mfma_f32_16x16x32_bf16 v[56:59], v[104:107], v[180:183], v[56:59]
    v_mfma_f32_16x16x32_bf16 v[60:63], v[108:111], v[180:183], v[60:63]
    v_xor_b32 v12, 448, v9
    ds_read_b128 v[172:175], v12 offset:0
    s_waitcnt lgkmcnt(7)
    v_mfma_f32_16x16x32_bf16 v[64:67], v[104:107], v[184:187], v[64:67]
    v_mfma_f32_16x16x32_bf16 v[68:71], v[108:111], v[184:187], v[68:71]
    ds_read_b128 v[176:179], v12 offset:8192
    s_waitcnt lgkmcnt(7)
    v_mfma_f32_16x16x32_bf16 v[72:75], v[104:107], v[188:191], v[72:75]
    v_mfma_f32_16x16x32_bf16 v[76:79], v[108:111], v[188:191], v[76:79]
    ds_read_b128 v[180:183], v12 offset:16384
    s_waitcnt lgkmcnt(7)
    v_mfma_f32_16x16x32_bf16 v[80:83], v[104:107], v[192:195], v[80:83]
    v_mfma_f32_16x16x32_bf16 v[84:87], v[108:111], v[192:195], v[84:87]
    ds_read_b128 v[184:187], v12 offset:24576
    s_waitcnt lgkmcnt(5)
    v_mfma_f32_16x16x32_bf16 v[88:91], v[104:107], v[196:199], v[88:91]
    v_mfma_f32_16x16x32_bf16 v[92:95], v[108:111], v[196:199], v[92:95]
    ds_read_b128 v[188:191], v12 offset:32768
    s_waitcnt lgkmcnt(5)
    v_mfma_f32_16x16x32_bf16 v[96:99], v[104:107], v[168:171], v[96:99]
    v_mfma_f32_16x16x32_bf16 v[100:103], v[108:111], v[168:171], v[100:103]
    ds_read_b128 v[192:195], v12 offset:40960
    s_waitcnt lgkmcnt(5)
    v_mfma_f32_16x16x32_bf16 v[48:51], v[112:115], v[172:175], v[48:51]
    v_mfma_f32_16x16x32_bf16 v[52:55], v[116:119], v[172:175], v[52:55]
    ds_read_b128 v[196:199], v12 offset:49152
    s_waitcnt lgkmcnt(5)
    v_mfma_f32_16x16x32_bf16 v[56:59], v[112:115], v[176:179], v[56:59]
    v_mfma_f32_16x16x32_bf16 v[60:63], v[116:119], v[176:179], v[60:63]
    s_waitcnt lgkmcnt(4)
    v_mfma_f32_16x16x32_bf16 v[64:67], v[112:115], v[180:183], v[64:67]
    v_mfma_f32_16x16x32_bf16 v[68:71], v[116:119], v[180:183], v[68:71]
    s_waitcnt lgkmcnt(3)
    v_mfma_f32_16x16x32_bf16 v[72:75], v[112:115], v[184:187], v[72:75]
    v_mfma_f32_16x16x32_bf16 v[76:79], v[116:119], v[184:187], v[76:79]
    s_waitcnt lgkmcnt(2)
    v_mfma_f32_16x16x32_bf16 v[80:83], v[112:115], v[188:191], v[80:83]
    v_mfma_f32_16x16x32_bf16 v[84:87], v[116:119], v[188:191], v[84:87]
    s_waitcnt lgkmcnt(1)
    v_mfma_f32_16x16x32_bf16 v[88:91], v[112:115], v[192:195], v[88:91]
    v_mfma_f32_16x16x32_bf16 v[92:95], v[116:119], v[192:195], v[92:95]
    s_waitcnt lgkmcnt(0)
    v_mfma_f32_16x16x32_bf16 v[96:99], v[112:115], v[196:199], v[96:99]
    v_mfma_f32_16x16x32_bf16 v[100:103], v[116:119], v[196:199], v[100:103]
    s_mul_i32 s30, s4, 28
    s_mul_i32 s31, s6, 14
    s_add_u32 s30, s30, s31
    s_mul_i32 s31, s52, 7
    s_add_u32 s30, s30, s31
    s_mul_i32 s30, s30, 14
    s_lshl_b32 s31, s7, 1
    s_add_u32 s30, s30, s31
    s_add_u32 s30, s30, s51
    s_lshl_b32 s30, s30, 10
    s_mov_b32 s31, 0x3db8aa3b
    v_mul_f32 v48, s31, v48
    v_mul_f32 v49, s31, v49
    v_mul_f32 v50, s31, v50
    v_mul_f32 v51, s31, v51
    v_mul_f32 v52, s31, v52
    v_mul_f32 v53, s31, v53
    v_mul_f32 v54, s31, v54
    v_mul_f32 v55, s31, v55
    v_cvt_pk_bf16_f32 v136, v48, v49
    v_cvt_pk_bf16_f32 v137, v50, v51
    v_cvt_pk_bf16_f32 v138, v52, v53
    v_cvt_pk_bf16_f32 v139, v54, v55
    buffer_store_dwordx4 v[136:139], v1, s[8:11], s30 offen sc1
    s_add_u32 s30, s30, 14336
    v_mul_f32 v56, s31, v56
    v_mul_f32 v57, s31, v57
    v_mul_f32 v58, s31, v58
    v_mul_f32 v59, s31, v59
    v_mul_f32 v60, s31, v60
    v_mul_f32 v61, s31, v61
    v_mul_f32 v62, s31, v62
    v_mul_f32 v63, s31, v63
    v_cvt_pk_bf16_f32 v140, v56, v57
    v_cvt_pk_bf16_f32 v141, v58, v59
    v_cvt_pk_bf16_f32 v142, v60, v61
    v_cvt_pk_bf16_f32 v143, v62, v63
    buffer_store_dwordx4 v[140:143], v1, s[8:11], s30 offen sc1
    s_add_u32 s30, s30, 14336
    v_mul_f32 v64, s31, v64
    v_mul_f32 v65, s31, v65
    v_mul_f32 v66, s31, v66
    v_mul_f32 v67, s31, v67
    v_mul_f32 v68, s31, v68
    v_mul_f32 v69, s31, v69
    v_mul_f32 v70, s31, v70
    v_mul_f32 v71, s31, v71
    v_cvt_pk_bf16_f32 v144, v64, v65
    v_cvt_pk_bf16_f32 v145, v66, v67
    v_cvt_pk_bf16_f32 v146, v68, v69
    v_cvt_pk_bf16_f32 v147, v70, v71
    buffer_store_dwordx4 v[144:147], v1, s[8:11], s30 offen sc1
    s_add_u32 s30, s30, 14336
    v_mul_f32 v72, s31, v72
    v_mul_f32 v73, s31, v73
    v_mul_f32 v74, s31, v74
    v_mul_f32 v75, s31, v75
    v_mul_f32 v76, s31, v76
    v_mul_f32 v77, s31, v77
    v_mul_f32 v78, s31, v78
    v_mul_f32 v79, s31, v79
    v_cvt_pk_bf16_f32 v148, v72, v73
    v_cvt_pk_bf16_f32 v149, v74, v75
    v_cvt_pk_bf16_f32 v150, v76, v77
    v_cvt_pk_bf16_f32 v151, v78, v79
    buffer_store_dwordx4 v[148:151], v1, s[8:11], s30 offen sc1
    s_add_u32 s30, s30, 14336
    v_mul_f32 v80, s31, v80
    v_mul_f32 v81, s31, v81
    v_mul_f32 v82, s31, v82
    v_mul_f32 v83, s31, v83
    v_mul_f32 v84, s31, v84
    v_mul_f32 v85, s31, v85
    v_mul_f32 v86, s31, v86
    v_mul_f32 v87, s31, v87
    v_cvt_pk_bf16_f32 v152, v80, v81
    v_cvt_pk_bf16_f32 v153, v82, v83
    v_cvt_pk_bf16_f32 v154, v84, v85
    v_cvt_pk_bf16_f32 v155, v86, v87
    buffer_store_dwordx4 v[152:155], v1, s[8:11], s30 offen sc1
    s_add_u32 s30, s30, 14336
    v_mul_f32 v88, s31, v88
    v_mul_f32 v89, s31, v89
    v_mul_f32 v90, s31, v90
    v_mul_f32 v91, s31, v91
    v_mul_f32 v92, s31, v92
    v_mul_f32 v93, s31, v93
    v_mul_f32 v94, s31, v94
    v_mul_f32 v95, s31, v95
    v_cvt_pk_bf16_f32 v156, v88, v89
    v_cvt_pk_bf16_f32 v157, v90, v91
    v_cvt_pk_bf16_f32 v158, v92, v93
    v_cvt_pk_bf16_f32 v159, v94, v95
    buffer_store_dwordx4 v[156:159], v1, s[8:11], s30 offen sc1
    s_add_u32 s30, s30, 14336
    v_mul_f32 v96, s31, v96
    v_mul_f32 v97, s31, v97
    v_mul_f32 v98, s31, v98
    v_mul_f32 v99, s31, v99
    v_mul_f32 v100, s31, v100
    v_mul_f32 v101, s31, v101
    v_mul_f32 v102, s31, v102
    v_mul_f32 v103, s31, v103
    v_cvt_pk_bf16_f32 v160, v96, v97
    v_cvt_pk_bf16_f32 v161, v98, v99
    v_cvt_pk_bf16_f32 v162, v100, v101
    v_cvt_pk_bf16_f32 v163, v102, v103
    buffer_store_dwordx4 v[160:163], v1, s[8:11], s30 offen sc1
    s_waitcnt vmcnt(0)
    s_barrier
    s_cmp_eq_u32 s3, 0
    s_cbranch_scc0 sf_12
    s_lshl_b32 s31, s53, 2
    s_add_u32 s31, s31, 0xf80c00
    v_mov_b32 v244, 1
    buffer_store_dword v244, off, s[8:11], s31 sc1
sf_12:
    s_branch fe_4
fa_3:
    v_xor_b32 v5, 0, v17
    s_xor_b32 m0, s54, 0
    s_xor_b32 s33, s55, 0
    buffer_load_dwordx4 v5, s[36:39], s33 offen lds
    v_xor_b32 v5, 32, v17
    s_xor_b32 m0, s54, 1024
    s_xor_b32 s33, s55, 16384
    buffer_load_dwordx4 v5, s[36:39], s33 offen lds
    v_xor_b32 v5, 0, v17
    s_xor_b32 m0, s54, 2048
    s_xor_b32 s33, s55, 32768
    buffer_load_dwordx4 v5, s[36:39], s33 offen lds
    v_xor_b32 v5, 32, v17
    s_xor_b32 m0, s54, 3072
    s_xor_b32 s33, s55, 49152
    buffer_load_dwordx4 v5, s[36:39], s33 offen lds
    s_add_u32 s31, s7, 0
    s_cmp_ge_u32 s31, 7
    s_cselect_b32 s32, 7, 0
    s_sub_u32 s31, s31, s32
    s_lshl_b32 s32, s31, 16
    s_add_u32 s32, s32, s50
    s_and_b32 s30, s31, 1
    s_lshl_b32 s30, s30, 7
    v_xor_b32 v6, s30, v4
    s_lshl_b32 s31, s31, 12
    s_add_u32 s31, s31, s49
    v_xor_b32 v5, 0, v6
    s_add_u32 m0, s31, 0
    s_nop 0
    buffer_load_dwordx4 v5, s[56:59], s32 offen lds
    s_add_u32 s32, s32, 16384
    v_xor_b32 v5, 32, v6
    s_add_u32 m0, s31, 1024
    s_nop 0
    buffer_load_dwordx4 v5, s[56:59], s32 offen lds
    s_add_u32 s32, s32, 16384
    v_xor_b32 v5, 64, v6
    s_add_u32 m0, s31, 2048
    s_nop 0
    buffer_load_dwordx4 v5, s[56:59], s32 offen lds
    s_add_u32 s32, s32, 16384
    v_xor_b32 v5, 96, v6
    s_add_u32 m0, s31, 3072
    s_nop 0
    buffer_load_dwordx4 v5, s[56:59], s32 offen lds
    s_lshl_b32 s31, s3, 6
    v_add_u32 v240, s31, v0
    v_lshrrev_b32 v225, 3, v240
    v_and_b32 v224, 7, v0
    s_movk_i32 s31, 896
    v_mul_u32_u24 v226, s31, v224
    v_lshlrev_b32 v230, 4, v225
    v_add_u32 v226, v226, v230
    v_cmp_gt_u32 vcc, 192, v240
    v_mov_b32 v227, 0x7000000
    v_lshlrev_b32 v228, 4, v240
    v_cndmask_b32 v227, v227, v226, vcc
    s_mul_i32 s30, s2, 7168
    buffer_load_dwordx4 v[208:211], v226, s[20:23], s30 offen
    buffer_load_dwordx4 v[212:215], v227, s[20:23], s30 offen offset:512
    buffer_load_dwordx4 v[216:219], v230, s[24:27], 0 offen
    buffer_load_dwordx4 v[220:223], v230, s[24:27], 0 offen offset:512
    s_add_u32 s31, s7, 1
    s_cmp_ge_u32 s31, 7
    s_cselect_b32 s32, 7, 0
    s_sub_u32 s31, s31, s32
    s_lshl_b32 s32, s31, 16
    s_add_u32 s32, s32, s50
    s_and_b32 s30, s31, 1
    s_lshl_b32 s30, s30, 7
    v_xor_b32 v6, s30, v4
    s_lshl_b32 s31, s31, 12
    s_add_u32 s31, s31, s49
    v_xor_b32 v5, 0, v6
    s_add_u32 m0, s31, 0
    s_nop 0
    buffer_load_dwordx4 v5, s[56:59], s32 offen lds
    s_add_u32 s32, s32, 16384
    v_xor_b32 v5, 32, v6
    s_add_u32 m0, s31, 1024
    s_nop 0
    buffer_load_dwordx4 v5, s[56:59], s32 offen lds
    s_add_u32 s32, s32, 16384
    v_xor_b32 v5, 64, v6
    s_add_u32 m0, s31, 2048
    s_nop 0
    buffer_load_dwordx4 v5, s[56:59], s32 offen lds
    s_add_u32 s32, s32, 16384
    v_xor_b32 v5, 96, v6
    s_add_u32 m0, s31, 3072
    s_nop 0
    buffer_load_dwordx4 v5, s[56:59], s32 offen lds
    s_add_u32 s31, s7, 2
    s_cmp_ge_u32 s31, 7
    s_cselect_b32 s32, 7, 0
    s_sub_u32 s31, s31, s32
    s_lshl_b32 s32, s31, 16
    s_add_u32 s32, s32, s50
    s_and_b32 s30, s31, 1
    s_lshl_b32 s30, s30, 7
    v_xor_b32 v6, s30, v4
    s_lshl_b32 s31, s31, 12
    s_add_u32 s31, s31, s49
    v_xor_b32 v5, 0, v6
    s_add_u32 m0, s31, 0
    s_nop 0
    buffer_load_dwordx4 v5, s[56:59], s32 offen lds
    s_add_u32 s32, s32, 16384
    v_xor_b32 v5, 32, v6
    s_add_u32 m0, s31, 1024
    s_nop 0
    buffer_load_dwordx4 v5, s[56:59], s32 offen lds
    s_add_u32 s32, s32, 16384
    v_xor_b32 v5, 64, v6
    s_add_u32 m0, s31, 2048
    s_nop 0
    buffer_load_dwordx4 v5, s[56:59], s32 offen lds
    s_add_u32 s32, s32, 16384
    v_xor_b32 v5, 96, v6
    s_add_u32 m0, s31, 3072
    s_nop 0
    buffer_load_dwordx4 v5, s[56:59], s32 offen lds
    s_add_u32 s31, s7, 3
    s_cmp_ge_u32 s31, 7
    s_cselect_b32 s32, 7, 0
    s_sub_u32 s31, s31, s32
    s_lshl_b32 s32, s31, 16
    s_add_u32 s32, s32, s50
    s_and_b32 s30, s31, 1
    s_lshl_b32 s30, s30, 7
    v_xor_b32 v6, s30, v4
    s_lshl_b32 s31, s31, 12
    s_add_u32 s31, s31, s49
    v_xor_b32 v5, 0, v6
    s_add_u32 m0, s31, 0
    s_nop 0
    buffer_load_dwordx4 v5, s[56:59], s32 offen lds
    s_add_u32 s32, s32, 16384
    v_xor_b32 v5, 32, v6
    s_add_u32 m0, s31, 1024
    s_nop 0
    buffer_load_dwordx4 v5, s[56:59], s32 offen lds
    s_add_u32 s32, s32, 16384
    v_xor_b32 v5, 64, v6
    s_add_u32 m0, s31, 2048
    s_nop 0
    buffer_load_dwordx4 v5, s[56:59], s32 offen lds
    s_add_u32 s32, s32, 16384
    v_xor_b32 v5, 96, v6
    s_add_u32 m0, s31, 3072
    s_nop 0
    buffer_load_dwordx4 v5, s[56:59], s32 offen lds
    s_add_u32 s31, s7, 4
    s_cmp_ge_u32 s31, 7
    s_cselect_b32 s32, 7, 0
    s_sub_u32 s31, s31, s32
    s_lshl_b32 s32, s31, 16
    s_add_u32 s32, s32, s50
    s_and_b32 s30, s31, 1
    s_lshl_b32 s30, s30, 7
    v_xor_b32 v6, s30, v4
    s_lshl_b32 s31, s31, 12
    s_add_u32 s31, s31, s49
    v_xor_b32 v5, 0, v6
    s_add_u32 m0, s31, 0
    s_nop 0
    buffer_load_dwordx4 v5, s[56:59], s32 offen lds
    s_add_u32 s32, s32, 16384
    v_xor_b32 v5, 32, v6
    s_add_u32 m0, s31, 1024
    s_nop 0
    buffer_load_dwordx4 v5, s[56:59], s32 offen lds
    s_add_u32 s32, s32, 16384
    v_xor_b32 v5, 64, v6
    s_add_u32 m0, s31, 2048
    s_nop 0
    buffer_load_dwordx4 v5, s[56:59], s32 offen lds
    s_add_u32 s32, s32, 16384
    v_xor_b32 v5, 96, v6
    s_add_u32 m0, s31, 3072
    s_nop 0
    buffer_load_dwordx4 v5, s[56:59], s32 offen lds
    s_add_u32 s31, s7, 5
    s_cmp_ge_u32 s31, 7
    s_cselect_b32 s32, 7, 0
    s_sub_u32 s31, s31, s32
    s_lshl_b32 s32, s31, 16
    s_add_u32 s32, s32, s50
    s_and_b32 s30, s31, 1
    s_lshl_b32 s30, s30, 7
    v_xor_b32 v6, s30, v4
    s_lshl_b32 s31, s31, 12
    s_add_u32 s31, s31, s49
    v_xor_b32 v5, 0, v6
    s_add_u32 m0, s31, 0
    s_nop 0
    buffer_load_dwordx4 v5, s[56:59], s32 offen lds
    s_add_u32 s32, s32, 16384
    v_xor_b32 v5, 32, v6
    s_add_u32 m0, s31, 1024
    s_nop 0
    buffer_load_dwordx4 v5, s[56:59], s32 offen lds
    s_add_u32 s32, s32, 16384
    v_xor_b32 v5, 64, v6
    s_add_u32 m0, s31, 2048
    s_nop 0
    buffer_load_dwordx4 v5, s[56:59], s32 offen lds
    s_add_u32 s32, s32, 16384
    v_xor_b32 v5, 96, v6
    s_add_u32 m0, s31, 3072
    s_nop 0
    buffer_load_dwordx4 v5, s[56:59], s32 offen lds
    s_add_u32 s31, s7, 6
    s_cmp_ge_u32 s31, 7
    s_cselect_b32 s32, 7, 0
    s_sub_u32 s31, s31, s32
    s_lshl_b32 s32, s31, 16
    s_add_u32 s32, s32, s50
    s_and_b32 s30, s31, 1
    s_lshl_b32 s30, s30, 7
    v_xor_b32 v6, s30, v4
    s_lshl_b32 s31, s31, 12
    s_add_u32 s31, s31, s49
    v_xor_b32 v5, 0, v6
    s_add_u32 m0, s31, 0
    s_nop 0
    buffer_load_dwordx4 v5, s[56:59], s32 offen lds
    s_add_u32 s32, s32, 16384
    v_xor_b32 v5, 32, v6
    s_add_u32 m0, s31, 1024
    s_nop 0
    buffer_load_dwordx4 v5, s[56:59], s32 offen lds
    s_add_u32 s32, s32, 16384
    v_xor_b32 v5, 64, v6
    s_add_u32 m0, s31, 2048
    s_nop 0
    buffer_load_dwordx4 v5, s[56:59], s32 offen lds
    s_add_u32 s32, s32, 16384
    v_xor_b32 v5, 96, v6
    s_add_u32 m0, s31, 3072
    s_nop 0
    buffer_load_dwordx4 v5, s[56:59], s32 offen lds
    v_xor_b32 v5, 64, v17
    s_xor_b32 m0, s54, 4096
    s_xor_b32 s33, s55, 65536
    buffer_load_dwordx4 v5, s[36:39], s33 offen lds
    v_xor_b32 v5, 96, v17
    s_xor_b32 m0, s54, 5120
    s_xor_b32 s33, s55, 81920
    buffer_load_dwordx4 v5, s[36:39], s33 offen lds
    v_xor_b32 v5, 64, v17
    s_xor_b32 m0, s54, 6144
    s_xor_b32 s33, s55, 98304
    buffer_load_dwordx4 v5, s[36:39], s33 offen lds
    v_xor_b32 v5, 96, v17
    s_xor_b32 m0, s54, 7168
    s_xor_b32 s33, s55, 114688
    buffer_load_dwordx4 v5, s[36:39], s33 offen lds
    buffer_load_dword v16, off, s[44:47], 0 offset:252 sc1
    s_lshr_b32 s51, s3, 1
    s_and_b32 s52, s3, 1
    v_xor_b32 v6, v3, v2
    v_lshlrev_b32 v6, 4, v6
    v_lshrrev_b32 v7, 2, v2
    v_lshlrev_b32 v7, 3, v7
    v_and_b32 v8, 3, v0
    v_add_u32 v7, v7, v8
    v_lshl_add_u32 v7, v7, 9, v6
    s_lshl_b32 s30, s51, 14
    v_add_u32 v7, s30, v7
    v_lshl_add_u32 v9, v2, 9, v6
    s_mul_i32 s30, s52, 57344
    s_add_u32 s30, s30, 32768
    v_add_u32 v9, s30, v9
    v_lshrrev_b32 v10, 2, v2
    v_lshl_add_u32 v10, v3, 3, v10
    s_movk_i32 s30, 448
    v_mul_u32_u24 v10, s30, v10
    v_lshl_add_u32 v10, v8, 3, v10
    s_mul_i32 s30, s52, 224
    s_add_u32 s30, s30, 32768
    v_add_u32 v10, s30, v10
    s_waitcnt vmcnt(0)
    v_mov_b32 v19, 149504
    s_cmp_eq_u32 s3, 0
    s_cbranch_scc0 cs_13
    v_readfirstlane_b32 s31, v18
    s_nop 1
    v_mov_b32 v18, s31
    ds_write_b32 v19, v18
    s_waitcnt lgkmcnt(0)
cs_13:
    s_barrier
    s_cmp_eq_u32 s12, 0
    s_cbranch_scc1 ck_14
    ds_read_b32 v18, v19
    s_waitcnt lgkmcnt(0)
    v_readfirstlane_b32 s31, v18
    s_bitcmp1_b32 s31, s53
    s_cbranch_scc1 die0
ck_14:
    v_bfe_u32 v5, v0, 2, 3
    v_lshlrev_b32 v5, 13, v5
    v_lshl_add_u32 v5, v8, 7, v5
    s_lshl_b32 s30, s6, 16
    s_add_u32 s30, s30, s28
    buffer_load_dword v14, v5, s[60:63], s30 offen
    v_xor_b32 v11, 0, v7
    ds_read_b128 v[104:107], v11 offset:0
    ds_read_b128 v[108:111], v11 offset:2048
    v_xor_b32 v12, 0, v9
    ds_read_b128 v[168:171], v12 offset:0
    ds_read_b128 v[172:175], v12 offset:8192
    ds_read_b128 v[176:179], v12 offset:16384
    ds_read_b128 v[180:183], v12 offset:24576
    ds_read_b128 v[184:187], v12 offset:32768
    v_xor_b32 v11, 64, v7
    ds_read_b128 v[112:115], v11 offset:0
    ds_read_b128 v[116:119], v11 offset:2048
    ds_read_b128 v[188:191], v12 offset:40960
    s_waitcnt lgkmcnt(7)
    v_mfma_f32_16x16x32_bf16 v[48:51], v[104:107], v[168:171], 0
    v_mfma_f32_16x16x32_bf16 v[52:55], v[108:111], v[168:171], 0
    ds_read_b128 v[192:195], v12 offset:49152
    s_waitcnt lgkmcnt(7)
    v_mfma_f32_16x16x32_bf16 v[56:59], v[104:107], v[172:175], 0
    v_mfma_f32_16x16x32_bf16 v[60:63], v[108:111], v[172:175], 0
    v_xor_b32 v12, 64, v9
    ds_read_b128 v[196:199], v12 offset:0
    s_waitcnt lgkmcnt(7)
    v_mfma_f32_16x16x32_bf16 v[64:67], v[104:107], v[176:179], 0
    v_mfma_f32_16x16x32_bf16 v[68:71], v[108:111], v[176:179], 0
    ds_read_b128 v[168:171], v12 offset:8192
    s_waitcnt lgkmcnt(7)
    v_mfma_f32_16x16x32_bf16 v[72:75], v[104:107], v[180:183], 0
    v_mfma_f32_16x16x32_bf16 v[76:79], v[108:111], v[180:183], 0
    ds_read_b128 v[172:175], v12 offset:16384
    s_waitcnt lgkmcnt(7)
    v_mfma_f32_16x16x32_bf16 v[80:83], v[104:107], v[184:187], 0
    v_mfma_f32_16x16x32_bf16 v[84:87], v[108:111], v[184:187], 0
    ds_read_b128 v[176:179], v12 offset:24576
    s_waitcnt lgkmcnt(5)
    v_mfma_f32_16x16x32_bf16 v[88:91], v[104:107], v[188:191], 0
    v_mfma_f32_16x16x32_bf16 v[92:95], v[108:111], v[188:191], 0
    ds_read_b128 v[180:183], v12 offset:32768
    s_waitcnt lgkmcnt(5)
    v_mfma_f32_16x16x32_bf16 v[96:99], v[104:107], v[192:195], 0
    v_mfma_f32_16x16x32_bf16 v[100:103], v[108:111], v[192:195], 0
    v_xor_b32 v11, 128, v7
    ds_read_b128 v[104:107], v11 offset:0
    ds_read_b128 v[108:111], v11 offset:2048
    ds_read_b128 v[184:187], v12 offset:40960
    s_waitcnt lgkmcnt(7)
    v_mfma_f32_16x16x32_bf16 v[48:51], v[112:115], v[196:199], v[48:51]
    v_mfma_f32_16x16x32_bf16 v[52:55], v[116:119], v[196:199], v[52:55]
    ds_read_b128 v[188:191], v12 offset:49152
    s_waitcnt lgkmcnt(7)
    v_mfma_f32_16x16x32_bf16 v[56:59], v[112:115], v[168:171], v[56:59]
    v_mfma_f32_16x16x32_bf16 v[60:63], v[116:119], v[168:171], v[60:63]
    v_xor_b32 v12, 128, v9
    ds_read_b128 v[192:195], v12 offset:0
    s_waitcnt lgkmcnt(7)
    v_mfma_f32_16x16x32_bf16 v[64:67], v[112:115], v[172:175], v[64:67]
    v_mfma_f32_16x16x32_bf16 v[68:71], v[116:119], v[172:175], v[68:71]
    ds_read_b128 v[196:199], v12 offset:8192
    s_waitcnt lgkmcnt(7)
    v_mfma_f32_16x16x32_bf16 v[72:75], v[112:115], v[176:179], v[72:75]
    v_mfma_f32_16x16x32_bf16 v[76:79], v[116:119], v[176:179], v[76:79]
    ds_read_b128 v[168:171], v12 offset:16384
    s_waitcnt lgkmcnt(7)
    v_mfma_f32_16x16x32_bf16 v[80:83], v[112:115], v[180:183], v[80:83]
    v_mfma_f32_16x16x32_bf16 v[84:87], v[116:119], v[180:183], v[84:87]
    ds_read_b128 v[172:175], v12 offset:24576
    s_waitcnt lgkmcnt(5)
    v_mfma_f32_16x16x32_bf16 v[88:91], v[112:115], v[184:187], v[88:91]
    v_mfma_f32_16x16x32_bf16 v[92:95], v[116:119], v[184:187], v[92:95]
    ds_read_b128 v[176:179], v12 offset:32768
    s_waitcnt lgkmcnt(5)
    v_mfma_f32_16x16x32_bf16 v[96:99], v[112:115], v[188:191], v[96:99]
    v_mfma_f32_16x16x32_bf16 v[100:103], v[116:119], v[188:191], v[100:103]
    v_xor_b32 v11, 192, v7
    ds_read_b128 v[112:115], v11 offset:0
    ds_read_b128 v[116:119], v11 offset:2048
    ds_read_b128 v[180:183], v12 offset:40960
    s_waitcnt lgkmcnt(7)
    v_mfma_f32_16x16x32_bf16 v[48:51], v[104:107], v[192:195], v[48:51]
    v_mfma_f32_16x16x32_bf16 v[52:55], v[108:111], v[192:195], v[52:55]
    ds_read_b128 v[184:187], v12 offset:49152
    s_waitcnt lgkmcnt(7)
    v_mfma_f32_16x16x32_bf16 v[56:59], v[104:107], v[196:199], v[56:59]
    v_mfma_f32_16x16x32_bf16 v[60:63], v[108:111], v[196:199], v[60:63]
    v_xor_b32 v12, 192, v9
    ds_read_b128 v[188:191], v12 offset:0
    s_waitcnt lgkmcnt(7)
    v_mfma_f32_16x16x32_bf16 v[64:67], v[104:107], v[168:171], v[64:67]
    v_mfma_f32_16x16x32_bf16 v[68:71], v[108:111], v[168:171], v[68:71]
    ds_read_b128 v[192:195], v12 offset:8192
    s_waitcnt lgkmcnt(7)
    v_mfma_f32_16x16x32_bf16 v[72:75], v[104:107], v[172:175], v[72:75]
    v_mfma_f32_16x16x32_bf16 v[76:79], v[108:111], v[172:175], v[76:79]
    ds_read_b128 v[196:199], v12 offset:16384
    s_waitcnt lgkmcnt(7)
    v_mfma_f32_16x16x32_bf16 v[80:83], v[104:107], v[176:179], v[80:83]
    v_mfma_f32_16x16x32_bf16 v[84:87], v[108:111], v[176:179], v[84:87]
    ds_read_b128 v[168:171], v12 offset:24576
    s_waitcnt lgkmcnt(5)
    v_mfma_f32_16x16x32_bf16 v[88:91], v[104:107], v[180:183], v[88:91]
    v_mfma_f32_16x16x32_bf16 v[92:95], v[108:111], v[180:183], v[92:95]
    ds_read_b128 v[172:175], v12 offset:32768
    s_waitcnt lgkmcnt(5)
    v_mfma_f32_16x16x32_bf16 v[96:99], v[104:107], v[184:187], v[96:99]
    v_mfma_f32_16x16x32_bf16 v[100:103], v[108:111], v[184:187], v[100:103]
    v_xor_b32 v11, 256, v7
    ds_read_b128 v[104:107], v11 offset:0
    ds_read_b128 v[108:111], v11 offset:2048
    ds_read_b128 v[176:179], v12 offset:40960
    s_waitcnt lgkmcnt(7)
    v_mfma_f32_16x16x32_bf16 v[48:51], v[112:115], v[188:191], v[48:51]
    v_mfma_f32_16x16x32_bf16 v[52:55], v[116:119], v[188:191], v[52:55]
    ds_read_b128 v[180:183], v12 offset:49152
    s_waitcnt lgkmcnt(7)
    v_mfma_f32_16x16x32_bf16 v[56:59], v[112:115], v[192:195], v[56:59]
    v_mfma_f32_16x16x32_bf16 v[60:63], v[116:119], v[192:195], v[60:63]
    v_xor_b32 v12, 256, v9
    ds_read_b128 v[184:187], v12 offset:0
    s_waitcnt lgkmcnt(7)
    v_mfma_f32_16x16x32_bf16 v[64:67], v[112:115], v[196:199], v[64:67]
    v_mfma_f32_16x16x32_bf16 v[68:71], v[116:119], v[196:199], v[68:71]
    ds_read_b128 v[188:191], v12 offset:8192
    s_waitcnt lgkmcnt(7)
    v_mfma_f32_16x16x32_bf16 v[72:75], v[112:115], v[168:171], v[72:75]
    v_mfma_f32_16x16x32_bf16 v[76:79], v[116:119], v[168:171], v[76:79]
    ds_read_b128 v[192:195], v12 offset:16384
    s_waitcnt lgkmcnt(7)
    v_mfma_f32_16x16x32_bf16 v[80:83], v[112:115], v[172:175], v[80:83]
    v_mfma_f32_16x16x32_bf16 v[84:87], v[116:119], v[172:175], v[84:87]
    ds_read_b128 v[196:199], v12 offset:24576
    s_waitcnt lgkmcnt(5)
    v_mfma_f32_16x16x32_bf16 v[88:91], v[112:115], v[176:179], v[88:91]
    v_mfma_f32_16x16x32_bf16 v[92:95], v[116:119], v[176:179], v[92:95]
    ds_read_b128 v[168:171], v12 offset:32768
    s_waitcnt lgkmcnt(5)
    v_mfma_f32_16x16x32_bf16 v[96:99], v[112:115], v[180:183], v[96:99]
    v_mfma_f32_16x16x32_bf16 v[100:103], v[116:119], v[180:183], v[100:103]
    v_xor_b32 v11, 320, v7
    ds_read_b128 v[112:115], v11 offset:0
    ds_read_b128 v[116:119], v11 offset:2048
    ds_read_b128 v[172:175], v12 offset:40960
    s_waitcnt lgkmcnt(7)
    v_mfma_f32_16x16x32_bf16 v[48:51], v[104:107], v[184:187], v[48:51]
    v_mfma_f32_16x16x32_bf16 v[52:55], v[108:111], v[184:187], v[52:55]
    ds_read_b128 v[176:179], v12 offset:49152
    s_waitcnt lgkmcnt(7)
    v_mfma_f32_16x16x32_bf16 v[56:59], v[104:107], v[188:191], v[56:59]
    v_mfma_f32_16x16x32_bf16 v[60:63], v[108:111], v[188:191], v[60:63]
    v_xor_b32 v12, 320, v9
    ds_read_b128 v[180:183], v12 offset:0
    s_waitcnt lgkmcnt(7)
    v_mfma_f32_16x16x32_bf16 v[64:67], v[104:107], v[192:195], v[64:67]
    v_mfma_f32_16x16x32_bf16 v[68:71], v[108:111], v[192:195], v[68:71]
    ds_read_b128 v[184:187], v12 offset:8192
    s_waitcnt lgkmcnt(7)
    v_mfma_f32_16x16x32_bf16 v[72:75], v[104:107], v[196:199], v[72:75]
    v_mfma_f32_16x16x32_bf16 v[76:79], v[108:111], v[196:199], v[76:79]
    ds_read_b128 v[188:191], v12 offset:16384
    s_waitcnt lgkmcnt(7)
    v_mfma_f32_16x16x32_bf16 v[80:83], v[104:107], v[168:171], v[80:83]
    v_mfma_f32_16x16x32_bf16 v[84:87], v[108:111], v[168:171], v[84:87]
    ds_read_b128 v[192:195], v12 offset:24576
    s_waitcnt lgkmcnt(5)
    v_mfma_f32_16x16x32_bf16 v[88:91], v[104:107], v[172:175], v[88:91]
    v_mfma_f32_16x16x32_bf16 v[92:95], v[108:111], v[172:175], v[92:95]
    ds_read_b128 v[196:199], v12 offset:32768
    s_waitcnt lgkmcnt(5)
    v_mfma_f32_16x16x32_bf16 v[96:99], v[104:107], v[176:179], v[96:99]
    v_mfma_f32_16x16x32_bf16 v[100:103], v[108:111], v[176:179], v[100:103]
    v_xor_b32 v11, 384, v7
    ds_read_b128 v[104:107], v11 offset:0
    ds_read_b128 v[108:111], v11 offset:2048
    ds_read_b128 v[168:171], v12 offset:40960
    s_waitcnt lgkmcnt(7)
    v_mfma_f32_16x16x32_bf16 v[48:51], v[112:115], v[180:183], v[48:51]
    v_mfma_f32_16x16x32_bf16 v[52:55], v[116:119], v[180:183], v[52:55]
    ds_read_b128 v[172:175], v12 offset:49152
    s_waitcnt lgkmcnt(7)
    v_mfma_f32_16x16x32_bf16 v[56:59], v[112:115], v[184:187], v[56:59]
    v_mfma_f32_16x16x32_bf16 v[60:63], v[116:119], v[184:187], v[60:63]
    v_xor_b32 v12, 384, v9
    ds_read_b128 v[176:179], v12 offset:0
    s_waitcnt lgkmcnt(7)
    v_mfma_f32_16x16x32_bf16 v[64:67], v[112:115], v[188:191], v[64:67]
    v_mfma_f32_16x16x32_bf16 v[68:71], v[116:119], v[188:191], v[68:71]
    ds_read_b128 v[180:183], v12 offset:8192
    s_waitcnt lgkmcnt(7)
    v_mfma_f32_16x16x32_bf16 v[72:75], v[112:115], v[192:195], v[72:75]
    v_mfma_f32_16x16x32_bf16 v[76:79], v[116:119], v[192:195], v[76:79]
    ds_read_b128 v[184:187], v12 offset:16384
    s_waitcnt lgkmcnt(7)
    v_mfma_f32_16x16x32_bf16 v[80:83], v[112:115], v[196:199], v[80:83]
    v_mfma_f32_16x16x32_bf16 v[84:87], v[116:119], v[196:199], v[84:87]
    ds_read_b128 v[188:191], v12 offset:24576
    s_waitcnt lgkmcnt(5)
    v_mfma_f32_16x16x32_bf16 v[88:91], v[112:115], v[168:171], v[88:91]
    v_mfma_f32_16x16x32_bf16 v[92:95], v[116:119], v[168:171], v[92:95]
    ds_read_b128 v[192:195], v12 offset:32768
    s_waitcnt lgkmcnt(5)
    v_mfma_f32_16x16x32_bf16 v[96:99], v[112:115], v[172:175], v[96:99]
    v_mfma_f32_16x16x32_bf16 v[100:103], v[116:119], v[172:175], v[100:103]
    v_xor_b32 v11, 448, v7
    ds_read_b128 v[112:115], v11 offset:0
    ds_read_b128 v[116:119], v11 offset:2048
    ds_read_b128 v[196:199], v12 offset:40960
    s_waitcnt lgkmcnt(7)
    v_mfma_f32_16x16x32_bf16 v[48:51], v[104:107], v[176:179], v[48:51]
    v_mfma_f32_16x16x32_bf16 v[52:55], v[108:111], v[176:179], v[52:55]
    ds_read_b128 v[168:171], v12 offset:49152
    s_waitcnt lgkmcnt(7)
    v_mfma_f32_16x16x32_bf16 v[56:59], v[104:107], v[180:183], v[56:59]
    v_mfma_f32_16x16x32_bf16 v[60:63], v[108:111], v[180:183], v[60:63]
    v_xor_b32 v12, 448, v9
    ds_read_b128 v[172:175], v12 offset:0
    s_waitcnt lgkmcnt(7)
    v_mfma_f32_16x16x32_bf16 v[64:67], v[104:107], v[184:187], v[64:67]
    v_mfma_f32_16x16x32_bf16 v[68:71], v[108:111], v[184:187], v[68:71]
    ds_read_b128 v[176:179], v12 offset:8192
    s_waitcnt lgkmcnt(7)
    v_mfma_f32_16x16x32_bf16 v[72:75], v[104:107], v[188:191], v[72:75]
    v_mfma_f32_16x16x32_bf16 v[76:79], v[108:111], v[188:191], v[76:79]
    ds_read_b128 v[180:183], v12 offset:16384
    s_waitcnt lgkmcnt(7)
    v_mfma_f32_16x16x32_bf16 v[80:83], v[104:107], v[192:195], v[80:83]
    v_mfma_f32_16x16x32_bf16 v[84:87], v[108:111], v[192:195], v[84:87]
    ds_read_b128 v[184:187], v12 offset:24576
    s_waitcnt lgkmcnt(5)
    v_mfma_f32_16x16x32_bf16 v[88:91], v[104:107], v[196:199], v[88:91]
    v_mfma_f32_16x16x32_bf16 v[92:95], v[108:111], v[196:199], v[92:95]
    ds_read_b128 v[188:191], v12 offset:32768
    s_waitcnt lgkmcnt(5)
    v_mfma_f32_16x16x32_bf16 v[96:99], v[104:107], v[168:171], v[96:99]
    v_mfma_f32_16x16x32_bf16 v[100:103], v[108:111], v[168:171], v[100:103]
    ds_read_b128 v[192:195], v12 offset:40960
    s_waitcnt lgkmcnt(5)
    v_mfma_f32_16x16x32_bf16 v[48:51], v[112:115], v[172:175], v[48:51]
    v_mfma_f32_16x16x32_bf16 v[52:55], v[116:119], v[172:175], v[52:55]
    ds_read_b128 v[196:199], v12 offset:49152
    s_waitcnt lgkmcnt(5)
    v_mfma_f32_16x16x32_bf16 v[56:59], v[112:115], v[176:179], v[56:59]
    v_mfma_f32_16x16x32_bf16 v[60:63], v[116:119], v[176:179], v[60:63]
    s_waitcnt lgkmcnt(4)
    v_mfma_f32_16x16x32_bf16 v[64:67], v[112:115], v[180:183], v[64:67]
    v_mfma_f32_16x16x32_bf16 v[68:71], v[116:119], v[180:183], v[68:71]
    s_waitcnt lgkmcnt(3)
    v_mfma_f32_16x16x32_bf16 v[72:75], v[112:115], v[184:187], v[72:75]
    v_mfma_f32_16x16x32_bf16 v[76:79], v[116:119], v[184:187], v[76:79]
    s_waitcnt lgkmcnt(2)
    v_mfma_f32_16x16x32_bf16 v[80:83], v[112:115], v[188:191], v[80:83]
    v_mfma_f32_16x16x32_bf16 v[84:87], v[116:119], v[188:191], v[84:87]
    s_waitcnt lgkmcnt(1)
    v_mfma_f32_16x16x32_bf16 v[88:91], v[112:115], v[192:195], v[88:91]
    v_mfma_f32_16x16x32_bf16 v[92:95], v[116:119], v[192:195], v[92:95]
    s_waitcnt lgkmcnt(0)
    v_mfma_f32_16x16x32_bf16 v[96:99], v[112:115], v[196:199], v[96:99]
    v_mfma_f32_16x16x32_bf16 v[100:103], v[116:119], v[196:199], v[100:103]
    s_mul_i32 s30, s4, 28
    s_mul_i32 s31, s6, 14
    s_add_u32 s30, s30, s31
    s_mul_i32 s31, s52, 7
    s_add_u32 s30, s30, s31
    s_mul_i32 s30, s30, 14
    s_lshl_b32 s31, s7, 1
    s_add_u32 s30, s30, s31
    s_add_u32 s30, s30, s51
    s_lshl_b32 s30, s30, 10
    s_mov_b32 s31, 0x3db8aa3b
    v_mul_f32 v48, s31, v48
    v_mul_f32 v49, s31, v49
    v_mul_f32 v50, s31, v50
    v_mul_f32 v51, s31, v51
    v_mul_f32 v52, s31, v52
    v_mul_f32 v53, s31, v53
    v_mul_f32 v54, s31, v54
    v_mul_f32 v55, s31, v55
    v_cvt_pk_bf16_f32 v136, v48, v49
    v_cvt_pk_bf16_f32 v137, v50, v51
    v_cvt_pk_bf16_f32 v138, v52, v53
    v_cvt_pk_bf16_f32 v139, v54, v55
    buffer_store_dwordx4 v[136:139], v1, s[8:11], s30 offen sc1
    s_add_u32 s30, s30, 14336
    v_mul_f32 v56, s31, v56
    v_mul_f32 v57, s31, v57
    v_mul_f32 v58, s31, v58
    v_mul_f32 v59, s31, v59
    v_mul_f32 v60, s31, v60
    v_mul_f32 v61, s31, v61
    v_mul_f32 v62, s31, v62
    v_mul_f32 v63, s31, v63
    v_cvt_pk_bf16_f32 v140, v56, v57
    v_cvt_pk_bf16_f32 v141, v58, v59
    v_cvt_pk_bf16_f32 v142, v60, v61
    v_cvt_pk_bf16_f32 v143, v62, v63
    buffer_store_dwordx4 v[140:143], v1, s[8:11], s30 offen sc1
    s_add_u32 s30, s30, 14336
    v_mul_f32 v64, s31, v64
    v_mul_f32 v65, s31, v65
    v_mul_f32 v66, s31, v66
    v_mul_f32 v67, s31, v67
    v_mul_f32 v68, s31, v68
    v_mul_f32 v69, s31, v69
    v_mul_f32 v70, s31, v70
    v_mul_f32 v71, s31, v71
    v_cvt_pk_bf16_f32 v144, v64, v65
    v_cvt_pk_bf16_f32 v145, v66, v67
    v_cvt_pk_bf16_f32 v146, v68, v69
    v_cvt_pk_bf16_f32 v147, v70, v71
    buffer_store_dwordx4 v[144:147], v1, s[8:11], s30 offen sc1
    s_add_u32 s30, s30, 14336
    v_mul_f32 v72, s31, v72
    v_mul_f32 v73, s31, v73
    v_mul_f32 v74, s31, v74
    v_mul_f32 v75, s31, v75
    v_mul_f32 v76, s31, v76
    v_mul_f32 v77, s31, v77
    v_mul_f32 v78, s31, v78
    v_mul_f32 v79, s31, v79
    v_cvt_pk_bf16_f32 v148, v72, v73
    v_cvt_pk_bf16_f32 v149, v74, v75
    v_cvt_pk_bf16_f32 v150, v76, v77
    v_cvt_pk_bf16_f32 v151, v78, v79
    buffer_store_dwordx4 v[148:151], v1, s[8:11], s30 offen sc1
    s_add_u32 s30, s30, 14336
    v_mul_f32 v80, s31, v80
    v_mul_f32 v81, s31, v81
    v_mul_f32 v82, s31, v82
    v_mul_f32 v83, s31, v83
    v_mul_f32 v84, s31, v84
    v_mul_f32 v85, s31, v85
    v_mul_f32 v86, s31, v86
    v_mul_f32 v87, s31, v87
    v_cvt_pk_bf16_f32 v152, v80, v81
    v_cvt_pk_bf16_f32 v153, v82, v83
    v_cvt_pk_bf16_f32 v154, v84, v85
    v_cvt_pk_bf16_f32 v155, v86, v87
    buffer_store_dwordx4 v[152:155], v1, s[8:11], s30 offen sc1
    s_add_u32 s30, s30, 14336
    v_mul_f32 v88, s31, v88
    v_mul_f32 v89, s31, v89
    v_mul_f32 v90, s31, v90
    v_mul_f32 v91, s31, v91
    v_mul_f32 v92, s31, v92
    v_mul_f32 v93, s31, v93
    v_mul_f32 v94, s31, v94
    v_mul_f32 v95, s31, v95
    v_cvt_pk_bf16_f32 v156, v88, v89
    v_cvt_pk_bf16_f32 v157, v90, v91
    v_cvt_pk_bf16_f32 v158, v92, v93
    v_cvt_pk_bf16_f32 v159, v94, v95
    buffer_store_dwordx4 v[156:159], v1, s[8:11], s30 offen sc1
    s_add_u32 s30, s30, 14336
    v_mul_f32 v96, s31, v96
    v_mul_f32 v97, s31, v97
    v_mul_f32 v98, s31, v98
    v_mul_f32 v99, s31, v99
    v_mul_f32 v100, s31, v100
    v_mul_f32 v101, s31, v101
    v_mul_f32 v102, s31, v102
    v_mul_f32 v103, s31, v103
    v_cvt_pk_bf16_f32 v160, v96, v97
    v_cvt_pk_bf16_f32 v161, v98, v99
    v_cvt_pk_bf16_f32 v162, v100, v101
    v_cvt_pk_bf16_f32 v163, v102, v103
    buffer_store_dwordx4 v[160:163], v1, s[8:11], s30 offen sc1
    s_lshr_b32 s32, s2, 1
    s_mul_i32 s32, s32, 14336
    s_and_b32 s30, s2, 1
    s_lshl_b32 s30, s30, 7
    s_add_u32 s32, s32, s30
    s_add_u32 s32, s32, 0xc40000
    s_add_u32 s30, s32, 8192
    v_cmp_gt_u32 vcc, 192, v240
    v_lshlrev_b32 v233, 8, v225
    v_lshl_add_u32 v233, v224, 4, v233
    v_mov_b32 v232, 0x8000000
    v_cndmask_b32 v232, v232, v233, vcc
    buffer_store_dwordx4 v[208:211], v233, s[8:11], s32 offen sc1
    buffer_store_dwordx4 v[212:215], v232, s[8:11], s30 offen sc1
    v_mov_b32 v234, 0
    v_dot2_f32_bf16 v234, v208, v216, v234
    v_dot2_f32_bf16 v234, v209, v217, v234
    v_dot2_f32_bf16 v234, v210, v218, v234
    v_dot2_f32_bf16 v234, v211, v219, v234
    v_dot2_f32_bf16 v234, v212, v220, v234
    v_dot2_f32_bf16 v234, v213, v221, v234
    v_dot2_f32_bf16 v234, v214, v222, v234
    v_dot2_f32_bf16 v234, v215, v223, v234
    v_lshlrev_b32 v232, 7, v224
    v_lshl_add_u32 v232, v225, 2, v232
    v_add_u32 v232, 147456, v232
    s_nop 0
    ds_write_b32 v232, v234
    s_waitcnt lgkmcnt(0)
    s_barrier
    s_cmp_eq_u32 s3, 3
    s_cbranch_scc0 ng_15
    v_lshlrev_b32 v232, 4, v0
    v_add_u32 v232, 147456, v232
    ds_read_b128 v[236:239], v232
    s_waitcnt lgkmcnt(0)
    v_add_f32 v233, v236, v237
    v_add_f32 v238, v238, v239
    v_add_f32 v233, v233, v238
    s_nop 1
    v_add_f32_dpp v233, v233, v233 quad_perm:[1,0,3,2] row_mask:0xf bank_mask:0xf
    s_nop 1
    v_add_f32_dpp v233, v233, v233 quad_perm:[2,3,0,1] row_mask:0xf bank_mask:0xf
    s_nop 1
    v_add_f32_dpp v233, v233, v233 row_half_mirror row_mask:0xf bank_mask:0xf
    v_mul_f32 v233, 0xbfb8aa3b, v233
    v_exp_f32 v233, v233
    s_nop 0
    v_add_f32 v233, 1.0, v233
    v_rcp_f32 v233, v233
    v_lshrrev_b32 v232, 3, v0
    v_lshlrev_b32 v232, 2, v232
    s_lshl_b32 s30, s2, 5
    s_add_u32 s30, s30, 0xe10000
    buffer_store_dword v233, v232, s[8:11], s30 offen sc1
ng_15:
    v_cmp_eq_u32 vcc, 0, v16
    s_cbranch_vccz js_16
    v_mov_b32 v243, 252
    s_mov_b32 s14, 0
ww_17:
    buffer_load_dword v16, v243, s[44:47], 0 offen sc1
    s_waitcnt vmcnt(0)
    v_cmp_eq_u32 vcc, 0, v16
    s_cbranch_vccz wk_18
    s_sleep 3
    s_add_u32 s14, s14, 1
    s_cmp_lt_u32 s14, 400000
    s_cbranch_scc1 ww_17
    s_endpgm
wk_18:
js_16:
    v_readfirstlane_b32 s5, v16
    s_waitcnt vmcnt(0)
    s_barrier
    s_cmp_eq_u32 s3, 0
    s_cbranch_scc0 sf_19
    s_lshl_b32 s31, s53, 2
    s_add_u32 s31, s31, 0xf80c00
    v_mov_b32 v244, 1
    buffer_store_dword v244, off, s[8:11], s31 sc1
    s_add_u32 s31, s31, -1024
    buffer_store_dword v244, off, s[8:11], s31 sc1
sf_19:
    v_xor_b32 v5, 0, v17
    s_xor_b32 m0, s54, 0
    s_xor_b32 s33, s55, 0
    buffer_load_dwordx4 v5, s[60:63], s33 offen lds
    v_xor_b32 v5, 32, v17
    s_xor_b32 m0, s54, 1024
    s_xor_b32 s33, s55, 16384
    buffer_load_dwordx4 v5, s[60:63], s33 offen lds
    v_xor_b32 v5, 0, v17
    s_xor_b32 m0, s54, 2048
    s_xor_b32 s33, s55, 32768
    buffer_load_dwordx4 v5, s[60:63], s33 offen lds
    v_xor_b32 v5, 32, v17
    s_xor_b32 m0, s54, 3072
    s_xor_b32 s33, s55, 49152
    buffer_load_dwordx4 v5, s[60:63], s33 offen lds
    s_movk_i32 s31, 2341
    s_movk_i32 s32, 896
    v_add_u32 v5, 0, v0
    v_mul_u32_u24 v6, s31, v5
    v_lshrrev_b32 v6, 16, v6
    v_mul_u32_u24 v13, 28, v6
    v_sub_u32 v13, v5, v13
    v_mul_u32_u24 v6, s32, v6
    v_lshl_add_u32 v20, v13, 4, v6
    v_add_u32 v5, 64, v0
    v_mul_u32_u24 v6, s31, v5
    v_lshrrev_b32 v6, 16, v6
    v_mul_u32_u24 v13, 28, v6
    v_sub_u32 v13, v5, v13
    v_mul_u32_u24 v6, s32, v6
    v_lshl_add_u32 v21, v13, 4, v6
    v_add_u32 v5, 128, v0
    v_mul_u32_u24 v6, s31, v5
    v_lshrrev_b32 v6, 16, v6
    v_mul_u32_u24 v13, 28, v6
    v_sub_u32 v13, v5, v13
    v_mul_u32_u24 v6, s32, v6
    v_lshl_add_u32 v22, v13, 4, v6
    v_add_u32 v5, 192, v0
    v_mul_u32_u24 v6, s31, v5
    v_lshrrev_b32 v6, 16, v6
    v_mul_u32_u24 v13, 28, v6
    v_sub_u32 v13, v5, v13
    v_mul_u32_u24 v6, s32, v6
    v_lshl_add_u32 v23, v13, 4, v6
    v_add_u32 v5, 256, v0
    v_mul_u32_u24 v6, s31, v5
    v_lshrrev_b32 v6, 16, v6
    v_mul_u32_u24 v13, 28, v6
    v_sub_u32 v13, v5, v13
    v_mul_u32_u24 v6, s32, v6
    v_lshl_add_u32 v24, v13, 4, v6
    v_add_u32 v5, 320, v0
    v_mul_u32_u24 v6, s31, v5
    v_lshrrev_b32 v6, 16, v6
    v_mul_u32_u24 v13, 28, v6
    v_sub_u32 v13, v5, v13
    v_mul_u32_u24 v6, s32, v6
    v_lshl_add_u32 v25, v13, 4, v6
    v_add_u32 v5, 384, v0
    v_mul_u32_u24 v6, s31, v5
    v_lshrrev_b32 v6, 16, v6
    v_mul_u32_u24 v13, 28, v6
    v_sub_u32 v13, v5, v13
    v_mul_u32_u24 v6, s32, v6
    v_lshl_add_u32 v26, v13, 4, v6
    s_lshr_b32 s31, s7, 1
    s_add_u32 s31, s31, 0
    s_and_b32 s31, s31, 3
    s_mul_i32 s32, s31, 14336
    s_add_u32 s32, s32, s35
    s_mul_i32 s31, s31, 7168
    s_add_u32 s31, s31, s49
    s_add_u32 m0, s31, 0
    s_nop 0
    buffer_load_dwordx4 v20, s[16:19], s32 offen lds
    s_add_u32 m0, s31, 1024
    s_nop 0
    buffer_load_dwordx4 v21, s[16:19], s32 offen lds
    s_add_u32 m0, s31, 2048
    s_nop 0
    buffer_load_dwordx4 v22, s[16:19], s32 offen lds
    s_add_u32 m0, s31, 3072
    s_nop 0
    buffer_load_dwordx4 v23, s[16:19], s32 offen lds
    s_add_u32 m0, s31, 4096
    s_nop 0
    buffer_load_dwordx4 v24, s[16:19], s32 offen lds
    s_add_u32 m0, s31, 5120
    s_nop 0
    buffer_load_dwordx4 v25, s[16:19], s32 offen lds
    s_add_u32 m0, s31, 6144
    s_nop 0
    buffer_load_dwordx4 v26, s[16:19], s32 offen lds
    s_lshr_b32 s31, s7, 1
    s_add_u32 s31, s31, 1
    s_and_b32 s31, s31, 3
    s_mul_i32 s32, s31, 14336
    s_add_u32 s32, s32, s35
    s_mul_i32 s31, s31, 7168
    s_add_u32 s31, s31, s49
    s_add_u32 m0, s31, 0
    s_nop 0
    buffer_load_dwordx4 v20, s[16:19], s32 offen lds
    s_add_u32 m0, s31, 1024
    s_nop 0
    buffer_load_dwordx4 v21, s[16:19], s32 offen lds
    s_add_u32 m0, s31, 2048
    s_nop 0
    buffer_load_dwordx4 v22, s[16:19], s32 offen lds
    s_add_u32 m0, s31, 3072
    s_nop 0
    buffer_load_dwordx4 v23, s[16:19], s32 offen lds
    s_add_u32 m0, s31, 4096
    s_nop 0
    buffer_load_dwordx4 v24, s[16:19], s32 offen lds
    s_add_u32 m0, s31, 5120
    s_nop 0
    buffer_load_dwordx4 v25, s[16:19], s32 offen lds
    s_add_u32 m0, s31, 6144
    s_nop 0
    buffer_load_dwordx4 v26, s[16:19], s32 offen lds
    s_lshr_b32 s31, s7, 1
    s_add_u32 s31, s31, 2
    s_and_b32 s31, s31, 3
    s_mul_i32 s32, s31, 14336
    s_add_u32 s32, s32, s35
    s_mul_i32 s31, s31, 7168
    s_add_u32 s31, s31, s49
    s_add_u32 m0, s31, 0
    s_nop 0
    buffer_load_dwordx4 v20, s[16:19], s32 offen lds
    s_add_u32 m0, s31, 1024
    s_nop 0
    buffer_load_dwordx4 v21, s[16:19], s32 offen lds
    s_add_u32 m0, s31, 2048
    s_nop 0
    buffer_load_dwordx4 v22, s[16:19], s32 offen lds
    s_add_u32 m0, s31, 3072
    s_nop 0
    buffer_load_dwordx4 v23, s[16:19], s32 offen lds
    s_add_u32 m0, s31, 4096
    s_nop 0
    buffer_load_dwordx4 v24, s[16:19], s32 offen lds
    s_add_u32 m0, s31, 5120
    s_nop 0
    buffer_load_dwordx4 v25, s[16:19], s32 offen lds
    s_add_u32 m0, s31, 6144
    s_nop 0
    buffer_load_dwordx4 v26, s[16:19], s32 offen lds
    s_lshr_b32 s31, s7, 1
    s_add_u32 s31, s31, 3
    s_and_b32 s31, s31, 3
    s_mul_i32 s32, s31, 14336
    s_add_u32 s32, s32, s35
    s_mul_i32 s31, s31, 7168
    s_add_u32 s31, s31, s49
    s_add_u32 m0, s31, 0
    s_nop 0
    buffer_load_dwordx4 v20, s[16:19], s32 offen lds
    s_add_u32 m0, s31, 1024
    s_nop 0
    buffer_load_dwordx4 v21, s[16:19], s32 offen lds
    s_add_u32 m0, s31, 2048
    s_nop 0
    buffer_load_dwordx4 v22, s[16:19], s32 offen lds
    s_add_u32 m0, s31, 3072
    s_nop 0
    buffer_load_dwordx4 v23, s[16:19], s32 offen lds
    s_add_u32 m0, s31, 4096
    s_nop 0
    buffer_load_dwordx4 v24, s[16:19], s32 offen lds
    s_add_u32 m0, s31, 5120
    s_nop 0
    buffer_load_dwordx4 v25, s[16:19], s32 offen lds
    s_add_u32 m0, s31, 6144
    s_nop 0
    buffer_load_dwordx4 v26, s[16:19], s32 offen lds
    v_xor_b32 v5, 64, v17
    s_xor_b32 m0, s54, 4096
    s_xor_b32 s33, s55, 65536
    buffer_load_dwordx4 v5, s[60:63], s33 offen lds
    v_xor_b32 v5, 96, v17
    s_xor_b32 m0, s54, 5120
    s_xor_b32 s33, s55, 81920
    buffer_load_dwordx4 v5, s[60:63], s33 offen lds
    v_xor_b32 v5, 64, v17
    s_xor_b32 m0, s54, 6144
    s_xor_b32 s33, s55, 98304
    buffer_load_dwordx4 v5, s[60:63], s33 offen lds
    v_xor_b32 v5, 96, v17
    s_xor_b32 m0, s54, 7168
    s_xor_b32 s33, s55, 114688
    buffer_load_dwordx4 v5, s[60:63], s33 offen lds
    s_waitcnt vmcnt(0)
    s_barrier
    v_xor_b32 v11, 0, v7
    ds_read_b128 v[104:107], v11 offset:0
    ds_read_b128 v[108:111], v11 offset:2048
    v_add_u32 v12, 0, v10
    ds_read_b64_tr_b16 v[168:169], v12 offset:0
    ds_read_b64_tr_b16 v[170:171], v12 offset:1792
    ds_read_b64_tr_b16 v[172:173], v12 offset:32
    ds_read_b64_tr_b16 v[174:175], v12 offset:1824
    ds_read_b64_tr_b16 v[176:177], v12 offset:64
    ds_read_b64_tr_b16 v[178:179], v12 offset:1856
    ds_read_b64_tr_b16 v[180:181], v12 offset:96
    ds_read_b64_tr_b16 v[182:183], v12 offset:1888
    ds_read_b64_tr_b16 v[184:185], v12 offset:128
    ds_read_b64_tr_b16 v[186:187], v12 offset:1920
    v_xor_b32 v11, 64, v7
    ds_read_b128 v[112:115], v11 offset:0
    ds_read_b128 v[116:119], v11 offset:2048
    ds_read_b64_tr_b16 v[188:189], v12 offset:160
    ds_read_b64_tr_b16 v[190:191], v12 offset:1952
    s_waitcnt lgkmcnt(12)
    v_mfma_f32_16x16x32_bf16 v[48:51], v[104:107], v[168:171], 0
    v_mfma_f32_16x16x32_bf16 v[52:55], v[108:111], v[168:171], 0
    ds_read_b64_tr_b16 v[192:193], v12 offset:192
    ds_read_b64_tr_b16 v[194:195], v12 offset:1984
    s_waitcnt lgkmcnt(12)
    v_mfma_f32_16x16x32_bf16 v[56:59], v[104:107], v[172:175], 0
    v_mfma_f32_16x16x32_bf16 v[60:63], v[108:111], v[172:175], 0
    v_add_u32 v12, 14336, v10
    ds_read_b64_tr_b16 v[196:197], v12 offset:0
    ds_read_b64_tr_b16 v[198:199], v12 offset:1792
    s_waitcnt lgkmcnt(12)
    v_mfma_f32_16x16x32_bf16 v[64:67], v[104:107], v[176:179], 0
    v_mfma_f32_16x16x32_bf16 v[68:71], v[108:111], v[176:179], 0
    ds_read_b64_tr_b16 v[168:169], v12 offset:32
    ds_read_b64_tr_b16 v[170:171], v12 offset:1824
    s_waitcnt lgkmcnt(12)
    v_mfma_f32_16x16x32_bf16 v[72:75], v[104:107], v[180:183], 0
    v_mfma_f32_16x16x32_bf16 v[76:79], v[108:111], v[180:183], 0
    ds_read_b64_tr_b16 v[172:173], v12 offset:64
    ds_read_b64_tr_b16 v[174:175], v12 offset:1856
    s_waitcnt lgkmcnt(12)
    v_mfma_f32_16x16x32_bf16 v[80:83], v[104:107], v[184:187], 0
    v_mfma_f32_16x16x32_bf16 v[84:87], v[108:111], v[184:187], 0
    ds_read_b64_tr_b16 v[176:177], v12 offset:96
    ds_read_b64_tr_b16 v[178:179], v12 offset:1888
    s_waitcnt lgkmcnt(10)
    v_mfma_f32_16x16x32_bf16 v[88:91], v[104:107], v[188:191], 0
    v_mfma_f32_16x16x32_bf16 v[92:95], v[108:111], v[188:191], 0
    ds_read_b64_tr_b16 v[180:181], v12 offset:128
    ds_read_b64_tr_b16 v[182:183], v12 offset:1920
    s_waitcnt lgkmcnt(10)
    v_mfma_f32_16x16x32_bf16 v[96:99], v[104:107], v[192:195], 0
    v_mfma_f32_16x16x32_bf16 v[100:103], v[108:111], v[192:195], 0
    v_xor_b32 v11, 128, v7
    ds_read_b128 v[104:107], v11 offset:0
    ds_read_b128 v[108:111], v11 offset:2048
    ds_read_b64_tr_b16 v[184:185], v12 offset:160
    ds_read_b64_tr_b16 v[186:187], v12 offset:1952
    s_waitcnt lgkmcnt(12)
    v_mfma_f32_16x16x32_bf16 v[48:51], v[112:115], v[196:199], v[48:51]
    v_mfma_f32_16x16x32_bf16 v[52:55], v[116:119], v[196:199], v[52:55]
    ds_read_b64_tr_b16 v[188:189], v12 offset:192
    ds_read_b64_tr_b16 v[190:191], v12 offset:1984
    s_waitcnt lgkmcnt(12)
    v_mfma_f32_16x16x32_bf16 v[56:59], v[112:115], v[168:171], v[56:59]
    v_mfma_f32_16x16x32_bf16 v[60:63], v[116:119], v[168:171], v[60:63]
    v_add_u32 v12, 28672, v10
    ds_read_b64_tr_b16 v[192:193], v12 offset:0
    ds_read_b64_tr_b16 v[194:195], v12 offset:1792
    s_waitcnt lgkmcnt(12)
    v_mfma_f32_16x16x32_bf16 v[64:67], v[112:115], v[172:175], v[64:67]
    v_mfma_f32_16x16x32_bf16 v[68:71], v[116:119], v[172:175], v[68:71]
    ds_read_b64_tr_b16 v[196:197], v12 offset:32
    ds_read_b64_tr_b16 v[198:199], v12 offset:1824
    s_waitcnt lgkmcnt(12)
    v_mfma_f32_16x16x32_bf16 v[72:75], v[112:115], v[176:179], v[72:75]
    v_mfma_f32_16x16x32_bf16 v[76:79], v[116:119], v[176:179], v[76:79]
    ds_read_b64_tr_b16 v[168:169], v12 offset:64
    ds_read_b64_tr_b16 v[170:171], v12 offset:1856
    s_waitcnt lgkmcnt(12)
    v_mfma_f32_16x16x32_bf16 v[80:83], v[112:115], v[180:183], v[80:83]
    v_mfma_f32_16x16x32_bf16 v[84:87], v[116:119], v[180:183], v[84:87]
    ds_read_b64_tr_b16 v[172:173], v12 offset:96
    ds_read_b64_tr_b16 v[174:175], v12 offset:1888
    s_waitcnt lgkmcnt(10)
    v_mfma_f32_16x16x32_bf16 v[88:91], v[112:115], v[184:187], v[88:91]
    v_mfma_f32_16x16x32_bf16 v[92:95], v[116:119], v[184:187], v[92:95]
    ds_read_b64_tr_b16 v[176:177], v12 offset:128
    ds_read_b64_tr_b16 v[178:179], v12 offset:1920
    s_waitcnt lgkmcnt(10)
    v_mfma_f32_16x16x32_bf16 v[96:99], v[112:115], v[188:191], v[96:99]
    v_mfma_f32_16x16x32_bf16 v[100:103], v[116:119], v[188:191], v[100:103]
    v_xor_b32 v11, 192, v7
    ds_read_b128 v[112:115], v11 offset:0
    ds_read_b128 v[116:119], v11 offset:2048
    ds_read_b64_tr_b16 v[180:181], v12 offset:160
    ds_read_b64_tr_b16 v[182:183], v12 offset:1952
    s_waitcnt lgkmcnt(12)
    v_mfma_f32_16x16x32_bf16 v[48:51], v[104:107], v[192:195], v[48:51]
    v_mfma_f32_16x16x32_bf16 v[52:55], v[108:111], v[192:195], v[52:55]
    ds_read_b64_tr_b16 v[184:185], v12 offset:192
    ds_read_b64_tr_b16 v[186:187], v12 offset:1984
    s_waitcnt lgkmcnt(12)
    v_mfma_f32_16x16x32_bf16 v[56:59], v[104:107], v[196:199], v[56:59]
    v_mfma_f32_16x16x32_bf16 v[60:63], v[108:111], v[196:199], v[60:63]
    v_add_u32 v12, 43008, v10
    ds_read_b64_tr_b16 v[188:189], v12 offset:0
    ds_read_b64_tr_b16 v[190:191], v12 offset:1792
    s_waitcnt lgkmcnt(12)
    v_mfma_f32_16x16x32_bf16 v[64:67], v[104:107], v[168:171], v[64:67]
    v_mfma_f32_16x16x32_bf16 v[68:71], v[108:111], v[168:171], v[68:71]
    ds_read_b64_tr_b16 v[192:193], v12 offset:32
    ds_read_b64_tr_b16 v[194:195], v12 offset:1824
    s_waitcnt lgkmcnt(12)
    v_mfma_f32_16x16x32_bf16 v[72:75], v[104:107], v[172:175], v[72:75]
    v_mfma_f32_16x16x32_bf16 v[76:79], v[108:111], v[172:175], v[76:79]
    ds_read_b64_tr_b16 v[196:197], v12 offset:64
    ds_read_b64_tr_b16 v[198:199], v12 offset:1856
    s_waitcnt lgkmcnt(12)
    v_mfma_f32_16x16x32_bf16 v[80:83], v[104:107], v[176:179], v[80:83]
    v_mfma_f32_16x16x32_bf16 v[84:87], v[108:111], v[176:179], v[84:87]
    ds_read_b64_tr_b16 v[168:169], v12 offset:96
    ds_read_b64_tr_b16 v[170:171], v12 offset:1888
    s_waitcnt lgkmcnt(10)
    v_mfma_f32_16x16x32_bf16 v[88:91], v[104:107], v[180:183], v[88:91]
    v_mfma_f32_16x16x32_bf16 v[92:95], v[108:111], v[180:183], v[92:95]
    ds_read_b64_tr_b16 v[172:173], v12 offset:128
    ds_read_b64_tr_b16 v[174:175], v12 offset:1920
    s_waitcnt lgkmcnt(10)
    v_mfma_f32_16x16x32_bf16 v[96:99], v[104:107], v[184:187], v[96:99]
    v_mfma_f32_16x16x32_bf16 v[100:103], v[108:111], v[184:187], v[100:103]
    v_xor_b32 v11, 256, v7
    ds_read_b128 v[104:107], v11 offset:0
    ds_read_b128 v[108:111], v11 offset:2048
    ds_read_b64_tr_b16 v[176:177], v12 offset:160
    ds_read_b64_tr_b16 v[178:179], v12 offset:1952
    s_waitcnt lgkmcnt(12)
    v_mfma_f32_16x16x32_bf16 v[48:51], v[112:115], v[188:191], v[48:51]
    v_mfma_f32_16x16x32_bf16 v[52:55], v[116:119], v[188:191], v[52:55]
    ds_read_b64_tr_b16 v[180:181], v12 offset:192
    ds_read_b64_tr_b16 v[182:183], v12 offset:1984
    s_waitcnt lgkmcnt(12)
    v_mfma_f32_16x16x32_bf16 v[56:59], v[112:115], v[192:195], v[56:59]
    v_mfma_f32_16x16x32_bf16 v[60:63], v[116:119], v[192:195], v[60:63]
    v_add_u32 v12, 57344, v10
    ds_read_b64_tr_b16 v[184:185], v12 offset:0
    ds_read_b64_tr_b16 v[186:187], v12 offset:1792
    s_waitcnt lgkmcnt(12)
    v_mfma_f32_16x16x32_bf16 v[64:67], v[112:115], v[196:199], v[64:67]
    v_mfma_f32_16x16x32_bf16 v[68:71], v[116:119], v[196:199], v[68:71]
    ds_read_b64_tr_b16 v[188:189], v12 offset:32
    ds_read_b64_tr_b16 v[190:191], v12 offset:1824
    s_waitcnt lgkmcnt(12)
    v_mfma_f32_16x16x32_bf16 v[72:75], v[112:115], v[168:171], v[72:75]
    v_mfma_f32_16x16x32_bf16 v[76:79], v[116:119], v[168:171], v[76:79]
    ds_read_b64_tr_b16 v[192:193], v12 offset:64
    ds_read_b64_tr_b16 v[194:195], v12 offset:1856
    s_waitcnt lgkmcnt(12)
    v_mfma_f32_16x16x32_bf16 v[80:83], v[112:115], v[172:175], v[80:83]
    v_mfma_f32_16x16x32_bf16 v[84:87], v[116:119], v[172:175], v[84:87]
    ds_read_b64_tr_b16 v[196:197], v12 offset:96
    ds_read_b64_tr_b16 v[198:199], v12 offset:1888
    s_waitcnt lgkmcnt(10)
    v_mfma_f32_16x16x32_bf16 v[88:91], v[112:115], v[176:179], v[88:91]
    v_mfma_f32_16x16x32_bf16 v[92:95], v[116:119], v[176:179], v[92:95]
    ds_read_b64_tr_b16 v[168:169], v12 offset:128
    ds_read_b64_tr_b16 v[170:171], v12 offset:1920
    s_waitcnt lgkmcnt(10)
    v_mfma_f32_16x16x32_bf16 v[96:99], v[112:115], v[180:183], v[96:99]
    v_mfma_f32_16x16x32_bf16 v[100:103], v[116:119], v[180:183], v[100:103]
    v_xor_b32 v11, 320, v7
    ds_read_b128 v[112:115], v11 offset:0
    ds_read_b128 v[116:119], v11 offset:2048
    ds_read_b64_tr_b16 v[172:173], v12 offset:160
    ds_read_b64_tr_b16 v[174:175], v12 offset:1952
    s_waitcnt lgkmcnt(12)
    v_mfma_f32_16x16x32_bf16 v[48:51], v[104:107], v[184:187], v[48:51]
    v_mfma_f32_16x16x32_bf16 v[52:55], v[108:111], v[184:187], v[52:55]
    ds_read_b64_tr_b16 v[176:177], v12 offset:192
    ds_read_b64_tr_b16 v[178:179], v12 offset:1984
    s_waitcnt lgkmcnt(12)
    v_mfma_f32_16x16x32_bf16 v[56:59], v[104:107], v[188:191], v[56:59]
    v_mfma_f32_16x16x32_bf16 v[60:63], v[108:111], v[188:191], v[60:63]
    v_add_u32 v12, 71680, v10
    ds_read_b64_tr_b16 v[180:181], v12 offset:0
    ds_read_b64_tr_b16 v[182:183], v12 offset:1792
    s_waitcnt lgkmcnt(12)
    v_mfma_f32_16x16x32_bf16 v[64:67], v[104:107], v[192:195], v[64:67]
    v_mfma_f32_16x16x32_bf16 v[68:71], v[108:111], v[192:195], v[68:71]
    ds_read_b64_tr_b16 v[184:185], v12 offset:32
    ds_read_b64_tr_b16 v[186:187], v12 offset:1824
    s_waitcnt lgkmcnt(12)
    v_mfma_f32_16x16x32_bf16 v[72:75], v[104:107], v[196:199], v[72:75]
    v_mfma_f32_16x16x32_bf16 v[76:79], v[108:111], v[196:199], v[76:79]
    ds_read_b64_tr_b16 v[188:189], v12 offset:64
    ds_read_b64_tr_b16 v[190:191], v12 offset:1856
    s_waitcnt lgkmcnt(12)
    v_mfma_f32_16x16x32_bf16 v[80:83], v[104:107], v[168:171], v[80:83]
    v_mfma_f32_16x16x32_bf16 v[84:87], v[108:111], v[168:171], v[84:87]
    ds_read_b64_tr_b16 v[192:193], v12 offset:96
    ds_read_b64_tr_b16 v[194:195], v12 offset:1888
    s_waitcnt lgkmcnt(10)
    v_mfma_f32_16x16x32_bf16 v[88:91], v[104:107], v[172:175], v[88:91]
    v_mfma_f32_16x16x32_bf16 v[92:95], v[108:111], v[172:175], v[92:95]
    ds_read_b64_tr_b16 v[196:197], v12 offset:128
    ds_read_b64_tr_b16 v[198:199], v12 offset:1920
    s_waitcnt lgkmcnt(10)
    v_mfma_f32_16x16x32_bf16 v[96:99], v[104:107], v[176:179], v[96:99]
    v_mfma_f32_16x16x32_bf16 v[100:103], v[108:111], v[176:179], v[100:103]
    v_xor_b32 v11, 384, v7
    ds_read_b128 v[104:107], v11 offset:0
    ds_read_b128 v[108:111], v11 offset:2048
    ds_read_b64_tr_b16 v[168:169], v12 offset:160
    ds_read_b64_tr_b16 v[170:171], v12 offset:1952
    s_waitcnt lgkmcnt(12)
    v_mfma_f32_16x16x32_bf16 v[48:51], v[112:115], v[180:183], v[48:51]
    v_mfma_f32_16x16x32_bf16 v[52:55], v[116:119], v[180:183], v[52:55]
    ds_read_b64_tr_b16 v[172:173], v12 offset:192
    ds_read_b64_tr_b16 v[174:175], v12 offset:1984
    s_waitcnt lgkmcnt(12)
    v_mfma_f32_16x16x32_bf16 v[56:59], v[112:115], v[184:187], v[56:59]
    v_mfma_f32_16x16x32_bf16 v[60:63], v[116:119], v[184:187], v[60:63]
    v_add_u32 v12, 86016, v10
    ds_read_b64_tr_b16 v[176:177], v12 offset:0
    ds_read_b64_tr_b16 v[178:179], v12 offset:1792
    s_waitcnt lgkmcnt(12)
    v_mfma_f32_16x16x32_bf16 v[64:67], v[112:115], v[188:191], v[64:67]
    v_mfma_f32_16x16x32_bf16 v[68:71], v[116:119], v[188:191], v[68:71]
    ds_read_b64_tr_b16 v[180:181], v12 offset:32
    ds_read_b64_tr_b16 v[182:183], v12 offset:1824
    s_waitcnt lgkmcnt(12)
    v_mfma_f32_16x16x32_bf16 v[72:75], v[112:115], v[192:195], v[72:75]
    v_mfma_f32_16x16x32_bf16 v[76:79], v[116:119], v[192:195], v[76:79]
    ds_read_b64_tr_b16 v[184:185], v12 offset:64
    ds_read_b64_tr_b16 v[186:187], v12 offset:1856
    s_waitcnt lgkmcnt(12)
    v_mfma_f32_16x16x32_bf16 v[80:83], v[112:115], v[196:199], v[80:83]
    v_mfma_f32_16x16x32_bf16 v[84:87], v[116:119], v[196:199], v[84:87]
    ds_read_b64_tr_b16 v[188:189], v12 offset:96
    ds_read_b64_tr_b16 v[190:191], v12 offset:1888
    s_waitcnt lgkmcnt(10)
    v_mfma_f32_16x16x32_bf16 v[88:91], v[112:115], v[168:171], v[88:91]
    v_mfma_f32_16x16x32_bf16 v[92:95], v[116:119], v[168:171], v[92:95]
    ds_read_b64_tr_b16 v[192:193], v12 offset:128
    ds_read_b64_tr_b16 v[194:195], v12 offset:1920
    s_waitcnt lgkmcnt(10)
    v_mfma_f32_16x16x32_bf16 v[96:99], v[112:115], v[172:175], v[96:99]
    v_mfma_f32_16x16x32_bf16 v[100:103], v[116:119], v[172:175], v[100:103]
    v_xor_b32 v11, 448, v7
    ds_read_b128 v[112:115], v11 offset:0
    ds_read_b128 v[116:119], v11 offset:2048
    ds_read_b64_tr_b16 v[196:197], v12 offset:160
    ds_read_b64_tr_b16 v[198:199], v12 offset:1952
    s_waitcnt lgkmcnt(12)
    v_mfma_f32_16x16x32_bf16 v[48:51], v[104:107], v[176:179], v[48:51]
    v_mfma_f32_16x16x32_bf16 v[52:55], v[108:111], v[176:179], v[52:55]
    ds_read_b64_tr_b16 v[168:169], v12 offset:192
    ds_read_b64_tr_b16 v[170:171], v12 offset:1984
    s_waitcnt lgkmcnt(12)
    v_mfma_f32_16x16x32_bf16 v[56:59], v[104:107], v[180:183], v[56:59]
    v_mfma_f32_16x16x32_bf16 v[60:63], v[108:111], v[180:183], v[60:63]
    v_add_u32 v12, 100352, v10
    ds_read_b64_tr_b16 v[172:173], v12 offset:0
    ds_read_b64_tr_b16 v[174:175], v12 offset:1792
    s_waitcnt lgkmcnt(12)
    v_mfma_f32_16x16x32_bf16 v[64:67], v[104:107], v[184:187], v[64:67]
    v_mfma_f32_16x16x32_bf16 v[68:71], v[108:111], v[184:187], v[68:71]
    ds_read_b64_tr_b16 v[176:177], v12 offset:32
    ds_read_b64_tr_b16 v[178:179], v12 offset:1824
    s_waitcnt lgkmcnt(12)
    v_mfma_f32_16x16x32_bf16 v[72:75], v[104:107], v[188:191], v[72:75]
    v_mfma_f32_16x16x32_bf16 v[76:79], v[108:111], v[188:191], v[76:79]
    ds_read_b64_tr_b16 v[180:181], v12 offset:64
    ds_read_b64_tr_b16 v[182:183], v12 offset:1856
    s_waitcnt lgkmcnt(12)
    v_mfma_f32_16x16x32_bf16 v[80:83], v[104:107], v[192:195], v[80:83]
    v_mfma_f32_16x16x32_bf16 v[84:87], v[108:111], v[192:195], v[84:87]
    ds_read_b64_tr_b16 v[184:185], v12 offset:96
    ds_read_b64_tr_b16 v[186:187], v12 offset:1888
    s_waitcnt lgkmcnt(10)
    v_mfma_f32_16x16x32_bf16 v[88:91], v[104:107], v[196:199], v[88:91]
    v_mfma_f32_16x16x32_bf16 v[92:95], v[108:111], v[196:199], v[92:95]
    ds_read_b64_tr_b16 v[188:189], v12 offset:128
    ds_read_b64_tr_b16 v[190:191], v12 offset:1920
    s_waitcnt lgkmcnt(10)
    v_mfma_f32_16x16x32_bf16 v[96:99], v[104:107], v[168:171], v[96:99]
    v_mfma_f32_16x16x32_bf16 v[100:103], v[108:111], v[168:171], v[100:103]
    ds_read_b64_tr_b16 v[192:193], v12 offset:160
    ds_read_b64_tr_b16 v[194:195], v12 offset:1952
    s_waitcnt lgkmcnt(10)
    v_mfma_f32_16x16x32_bf16 v[48:51], v[112:115], v[172:175], v[48:51]
    v_mfma_f32_16x16x32_bf16 v[52:55], v[116:119], v[172:175], v[52:55]
    ds_read_b64_tr_b16 v[196:197], v12 offset:192
    ds_read_b64_tr_b16 v[198:199], v12 offset:1984
    s_waitcnt lgkmcnt(10)
    v_mfma_f32_16x16x32_bf16 v[56:59], v[112:115], v[176:179], v[56:59]
    v_mfma_f32_16x16x32_bf16 v[60:63], v[116:119], v[176:179], v[60:63]
    s_waitcnt lgkmcnt(8)
    v_mfma_f32_16x16x32_bf16 v[64:67], v[112:115], v[180:183], v[64:67]
    v_mfma_f32_16x16x32_bf16 v[68:71], v[116:119], v[180:183], v[68:71]
    s_waitcnt lgkmcnt(6)
    v_mfma_f32_16x16x32_bf16 v[72:75], v[112:115], v[184:187], v[72:75]
    v_mfma_f32_16x16x32_bf16 v[76:79], v[116:119], v[184:187], v[76:79]
    s_waitcnt lgkmcnt(4)
    v_mfma_f32_16x16x32_bf16 v[80:83], v[112:115], v[188:191], v[80:83]
    v_mfma_f32_16x16x32_bf16 v[84:87], v[116:119], v[188:191], v[84:87]
    s_waitcnt lgkmcnt(2)
    v_mfma_f32_16x16x32_bf16 v[88:91], v[112:115], v[192:195], v[88:91]
    v_mfma_f32_16x16x32_bf16 v[92:95], v[116:119], v[192:195], v[92:95]
    s_waitcnt lgkmcnt(0)
    v_mfma_f32_16x16x32_bf16 v[96:99], v[112:115], v[196:199], v[96:99]
    v_mfma_f32_16x16x32_bf16 v[100:103], v[116:119], v[196:199], v[100:103]
    s_mul_i32 s30, s4, 28
    s_mul_i32 s31, s6, 14
    s_add_u32 s30, s30, s31
    s_mul_i32 s31, s52, 7
    s_add_u32 s30, s30, s31
    s_mul_i32 s30, s30, 14
    s_lshl_b32 s31, s7, 1
    s_add_u32 s30, s30, s31
    s_add_u32 s30, s30, s51
    s_lshl_b32 s30, s30, 10
    s_add_u32 s30, s30, 0x620000
    s_mov_b32 s31, 0x3db8aa3b
    v_cvt_pk_bf16_f32 v136, v48, v49
    v_cvt_pk_bf16_f32 v137, v50, v51
    v_cvt_pk_bf16_f32 v138, v52, v53
    v_cvt_pk_bf16_f32 v139, v54, v55
    buffer_store_dwordx4 v[136:139], v1, s[8:11], s30 offen sc1
    s_add_u32 s30, s30, 14336
    v_cvt_pk_bf16_f32 v140, v56, v57
    v_cvt_pk_bf16_f32 v141, v58, v59
    v_cvt_pk_bf16_f32 v142, v60, v61
    v_cvt_pk_bf16_f32 v143, v62, v63
    buffer_store_dwordx4 v[140:143], v1, s[8:11], s30 offen sc1
    s_add_u32 s30, s30, 14336
    v_cvt_pk_bf16_f32 v144, v64, v65
    v_cvt_pk_bf16_f32 v145, v66, v67
    v_cvt_pk_bf16_f32 v146, v68, v69
    v_cvt_pk_bf16_f32 v147, v70, v71
    buffer_store_dwordx4 v[144:147], v1, s[8:11], s30 offen sc1
    s_add_u32 s30, s30, 14336
    v_cvt_pk_bf16_f32 v148, v72, v73
    v_cvt_pk_bf16_f32 v149, v74, v75
    v_cvt_pk_bf16_f32 v150, v76, v77
    v_cvt_pk_bf16_f32 v151, v78, v79
    buffer_store_dwordx4 v[148:151], v1, s[8:11], s30 offen sc1
    s_add_u32 s30, s30, 14336
    v_cvt_pk_bf16_f32 v152, v80, v81
    v_cvt_pk_bf16_f32 v153, v82, v83
    v_cvt_pk_bf16_f32 v154, v84, v85
    v_cvt_pk_bf16_f32 v155, v86, v87
    buffer_store_dwordx4 v[152:155], v1, s[8:11], s30 offen sc1
    s_add_u32 s30, s30, 14336
    v_cvt_pk_bf16_f32 v156, v88, v89
    v_cvt_pk_bf16_f32 v157, v90, v91
    v_cvt_pk_bf16_f32 v158, v92, v93
    v_cvt_pk_bf16_f32 v159, v94, v95
    buffer_store_dwordx4 v[156:159], v1, s[8:11], s30 offen sc1
    s_add_u32 s30, s30, 14336
    v_cvt_pk_bf16_f32 v160, v96, v97
    v_cvt_pk_bf16_f32 v161, v98, v99
    v_cvt_pk_bf16_f32 v162, v100, v101
    v_cvt_pk_bf16_f32 v163, v102, v103
    buffer_store_dwordx4 v[160:163], v1, s[8:11], s30 offen sc1
    s_waitcnt vmcnt(0)
    s_barrier
    s_cmp_eq_u32 s3, 0
    s_cbranch_scc0 sf_20
    s_lshl_b32 s31, s53, 2
    s_add_u32 s31, s31, 0xf81000
    v_mov_b32 v244, 1
    buffer_store_dword v244, off, s[8:11], s31 sc1
sf_20:
fe_4:
    s_cmp_eq_u32 s5, 1
    s_cselect_b32 s31, 192, 0
    s_add_u32 s30, s53, s31
    s_cmp_ge_u32 s30, 224
    s_cselect_b32 s31, 224, 0
    s_sub_u32 s30, s30, s31
    s_cmp_ge_u32 s30, 190
    s_cbranch_scc1 quit
    s_cmp_lt_u32 s30, 56
    s_cbranch_scc1 role_d
    s_sub_u32 s30, s30, 56
    s_cmp_eq_u32 s3, 0
    s_cbranch_scc0 wo_22
    s_mov_b32 s14, 0
    s_mov_b32 s31, 0xf81380
ws_21:
    buffer_load_dword v244, off, s[8:11], s31 sc1
    s_waitcnt vmcnt(0)
    v_cmp_eq_u32 vcc, 0, v244
    s_cbranch_vccz wo_22
    s_sleep 16
    s_add_u32 s14, s14, 1
    s_cmp_lt_u32 s14, 400000
    s_cbranch_scc1 ws_21
    s_endpgm
wo_22:
    s_barrier
    s_cmp_lt_u32 s30, 64
    s_cbranch_scc1 role_xs
    s_sub_u32 s30, s30, 64
    s_cmp_lt_u32 s30, 28
    s_cbranch_scc1 role_f1
    s_sub_u32 s30, s30, 28
    s_cmp_lt_u32 s30, 42
    s_cbranch_scc1 role_fin
    s_sub_u32 s30, s30, 42
quit:
    s_endpgm
die0:
    s_cmp_eq_u32 s53, 31
    s_cbranch_scc0 nj_23
    v_mov_b32 v244, 0
    v_mov_b32 v245, 0
    v_mov_b32 v246, 0
    v_mov_b32 v247, 0
    v_lshlrev_b32 v243, 4, v0
    s_mov_b32 s31, 0xf80000
    s_cmp_eq_u32 s3, 0
    s_cbranch_scc0 jn_24
    buffer_store_dwordx4 v[244:247], v243, s[8:11], s31 offen offset:0 sc1
    buffer_store_dwordx4 v[244:247], v243, s[8:11], s31 offen offset:1024 sc1
    buffer_store_dwordx4 v[244:247], v243, s[8:11], s31 offen offset:2048 sc1
    buffer_store_dwordx4 v[244:247], v243, s[8:11], s31 offen offset:3072 sc1
    s_add_u32 s31, s31, 4096
    buffer_store_dwordx4 v[244:247], v243, s[8:11], s31 offen sc1
    buffer_store_dwordx4 v[244:247], v243, s[8:11], s31 offen offset:1024 sc1
    s_waitcnt vmcnt(0)
    s_sub_u32 s31, 2, s13
    v_mov_b32 v244, s31
    buffer_store_dword v244, off, s[44:47], 0 offset:252 sc1
jn_24:
nj_23:
    s_lshl_b32 s31, s3, 6
    v_add_u32 v240, s31, v0
    v_lshrrev_b32 v225, 3, v240
    v_and_b32 v224, 7, v0
    s_movk_i32 s31, 896
    v_mul_u32_u24 v226, s31, v224
    v_lshlrev_b32 v230, 4, v225
    v_add_u32 v226, v226, v230
    v_cmp_gt_u32 vcc, 192, v240
    v_mov_b32 v227, 0x7000000
    v_lshlrev_b32 v228, 4, v240
    v_cndmask_b32 v227, v227, v226, vcc
    s_mul_i32 s30, s2, 7168
    buffer_load_dwordx4 v[208:211], v226, s[20:23], s30 offen
    buffer_load_dwordx4 v[212:215], v227, s[20:23], s30 offen offset:512
    buffer_load_dwordx4 v[216:219], v230, s[24:27], 0 offen
    buffer_load_dwordx4 v[220:223], v230, s[24:27], 0 offen offset:512
    s_getreg_b32 s31, hwreg(HW_REG_XCC_ID)
    s_and_b32 s31, s31, 15
    s_add_u32 s31, s31, 1
    v_mov_b32 v3, s31
    s_lshl_b32 s32, s53, 2
    s_cmp_eq_u32 s3, 0
    s_cselect_b32 s32, s32, 256
    buffer_store_dword v3, off, s[44:47], s32 sc1
    v_cmp_gt_u32 vcc, 192, v240
    v_mov_b32 v229, 0x8000000
    v_add_u32 v232, 4096, v228
    v_cndmask_b32 v229, v229, v232, vcc
    v_mov_b32 v200, -1
    v_mov_b32 v201, -1
    v_mov_b32 v202, -1
    v_mov_b32 v203, -1
    v_mov_b32 v204, -1
    v_mov_b32 v205, -1
    v_mov_b32 v206, -1
    v_mov_b32 v207, -1
    s_mul_i32 s30, s53, 7168
    s_add_u32 s30, s30, 0xe20000
    s_add_u32 s31, s30, 229376
    buffer_store_dwordx4 v[200:203], v228, s[8:11], s31 offen sc1
    buffer_store_dwordx4 v[204:207], v229, s[8:11], s31 offen sc1
    s_add_u32 s31, s30, 688128
    buffer_store_dwordx4 v[200:203], v228, s[8:11], s31 offen sc1
    buffer_store_dwordx4 v[204:207], v229, s[8:11], s31 offen sc1
    s_add_u32 s31, s30, 917504
    s_cmp_lt_u32 s53, 10
    s_cselect_b32 s31, s31, 0x8000000
    buffer_store_dwordx4 v[200:203], v228, s[8:11], s31 offen sc1
    buffer_store_dwordx4 v[204:207], v229, s[8:11], s31 offen sc1
    s_cmp_eq_u32 s53, 10
    s_cbranch_scc0 fs_26
m0_25:
    v_bfe_u32 v232, v0, 2, 2
    v_and_b32 v233, 1, v0
    v_lshl_add_u32 v232, v232, 1, v233
    s_movk_i32 s31, 896
    v_mul_u32_u24 v232, s31, v232
    v_lshrrev_b32 v233, 4, v240
    v_lshl_add_u32 v232, v233, 5, v232
    v_bfe_u32 v233, v0, 1, 1
    v_lshl_add_u32 v232, v233, 2, v232
    buffer_load_dword v200, v232, s[40:43], 0 offen offset:0
    buffer_load_dword v201, v232, s[40:43], 0 offen offset:8
    buffer_load_dword v202, v232, s[40:43], 0 offen offset:16
    buffer_load_dword v203, v232, s[40:43], 0 offen offset:24
    buffer_load_dword v204, v232, s[40:43], 0 offen offset:512
    buffer_load_dword v205, v232, s[40:43], 0 offen offset:520
    buffer_load_dword v206, v232, s[40:43], 0 offen offset:528
    buffer_load_dword v207, v232, s[40:43], 0 offen offset:536
    s_waitcnt vmcnt(0)
    v_min_u32 v200, -2, v200
    v_min_u32 v201, -2, v201
    v_min_u32 v202, -2, v202
    v_min_u32 v203, -2, v203
    v_min_u32 v204, -2, v204
    v_min_u32 v205, -2, v205
    v_min_u32 v206, -2, v206
    v_min_u32 v207, -2, v207
fs_26:
    s_add_u32 s31, s30, 458752
    buffer_store_dwordx4 v[200:203], v228, s[8:11], s30 offen sc1
    buffer_store_dwordx4 v[204:207], v229, s[8:11], s30 offen sc1
    buffer_store_dwordx4 v[200:203], v228, s[8:11], s31 offen sc1
    buffer_store_dwordx4 v[204:207], v229, s[8:11], s31 offen sc1
    s_waitcnt vmcnt(0)
    s_lshr_b32 s32, s2, 1
    s_mul_i32 s32, s32, 14336
    s_and_b32 s30, s2, 1
    s_lshl_b32 s30, s30, 7
    s_add_u32 s32, s32, s30
    s_add_u32 s32, s32, 0xc40000
    s_add_u32 s30, s32, 8192
    v_cmp_gt_u32 vcc, 192, v240
    v_lshlrev_b32 v233, 8, v225
    v_lshl_add_u32 v233, v224, 4, v233
    v_mov_b32 v232, 0x8000000
    v_cndmask_b32 v232, v232, v233, vcc
    buffer_store_dwordx4 v[208:211], v233, s[8:11], s32 offen sc1
    buffer_store_dwordx4 v[212:215], v232, s[8:11], s30 offen sc1
    v_mov_b32 v234, 0
    v_dot2_f32_bf16 v234, v208, v216, v234
    v_dot2_f32_bf16 v234, v209, v217, v234
    v_dot2_f32_bf16 v234, v210, v218, v234
    v_dot2_f32_bf16 v234, v211, v219, v234
    v_dot2_f32_bf16 v234, v212, v220, v234
    v_dot2_f32_bf16 v234, v213, v221, v234
    v_dot2_f32_bf16 v234, v214, v222, v234
    v_dot2_f32_bf16 v234, v215, v223, v234
    v_lshlrev_b32 v232, 7, v224
    v_lshl_add_u32 v232, v225, 2, v232
    v_add_u32 v232, 147456, v232
    s_nop 0
    ds_write_b32 v232, v234
    s_waitcnt lgkmcnt(0)
    s_barrier
    s_cmp_eq_u32 s3, 3
    s_cbranch_scc0 ng_27
    v_lshlrev_b32 v232, 4, v0
    v_add_u32 v232, 147456, v232
    ds_read_b128 v[236:239], v232
    s_waitcnt lgkmcnt(0)
    v_add_f32 v233, v236, v237
    v_add_f32 v238, v238, v239
    v_add_f32 v233, v233, v238
    s_nop 1
    v_add_f32_dpp v233, v233, v233 quad_perm:[1,0,3,2] row_mask:0xf bank_mask:0xf
    s_nop 1
    v_add_f32_dpp v233, v233, v233 quad_perm:[2,3,0,1] row_mask:0xf bank_mask:0xf
    s_nop 1
    v_add_f32_dpp v233, v233, v233 row_half_mirror row_mask:0xf bank_mask:0xf
    v_mul_f32 v233, 0xbfb8aa3b, v233
    v_exp_f32 v233, v233
    s_nop 0
    v_add_f32 v233, 1.0, v233
    v_rcp_f32 v233, v233
    v_lshrrev_b32 v232, 3, v0
    v_lshlrev_b32 v232, 2, v232
    s_lshl_b32 s30, s2, 5
    s_add_u32 s30, s30, 0xe10000
    buffer_store_dword v233, v232, s[8:11], s30 offen sc1
ng_27:
    v_mov_b32 v243, 252
    s_cmp_eq_u32 s3, 0
    s_cbranch_scc0 wj_28
    s_mov_b32 s14, 0
ww_29:
    buffer_load_dword v244, v243, s[44:47], 0 offen sc1
    s_waitcnt vmcnt(0)
    v_cmp_eq_u32 vcc, 0, v244
    s_cbranch_vccz wk_30
    s_sleep 3
    s_add_u32 s14, s14, 1
    s_cmp_lt_u32 s14, 400000
    s_cbranch_scc1 ww_29
    s_endpgm
wk_30:
wj_28:
    s_add_u32 s34, s53, 224
    s_waitcnt vmcnt(0)
    s_barrier
    s_cmp_eq_u32 s3, 0
    s_cbranch_scc0 sf_31
    s_lshl_b32 s31, s34, 2
    s_add_u32 s31, s31, 0xf80800
    v_mov_b32 v244, 1
    buffer_store_dword v244, off, s[8:11], s31 sc1
sf_31:
    s_mov_b32 s30, s53
team:
    s_and_b32 s4, s30, 15
    s_lshr_b32 s5, s30, 4
    v_lshlrev_b32 v1, 4, v0
    s_lshl_b32 s33, s3, 1
    s_lshl_b32 s15, s33, 10
    s_add_u32 s33, s33, 1
    s_cmp_ge_u32 s33, 7
    s_cselect_b32 s32, 7, 0
    s_sub_u32 s33, s33, s32
    s_lshl_b32 s16, s33, 10
    s_add_u32 s33, s33, 1
    s_cmp_ge_u32 s33, 7
    s_cselect_b32 s32, 7, 0
    s_sub_u32 s33, s33, s32
    s_lshl_b32 s17, s33, 10
    s_add_u32 s33, s33, 1
    s_cmp_ge_u32 s33, 7
    s_cselect_b32 s32, 7, 0
    s_sub_u32 s33, s33, s32
    s_lshl_b32 s18, s33, 10
    s_add_u32 s33, s33, 1
    s_cmp_ge_u32 s33, 7
    s_cselect_b32 s32, 7, 0
    s_sub_u32 s33, s33, s32
    s_lshl_b32 s19, s33, 10
    s_add_u32 s33, s33, 1
    s_cmp_ge_u32 s33, 7
    s_cselect_b32 s32, 7, 0
    s_sub_u32 s33, s33, s32
    s_lshl_b32 s20, s33, 10
    s_add_u32 s33, s33, 1
    s_cmp_ge_u32 s33, 7
    s_cselect_b32 s32, 7, 0
    s_sub_u32 s33, s33, s32
    s_lshl_b32 s21, s33, 10
    s_cmp_ge_u32 s30, 30
    s_cbranch_scc1 export
    v_mov_b32 v4, 0
    v_mov_b32 v5, 0
    v_mov_b32 v6, 0
    v_mov_b32 v7, 0
    v_mov_b32 v8, 0
    v_mov_b32 v9, 0
    v_mov_b32 v10, 0
    v_mov_b32 v11, 0
    v_mov_b32 v12, 0
    v_mov_b32 v13, 0
    v_mov_b32 v14, 0
    v_mov_b32 v15, 0
    v_and_b32 v3, 2, v0
    v_cmp_eq_u32 s[58:59], 0, v3
    v_mov_b32 v2, 0xeeee
    v_mov_b32 v18, 0x4444
    v_cndmask_b32 v2, v2, v18, s[58:59]
    v_add_u32 v16, s15, v1
    v_add_u32 v17, s16, v1
    s_mov_b32 s49, 0xf80f80
    v_cmp_gt_u32 s[62:63], 56, v0
    v_min_u32 v20, 31, v0
    v_lshlrev_b32 v20, 2, v20
    s_mov_b32 s14, 0
xc_32:
    buffer_load_dword v3, v20, s[44:47], 0 offen sc1
    s_waitcnt vmcnt(0)
    v_cmp_eq_u32 vcc, 0, v3
    s_cbranch_vccz xo_33
    s_sleep 4
    s_add_u32 s14, s14, 1
    s_cmp_lt_u32 s14, 200000
    s_cbranch_scc1 xc_32
    s_endpgm
xo_33:
    v_readfirstlane_b32 s31, v3
    s_nop 1
    v_cmp_ne_u32 vcc, s31, v3
    s_nop 1
    s_cmp_lg_u64 vcc, 0
    s_cselect_b32 s51, 1, 0
    s_cmp_eq_u32 s5, 1
    s_cbranch_scc1 iv_34
    v_min_u32 v243, 13, v0
    s_movk_i32 s31, 4682
    v_mul_u32_u24 v242, s31, v243
    v_lshrrev_b32 v242, 16, v242
    v_mul_u32_u24 v242, 14, v242
    v_sub_u32 v241, v243, v242
    v_and_b32 v241, 2, v241
    v_cmp_eq_u32 vcc, 2, v241
    v_add_u32 v242, 2, v242
    s_nop 0
    v_cndmask_b32 v243, v242, v243, vcc
    v_lshlrev_b32 v243, 2, v243
    s_mul_i32 s31, s4, 56
    s_add_u32 s31, s31, 0xf80c00
    s_mov_b32 s14, 0
ww_36:
    buffer_load_dword v244, v243, s[8:11], s31 offen sc1
    s_waitcnt vmcnt(0)
    v_cmp_eq_u32 vcc, 0, v244
    s_cbranch_vccz wk_37
    s_sleep 3
    s_add_u32 s14, s14, 1
    s_cmp_lt_u32 s14, 400000
    s_cbranch_scc1 ww_36
    s_endpgm
wk_37:
    s_mul_i32 s30, s4, 28
    s_mul_i32 s32, s3, 7
    s_add_u32 s30, s30, s32
    s_mul_i32 s30, s30, 14336
    s_bitcmp1_b32 s15, 10
    s_cbranch_scc0 wl_38
    s_waitcnt vmcnt(40)
    s_lshl_b32 s33, s15, 1
    s_add_u32 s33, s33, s30
    s_add_u32 s32, s33, 0
    buffer_load_dwordx4 a[0:3], v1, s[8:11], s32 offen sc1
    buffer_load_dwordx4 a[4:7], v1, s[8:11], s32 offen offset:1024 sc1
    s_add_u32 s32, s33, 14336
    buffer_load_dwordx4 a[8:11], v1, s[8:11], s32 offen sc1
    buffer_load_dwordx4 a[12:15], v1, s[8:11], s32 offen offset:1024 sc1
    s_add_u32 s32, s33, 28672
    buffer_load_dwordx4 a[32:35], v1, s[8:11], s32 offen sc1
    buffer_load_dwordx4 a[36:39], v1, s[8:11], s32 offen offset:1024 sc1
    s_add_u32 s32, s33, 43008
    buffer_load_dwordx4 a[40:43], v1, s[8:11], s32 offen sc1
    buffer_load_dwordx4 a[44:47], v1, s[8:11], s32 offen offset:1024 sc1
    s_add_u32 s32, s33, 57344
    buffer_load_dwordx4 a[64:67], v1, s[8:11], s32 offen sc1
    buffer_load_dwordx4 a[68:71], v1, s[8:11], s32 offen offset:1024 sc1
    s_add_u32 s32, s33, 71680
    buffer_load_dwordx4 a[72:75], v1, s[8:11], s32 offen sc1
    buffer_load_dwordx4 a[76:79], v1, s[8:11], s32 offen offset:1024 sc1
    s_add_u32 s32, s33, 86016
    buffer_load_dwordx4 a[80:83], v1, s[8:11], s32 offen sc1
    buffer_load_dwordx4 a[84:87], v1, s[8:11], s32 offen offset:1024 sc1
wl_38:
    s_bitcmp1_b32 s16, 10
    s_cbranch_scc0 wl_39
    s_waitcnt vmcnt(40)
    s_lshl_b32 s33, s16, 1
    s_add_u32 s33, s33, s30
    s_add_u32 s32, s33, 0
    buffer_load_dwordx4 a[16:19], v1, s[8:11], s32 offen sc1
    buffer_load_dwordx4 a[20:23], v1, s[8:11], s32 offen offset:1024 sc1
    s_add_u32 s32, s33, 14336
    buffer_load_dwordx4 a[24:27], v1, s[8:11], s32 offen sc1
    buffer_load_dwordx4 a[28:31], v1, s[8:11], s32 offen offset:1024 sc1
    s_add_u32 s32, s33, 28672
    buffer_load_dwordx4 a[48:51], v1, s[8:11], s32 offen sc1
    buffer_load_dwordx4 a[52:55], v1, s[8:11], s32 offen offset:1024 sc1
    s_add_u32 s32, s33, 43008
    buffer_load_dwordx4 a[56:59], v1, s[8:11], s32 offen sc1
    buffer_load_dwordx4 a[60:63], v1, s[8:11], s32 offen offset:1024 sc1
    s_add_u32 s32, s33, 57344
    buffer_load_dwordx4 a[88:91], v1, s[8:11], s32 offen sc1
    buffer_load_dwordx4 a[92:95], v1, s[8:11], s32 offen offset:1024 sc1
    s_add_u32 s32, s33, 71680
    buffer_load_dwordx4 a[96:99], v1, s[8:11], s32 offen sc1
    buffer_load_dwordx4 a[100:103], v1, s[8:11], s32 offen offset:1024 sc1
    s_add_u32 s32, s33, 86016
    buffer_load_dwordx4 a[104:107], v1, s[8:11], s32 offen sc1
    buffer_load_dwordx4 a[108:111], v1, s[8:11], s32 offen offset:1024 sc1
wl_39:
    s_bitcmp1_b32 s17, 10
    s_cbranch_scc0 wl_40
    s_waitcnt vmcnt(40)
    s_lshl_b32 s33, s17, 1
    s_add_u32 s33, s33, s30
    s_add_u32 s32, s33, 0
    buffer_load_dwordx4 a[112:115], v1, s[8:11], s32 offen sc1
    buffer_load_dwordx4 a[116:119], v1, s[8:11], s32 offen offset:1024 sc1
    s_add_u32 s32, s33, 14336
    buffer_load_dwordx4 a[120:123], v1, s[8:11], s32 offen sc1
    buffer_load_dwordx4 a[124:127], v1, s[8:11], s32 offen offset:1024 sc1
    s_add_u32 s32, s33, 28672
    buffer_load_dwordx4 a[128:131], v1, s[8:11], s32 offen sc1
    buffer_load_dwordx4 a[132:135], v1, s[8:11], s32 offen offset:1024 sc1
    s_add_u32 s32, s33, 43008
    buffer_load_dwordx4 a[136:139], v1, s[8:11], s32 offen sc1
    buffer_load_dwordx4 a[140:143], v1, s[8:11], s32 offen offset:1024 sc1
    s_add_u32 s32, s33, 57344
    buffer_load_dwordx4 a[144:147], v1, s[8:11], s32 offen sc1
    buffer_load_dwordx4 a[148:151], v1, s[8:11], s32 offen offset:1024 sc1
    s_add_u32 s32, s33, 71680
    buffer_load_dwordx4 a[152:155], v1, s[8:11], s32 offen sc1
    buffer_load_dwordx4 a[156:159], v1, s[8:11], s32 offen offset:1024 sc1
    s_add_u32 s32, s33, 86016
    buffer_load_dwordx4 a[160:163], v1, s[8:11], s32 offen sc1
    buffer_load_dwordx4 a[164:167], v1, s[8:11], s32 offen offset:1024 sc1
wl_40:
    s_bitcmp1_b32 s18, 10
    s_cbranch_scc0 wl_41
    s_waitcnt vmcnt(40)
    s_lshl_b32 s33, s18, 1
    s_add_u32 s33, s33, s30
    s_add_u32 s32, s33, 0
    buffer_load_dwordx4 a[168:171], v1, s[8:11], s32 offen sc1
    buffer_load_dwordx4 a[172:175], v1, s[8:11], s32 offen offset:1024 sc1
    s_add_u32 s32, s33, 14336
    buffer_load_dwordx4 a[200:203], v1, s[8:11], s32 offen sc1
    buffer_load_dwordx4 a[204:207], v1, s[8:11], s32 offen offset:1024 sc1
    s_add_u32 s32, s33, 28672
    buffer_load_dwordx4 a[232:235], v1, s[8:11], s32 offen sc1
    buffer_load_dwordx4 a[236:239], v1, s[8:11], s32 offen offset:1024 sc1
    s_add_u32 s32, s33, 43008
    buffer_load_dwordx4 v[128:131], v1, s[8:11], s32 offen sc1
    buffer_load_dwordx4 v[132:135], v1, s[8:11], s32 offen offset:1024 sc1
    s_add_u32 s32, s33, 57344
    buffer_load_dwordx4 v[160:163], v1, s[8:11], s32 offen sc1
    buffer_load_dwordx4 v[164:167], v1, s[8:11], s32 offen offset:1024 sc1
    s_add_u32 s32, s33, 71680
    buffer_load_dwordx4 v[192:195], v1, s[8:11], s32 offen sc1
    buffer_load_dwordx4 v[196:199], v1, s[8:11], s32 offen offset:1024 sc1
    s_add_u32 s32, s33, 86016
    buffer_load_dwordx4 v[224:227], v1, s[8:11], s32 offen sc1
    buffer_load_dwordx4 v[228:231], v1, s[8:11], s32 offen offset:1024 sc1
wl_41:
    s_bitcmp1_b32 s19, 10
    s_cbranch_scc0 wl_42
    s_waitcnt vmcnt(40)
    s_lshl_b32 s33, s19, 1
    s_add_u32 s33, s33, s30
    s_add_u32 s32, s33, 0
    buffer_load_dwordx4 a[176:179], v1, s[8:11], s32 offen sc1
    buffer_load_dwordx4 a[180:183], v1, s[8:11], s32 offen offset:1024 sc1
    s_add_u32 s32, s33, 14336
    buffer_load_dwordx4 a[208:211], v1, s[8:11], s32 offen sc1
    buffer_load_dwordx4 a[212:215], v1, s[8:11], s32 offen offset:1024 sc1
    s_add_u32 s32, s33, 28672
    buffer_load_dwordx4 a[240:243], v1, s[8:11], s32 offen sc1
    buffer_load_dwordx4 a[244:247], v1, s[8:11], s32 offen offset:1024 sc1
    s_add_u32 s32, s33, 43008
    buffer_load_dwordx4 v[136:139], v1, s[8:11], s32 offen sc1
    buffer_load_dwordx4 v[140:143], v1, s[8:11], s32 offen offset:1024 sc1
    s_add_u32 s32, s33, 57344
    buffer_load_dwordx4 v[168:171], v1, s[8:11], s32 offen sc1
    buffer_load_dwordx4 v[172:175], v1, s[8:11], s32 offen offset:1024 sc1
    s_add_u32 s32, s33, 71680
    buffer_load_dwordx4 v[200:203], v1, s[8:11], s32 offen sc1
    buffer_load_dwordx4 v[204:207], v1, s[8:11], s32 offen offset:1024 sc1
    s_add_u32 s32, s33, 86016
    buffer_load_dwordx4 v[232:235], v1, s[8:11], s32 offen sc1
    buffer_load_dwordx4 v[236:239], v1, s[8:11], s32 offen offset:1024 sc1
wl_42:
    s_bitcmp1_b32 s20, 10
    s_cbranch_scc0 wl_43
    s_waitcnt vmcnt(40)
    s_lshl_b32 s33, s20, 1
    s_add_u32 s33, s33, s30
    s_add_u32 s32, s33, 0
    buffer_load_dwordx4 a[184:187], v1, s[8:11], s32 offen sc1
    buffer_load_dwordx4 a[188:191], v1, s[8:11], s32 offen offset:1024 sc1
    s_add_u32 s32, s33, 14336
    buffer_load_dwordx4 a[216:219], v1, s[8:11], s32 offen sc1
    buffer_load_dwordx4 a[220:223], v1, s[8:11], s32 offen offset:1024 sc1
    s_add_u32 s32, s33, 28672
    buffer_load_dwordx4 a[248:251], v1, s[8:11], s32 offen sc1
    buffer_load_dwordx4 a[252:255], v1, s[8:11], s32 offen offset:1024 sc1
    s_add_u32 s32, s33, 43008
    buffer_load_dwordx4 v[144:147], v1, s[8:11], s32 offen sc1
    buffer_load_dwordx4 v[148:151], v1, s[8:11], s32 offen offset:1024 sc1
    s_add_u32 s32, s33, 57344
    buffer_load_dwordx4 v[176:179], v1, s[8:11], s32 offen sc1
    buffer_load_dwordx4 v[180:183], v1, s[8:11], s32 offen offset:1024 sc1
    s_add_u32 s32, s33, 71680
    buffer_load_dwordx4 v[208:211], v1, s[8:11], s32 offen sc1
    buffer_load_dwordx4 v[212:215], v1, s[8:11], s32 offen offset:1024 sc1
    s_add_u32 s32, s33, 86016
    buffer_load_dwordx4 v[240:243], v1, s[8:11], s32 offen sc1
    buffer_load_dwordx4 v[244:247], v1, s[8:11], s32 offen offset:1024 sc1
wl_43:
    s_bitcmp1_b32 s21, 10
    s_cbranch_scc0 wl_44
    s_waitcnt vmcnt(40)
    s_lshl_b32 s33, s21, 1
    s_add_u32 s33, s33, s30
    s_add_u32 s32, s33, 0
    buffer_load_dwordx4 a[192:195], v1, s[8:11], s32 offen sc1
    buffer_load_dwordx4 a[196:199], v1, s[8:11], s32 offen offset:1024 sc1
    s_add_u32 s32, s33, 14336
    buffer_load_dwordx4 a[224:227], v1, s[8:11], s32 offen sc1
    buffer_load_dwordx4 a[228:231], v1, s[8:11], s32 offen offset:1024 sc1
    s_add_u32 s32, s33, 28672
    buffer_load_dwordx4 v[120:123], v1, s[8:11], s32 offen sc1
    buffer_load_dwordx4 v[124:127], v1, s[8:11], s32 offen offset:1024 sc1
    s_add_u32 s32, s33, 43008
    buffer_load_dwordx4 v[152:155], v1, s[8:11], s32 offen sc1
    buffer_load_dwordx4 v[156:159], v1, s[8:11], s32 offen offset:1024 sc1
    s_add_u32 s32, s33, 57344
    buffer_load_dwordx4 v[184:187], v1, s[8:11], s32 offen sc1
    buffer_load_dwordx4 v[188:191], v1, s[8:11], s32 offen offset:1024 sc1
    s_add_u32 s32, s33, 71680
    buffer_load_dwordx4 v[216:219], v1, s[8:11], s32 offen sc1
    buffer_load_dwordx4 v[220:223], v1, s[8:11], s32 offen offset:1024 sc1
    s_add_u32 s32, s33, 86016
    buffer_load_dwordx4 v[248:251], v1, s[8:11], s32 offen sc1
    buffer_load_dwordx4 v[252:255], v1, s[8:11], s32 offen offset:1024 sc1
wl_44:
    v_min_u32 v23, 13, v0
    v_lshlrev_b32 v23, 2, v23
    s_mul_i32 s31, s4, 56
    s_add_u32 s31, s31, 0xf80c00
    s_mov_b32 s32, 0xf80800
    s_mov_b32 s14, 0
wh_45:
    buffer_load_dwordx4 v[24:27], v1, s[8:11], s32 offen sc1
    buffer_load_dword v28, v23, s[8:11], s31 offen sc1
    s_waitcnt vmcnt(0)
    v_min3_u32 v24, v24, v25, v26
    v_min3_u32 v24, v24, v27, v28
    v_cmp_eq_u32 vcc, 0, v24
    s_cbranch_vccz wi_46
    s_sleep 3
    s_add_u32 s14, s14, 1
    s_cmp_lt_u32 s14, 400000
    s_cbranch_scc1 wh_45
    s_endpgm
wi_46:
    s_bitcmp1_b32 s15, 10
    s_cbranch_scc1 wl_47
    s_waitcnt vmcnt(40)
    s_lshl_b32 s33, s15, 1
    s_add_u32 s33, s33, s30
    s_add_u32 s32, s33, 0
    buffer_load_dwordx4 a[0:3], v1, s[8:11], s32 offen sc1
    buffer_load_dwordx4 a[4:7], v1, s[8:11], s32 offen offset:1024 sc1
    s_add_u32 s32, s33, 14336
    buffer_load_dwordx4 a[8:11], v1, s[8:11], s32 offen sc1
    buffer_load_dwordx4 a[12:15], v1, s[8:11], s32 offen offset:1024 sc1
    s_add_u32 s32, s33, 28672
    buffer_load_dwordx4 a[32:35], v1, s[8:11], s32 offen sc1
    buffer_load_dwordx4 a[36:39], v1, s[8:11], s32 offen offset:1024 sc1
    s_add_u32 s32, s33, 43008
    buffer_load_dwordx4 a[40:43], v1, s[8:11], s32 offen sc1
    buffer_load_dwordx4 a[44:47], v1, s[8:11], s32 offen offset:1024 sc1
    s_add_u32 s32, s33, 57344
    buffer_load_dwordx4 a[64:67], v1, s[8:11], s32 offen sc1
    buffer_load_dwordx4 a[68:71], v1, s[8:11], s32 offen offset:1024 sc1
    s_add_u32 s32, s33, 71680
    buffer_load_dwordx4 a[72:75], v1, s[8:11], s32 offen sc1
    buffer_load_dwordx4 a[76:79], v1, s[8:11], s32 offen offset:1024 sc1
    s_add_u32 s32, s33, 86016
    buffer_load_dwordx4 a[80:83], v1, s[8:11], s32 offen sc1
    buffer_load_dwordx4 a[84:87], v1, s[8:11], s32 offen offset:1024 sc1
wl_47:
    s_bitcmp1_b32 s16, 10
    s_cbranch_scc1 wl_48
    s_waitcnt vmcnt(40)
    s_lshl_b32 s33, s16, 1
    s_add_u32 s33, s33, s30
    s_add_u32 s32, s33, 0
    buffer_load_dwordx4 a[16:19], v1, s[8:11], s32 offen sc1
    buffer_load_dwordx4 a[20:23], v1, s[8:11], s32 offen offset:1024 sc1
    s_add_u32 s32, s33, 14336
    buffer_load_dwordx4 a[24:27], v1, s[8:11], s32 offen sc1
    buffer_load_dwordx4 a[28:31], v1, s[8:11], s32 offen offset:1024 sc1
    s_add_u32 s32, s33, 28672
    buffer_load_dwordx4 a[48:51], v1, s[8:11], s32 offen sc1
    buffer_load_dwordx4 a[52:55], v1, s[8:11], s32 offen offset:1024 sc1
    s_add_u32 s32, s33, 43008
    buffer_load_dwordx4 a[56:59], v1, s[8:11], s32 offen sc1
    buffer_load_dwordx4 a[60:63], v1, s[8:11], s32 offen offset:1024 sc1
    s_add_u32 s32, s33, 57344
    buffer_load_dwordx4 a[88:91], v1, s[8:11], s32 offen sc1
    buffer_load_dwordx4 a[92:95], v1, s[8:11], s32 offen offset:1024 sc1
    s_add_u32 s32, s33, 71680
    buffer_load_dwordx4 a[96:99], v1, s[8:11], s32 offen sc1
    buffer_load_dwordx4 a[100:103], v1, s[8:11], s32 offen offset:1024 sc1
    s_add_u32 s32, s33, 86016
    buffer_load_dwordx4 a[104:107], v1, s[8:11], s32 offen sc1
    buffer_load_dwordx4 a[108:111], v1, s[8:11], s32 offen offset:1024 sc1
wl_48:
    s_bitcmp1_b32 s17, 10
    s_cbranch_scc1 wl_49
    s_waitcnt vmcnt(40)
    s_lshl_b32 s33, s17, 1
    s_add_u32 s33, s33, s30
    s_add_u32 s32, s33, 0
    buffer_load_dwordx4 a[112:115], v1, s[8:11], s32 offen sc1
    buffer_load_dwordx4 a[116:119], v1, s[8:11], s32 offen offset:1024 sc1
    s_add_u32 s32, s33, 14336
    buffer_load_dwordx4 a[120:123], v1, s[8:11], s32 offen sc1
    buffer_load_dwordx4 a[124:127], v1, s[8:11], s32 offen offset:1024 sc1
    s_add_u32 s32, s33, 28672
    buffer_load_dwordx4 a[128:131], v1, s[8:11], s32 offen sc1
    buffer_load_dwordx4 a[132:135], v1, s[8:11], s32 offen offset:1024 sc1
    s_add_u32 s32, s33, 43008
    buffer_load_dwordx4 a[136:139], v1, s[8:11], s32 offen sc1
    buffer_load_dwordx4 a[140:143], v1, s[8:11], s32 offen offset:1024 sc1
    s_add_u32 s32, s33, 57344
    buffer_load_dwordx4 a[144:147], v1, s[8:11], s32 offen sc1
    buffer_load_dwordx4 a[148:151], v1, s[8:11], s32 offen offset:1024 sc1
    s_add_u32 s32, s33, 71680
    buffer_load_dwordx4 a[152:155], v1, s[8:11], s32 offen sc1
    buffer_load_dwordx4 a[156:159], v1, s[8:11], s32 offen offset:1024 sc1
    s_add_u32 s32, s33, 86016
    buffer_load_dwordx4 a[160:163], v1, s[8:11], s32 offen sc1
    buffer_load_dwordx4 a[164:167], v1, s[8:11], s32 offen offset:1024 sc1
wl_49:
    s_bitcmp1_b32 s18, 10
    s_cbranch_scc1 wl_50
    s_waitcnt vmcnt(40)
    s_lshl_b32 s33, s18, 1
    s_add_u32 s33, s33, s30
    s_add_u32 s32, s33, 0
    buffer_load_dwordx4 a[168:171], v1, s[8:11], s32 offen sc1
    buffer_load_dwordx4 a[172:175], v1, s[8:11], s32 offen offset:1024 sc1
    s_add_u32 s32, s33, 14336
    buffer_load_dwordx4 a[200:203], v1, s[8:11], s32 offen sc1
    buffer_load_dwordx4 a[204:207], v1, s[8:11], s32 offen offset:1024 sc1
    s_add_u32 s32, s33, 28672
    buffer_load_dwordx4 a[232:235], v1, s[8:11], s32 offen sc1
    buffer_load_dwordx4 a[236:239], v1, s[8:11], s32 offen offset:1024 sc1
    s_add_u32 s32, s33, 43008
    buffer_load_dwordx4 v[128:131], v1, s[8:11], s32 offen sc1
    buffer_load_dwordx4 v[132:135], v1, s[8:11], s32 offen offset:1024 sc1
    s_add_u32 s32, s33, 57344
    buffer_load_dwordx4 v[160:163], v1, s[8:11], s32 offen sc1
    buffer_load_dwordx4 v[164:167], v1, s[8:11], s32 offen offset:1024 sc1
    s_add_u32 s32, s33, 71680
    buffer_load_dwordx4 v[192:195], v1, s[8:11], s32 offen sc1
    buffer_load_dwordx4 v[196:199], v1, s[8:11], s32 offen offset:1024 sc1
    s_add_u32 s32, s33, 86016
    buffer_load_dwordx4 v[224:227], v1, s[8:11], s32 offen sc1
    buffer_load_dwordx4 v[228:231], v1, s[8:11], s32 offen offset:1024 sc1
wl_50:
    s_bitcmp1_b32 s19, 10
    s_cbranch_scc1 wl_51
    s_waitcnt vmcnt(40)
    s_lshl_b32 s33, s19, 1
    s_add_u32 s33, s33, s30
    s_add_u32 s32, s33, 0
    buffer_load_dwordx4 a[176:179], v1, s[8:11], s32 offen sc1
    buffer_load_dwordx4 a[180:183], v1, s[8:11], s32 offen offset:1024 sc1
    s_add_u32 s32, s33, 14336
    buffer_load_dwordx4 a[208:211], v1, s[8:11], s32 offen sc1
    buffer_load_dwordx4 a[212:215], v1, s[8:11], s32 offen offset:1024 sc1
    s_add_u32 s32, s33, 28672
    buffer_load_dwordx4 a[240:243], v1, s[8:11], s32 offen sc1
    buffer_load_dwordx4 a[244:247], v1, s[8:11], s32 offen offset:1024 sc1
    s_add_u32 s32, s33, 43008
    buffer_load_dwordx4 v[136:139], v1, s[8:11], s32 offen sc1
    buffer_load_dwordx4 v[140:143], v1, s[8:11], s32 offen offset:1024 sc1
    s_add_u32 s32, s33, 57344
    buffer_load_dwordx4 v[168:171], v1, s[8:11], s32 offen sc1
    buffer_load_dwordx4 v[172:175], v1, s[8:11], s32 offen offset:1024 sc1
    s_add_u32 s32, s33, 71680
    buffer_load_dwordx4 v[200:203], v1, s[8:11], s32 offen sc1
    buffer_load_dwordx4 v[204:207], v1, s[8:11], s32 offen offset:1024 sc1
    s_add_u32 s32, s33, 86016
    buffer_load_dwordx4 v[232:235], v1, s[8:11], s32 offen sc1
    buffer_load_dwordx4 v[236:239], v1, s[8:11], s32 offen offset:1024 sc1
wl_51:
    s_bitcmp1_b32 s20, 10
    s_cbranch_scc1 wl_52
    s_waitcnt vmcnt(40)
    s_lshl_b32 s33, s20, 1
    s_add_u32 s33, s33, s30
    s_add_u32 s32, s33, 0
    buffer_load_dwordx4 a[184:187], v1, s[8:11], s32 offen sc1
    buffer_load_dwordx4 a[188:191], v1, s[8:11], s32 offen offset:1024 sc1
    s_add_u32 s32, s33, 14336
    buffer_load_dwordx4 a[216:219], v1, s[8:11], s32 offen sc1
    buffer_load_dwordx4 a[220:223], v1, s[8:11], s32 offen offset:1024 sc1
    s_add_u32 s32, s33, 28672
    buffer_load_dwordx4 a[248:251], v1, s[8:11], s32 offen sc1
    buffer_load_dwordx4 a[252:255], v1, s[8:11], s32 offen offset:1024 sc1
    s_add_u32 s32, s33, 43008
    buffer_load_dwordx4 v[144:147], v1, s[8:11], s32 offen sc1
    buffer_load_dwordx4 v[148:151], v1, s[8:11], s32 offen offset:1024 sc1
    s_add_u32 s32, s33, 57344
    buffer_load_dwordx4 v[176:179], v1, s[8:11], s32 offen sc1
    buffer_load_dwordx4 v[180:183], v1, s[8:11], s32 offen offset:1024 sc1
    s_add_u32 s32, s33, 71680
    buffer_load_dwordx4 v[208:211], v1, s[8:11], s32 offen sc1
    buffer_load_dwordx4 v[212:215], v1, s[8:11], s32 offen offset:1024 sc1
    s_add_u32 s32, s33, 86016
    buffer_load_dwordx4 v[240:243], v1, s[8:11], s32 offen sc1
    buffer_load_dwordx4 v[244:247], v1, s[8:11], s32 offen offset:1024 sc1
wl_52:
    s_bitcmp1_b32 s21, 10
    s_cbranch_scc1 wl_53
    s_waitcnt vmcnt(40)
    s_lshl_b32 s33, s21, 1
    s_add_u32 s33, s33, s30
    s_add_u32 s32, s33, 0
    buffer_load_dwordx4 a[192:195], v1, s[8:11], s32 offen sc1
    buffer_load_dwordx4 a[196:199], v1, s[8:11], s32 offen offset:1024 sc1
    s_add_u32 s32, s33, 14336
    buffer_load_dwordx4 a[224:227], v1, s[8:11], s32 offen sc1
    buffer_load_dwordx4 a[228:231], v1, s[8:11], s32 offen offset:1024 sc1
    s_add_u32 s32, s33, 28672
    buffer_load_dwordx4 v[120:123], v1, s[8:11], s32 offen sc1
    buffer_load_dwordx4 v[124:127], v1, s[8:11], s32 offen offset:1024 sc1
    s_add_u32 s32, s33, 43008
    buffer_load_dwordx4 v[152:155], v1, s[8:11], s32 offen sc1
    buffer_load_dwordx4 v[156:159], v1, s[8:11], s32 offen offset:1024 sc1
    s_add_u32 s32, s33, 57344
    buffer_load_dwordx4 v[184:187], v1, s[8:11], s32 offen sc1
    buffer_load_dwordx4 v[188:191], v1, s[8:11], s32 offen offset:1024 sc1
    s_add_u32 s32, s33, 71680
    buffer_load_dwordx4 v[216:219], v1, s[8:11], s32 offen sc1
    buffer_load_dwordx4 v[220:223], v1, s[8:11], s32 offen offset:1024 sc1
    s_add_u32 s32, s33, 86016
    buffer_load_dwordx4 v[248:251], v1, s[8:11], s32 offen sc1
    buffer_load_dwordx4 v[252:255], v1, s[8:11], s32 offen offset:1024 sc1
wl_53:
    v_and_b32 v3, 8, v0
    v_cmp_eq_u32 vcc, 0, v3
    s_nop 1
    v_cndmask_b32 v14, 0, 1.0, vcc
    v_bfe_u32 v3, v0, 2, 2
    v_lshlrev_b32 v4, 6, v3
    v_bfe_u32 v3, v0, 0, 1
    v_lshl_add_u32 v4, v3, 5, v4
    v_bfe_u32 v3, v0, 4, 2
    v_lshl_add_u32 v4, v3, 3, v4
    v_bfe_u32 v3, v0, 1, 1
    v_lshl_add_u32 v4, v3, 2, v4
    v_bfe_u32 v3, v0, 4, 2
    v_lshlrev_b32 v5, 8, v3
    v_bfe_u32 v3, v0, 0, 4
    v_lshl_add_u32 v5, v3, 3, v5
    s_lshl_b32 s30, s3, 11
    s_add_u32 s30, s30, 7680
    v_add_u32 v4, s30, v4
    v_add_u32 v5, s30, v5
    s_mul_i32 s30, s3, 3584
    s_add_u32 s30, s30, 28160
    v_bfe_u32 v3, v0, 4, 2
    v_lshlrev_b32 v6, 8, v3
    v_bfe_u32 v3, v0, 0, 2
    v_lshl_add_u32 v6, v3, 6, v6
    v_bfe_u32 v3, v0, 2, 1
    v_lshl_add_u32 v6, v3, 5, v6
    v_bfe_u32 v3, v0, 3, 1
    s_movk_i32 s31, 14352
    v_mul_u32_u24 v3, s31, v3
    v_add3_u32 v6, v6, v3, s30
    v_bfe_u32 v3, v0, 5, 1
    v_lshlrev_b32 v8, 8, v3
    v_bfe_u32 v3, v0, 0, 2
    v_lshl_add_u32 v8, v3, 6, v8
    v_bfe_u32 v3, v0, 2, 1
    v_lshl_add_u32 v8, v3, 4, v8
    v_bfe_u32 v3, v0, 4, 1
    v_lshl_add_u32 v8, v3, 3, v8
    s_mul_i32 s30, s3, 1792
    v_add_u32 v8, s30, v8
    v_add_u32 v9, 1024, v8
    s_max_u32 s31, s3, 1
    s_lshl_b32 s31, s31, 10
    s_add_u32 s31, s31, 14848
    v_add_u32 v10, s31, v1
    s_lshl_b32 s31, s3, 12
    s_add_u32 s31, s31, 15872
    v_add_u32 v11, s31, v1
    s_lshl_b32 s30, s4, 9
    s_lshl_b32 s31, s3, 6
    s_add_u32 s30, s30, s31
    v_bfe_u32 v3, v0, 4, 2
    v_lshlrev_b32 v12, 7, v3
    v_bfe_u32 v3, v0, 0, 4
    v_lshl_add_u32 v12, v3, 2, v12
    v_add_u32 v12, s30, v12
    v_bfe_u32 v3, v0, 4, 2
    v_lshlrev_b32 v13, 5, v3
    v_bfe_u32 v3, v0, 0, 2
    v_lshl_add_u32 v13, v3, 2, v13
    s_lshl_b32 s30, s4, 7
    s_lshl_b32 s31, s3, 4
    s_add_u32 s30, s30, s31
    s_add_u32 s30, s30, 8192
    v_add_u32 v13, s30, v13
    v_and_b32 v3, 12, v0
    v_cmp_eq_u32 vcc, 0, v3
    v_mov_b32 v18, 0x8000000
    s_nop 0
    v_cndmask_b32 v13, v18, v13, vcc
    v_mov_b32 v3, 0
    v_lshlrev_b32 v18, 2, v0
    ds_write_b32 v18, v3 offset:7168
    ds_write_b32 v18, v3 offset:9472
    ds_write_b32 v18, v3 offset:11520
    ds_write_b32 v18, v3 offset:13568
    ds_write_b32 v18, v3 offset:15616
    ds_write_b32 v18, v3 offset:42368
    ds_write_b32 v18, v3 offset:56848
    ds_write_b32 v18, v3 offset:57104
    s_waitcnt lgkmcnt(0)
    s_barrier
    s_mov_b32 s50, 0
    s_mul_i32 s30, s3, 7168
    s_add_u32 s34, s30, 0xc40000
    s_add_u32 s36, s30, 28160
    s_lshr_b32 s31, s3, 1
    s_lshl_b32 s31, s31, 4
    s_add_u32 s36, s36, s31
    s_mov_b32 m0, s36
    s_add_u32 s30, s34, 4096
    buffer_load_dwordx4 v1, s[8:11], s34 offen offset:0 sc1 lds
    buffer_load_dwordx4 v1, s[8:11], s34 offen offset:1024 sc1 lds
    buffer_load_dwordx4 v1, s[8:11], s34 offen offset:2048 sc1 lds
    buffer_load_dwordx4 v1, s[8:11], s34 offen offset:3072 sc1 lds
    s_add_u32 m0, s36, 4096
    s_add_u32 s34, s34, 28672
    buffer_load_dwordx4 v1, s[8:11], s30 offen offset:0 sc1 lds
    buffer_load_dwordx4 v1, s[8:11], s30 offen offset:1024 sc1 lds
    buffer_load_dwordx4 v1, s[8:11], s30 offen offset:2048 sc1 lds
    s_lshl_b32 s31, s4, 10
    s_add_u32 s27, s31, 0xe27000
    s_cmp_lt_u32 s4, 10
    s_cselect_b32 s27, s27, 0x8000000
    s_cmp_eq_u32 s3, 2
    s_cselect_b32 s27, s27, 0x8000000
    s_lshl_b32 s31, s4, 2
    s_add_u32 s31, s31, s3
    s_mul_i32 s35, s31, 7168
    s_add_u32 s35, s35, 0x21e0000
    v_lshl_add_u32 v7, v0, 7, s35
    s_lshl_b32 s31, s31, 9
    s_add_u32 s31, s31, 0xc4e000
    v_and_b32 v3, 3, v0
    v_lshl_add_u32 v3, v3, 7, s31
    v_cndmask_b32 v7, v3, v7, s[62:63]
    s_mov_b32 s38, 0x8000000
    buffer_load_dword v18, off, s[8:11], s49 sc1
    s_waitcnt vmcnt(0)
    v_readfirstlane_b32 s29, v18
    s_cmp_le_u32 s29, 2
    s_cselect_b32 s38, 0x8000000, 0
    s_branch ij_35
iv_34:
    s_lshl_b32 s34, s3, 2
    v_min_u32 v243, 55, v0
    s_movk_i32 s31, 4682
    v_mul_u32_u24 v242, s31, v243
    v_lshrrev_b32 v242, 16, v242
    v_mul_u32_u24 v242, 14, v242
    v_sub_u32 v241, v243, v242
    v_and_b32 v241, 2, v241
    v_cmp_eq_u32 vcc, 0, v241
    v_add_u32 v242, 0, v242
    s_nop 0
    v_cndmask_b32 v243, v242, v243, vcc
    v_lshlrev_b32 v243, 2, v243
    s_mul_i32 s31, s34, 56
    s_add_u32 s31, s31, 0xf81000
    s_mov_b32 s14, 0
ww_54:
    buffer_load_dword v244, v243, s[8:11], s31 offen sc1
    s_waitcnt vmcnt(0)
    v_cmp_eq_u32 vcc, 0, v244
    s_cbranch_vccz wk_55
    s_sleep 3
    s_add_u32 s14, s14, 1
    s_cmp_lt_u32 s14, 400000
    s_cbranch_scc1 ww_54
    s_endpgm
wk_55:
    s_mul_i32 s30, s3, 4*28
    s_lshl_b32 s32, s4, 1
    s_add_u32 s30, s30, s32
    s_mul_i32 s30, s30, 14336
    s_add_u32 s30, s30, 0x620000
    s_mul_i32 s29, s3, 14336
    s_add_u32 s29, s29, 98304
    s_bitcmp1_b32 s15, 10
    s_cbranch_scc1 wl_56
    s_waitcnt vmcnt(40)
    s_lshl_b32 s33, s15, 1
    s_add_u32 s33, s33, s30
    s_add_u32 s32, s33, 0
    buffer_load_dwordx4 a[0:3], v1, s[8:11], s32 offen sc1
    buffer_load_dwordx4 a[4:7], v1, s[8:11], s32 offen offset:1024 sc1
    s_add_u32 s32, s33, 401408
    buffer_load_dwordx4 a[8:11], v1, s[8:11], s32 offen sc1
    buffer_load_dwordx4 a[12:15], v1, s[8:11], s32 offen offset:1024 sc1
    s_add_u32 s32, s33, 802816
    buffer_load_dwordx4 a[16:19], v1, s[8:11], s32 offen sc1
    buffer_load_dwordx4 a[20:23], v1, s[8:11], s32 offen offset:1024 sc1
    s_add_u32 s32, s33, 1204224
    buffer_load_dwordx4 a[24:27], v1, s[8:11], s32 offen sc1
    buffer_load_dwordx4 a[28:31], v1, s[8:11], s32 offen offset:1024 sc1
    s_add_u32 s32, s33, 14336
    buffer_load_dwordx4 a[32:35], v1, s[8:11], s32 offen sc1
    buffer_load_dwordx4 a[36:39], v1, s[8:11], s32 offen offset:1024 sc1
    s_add_u32 s32, s33, 415744
    buffer_load_dwordx4 a[40:43], v1, s[8:11], s32 offen sc1
    buffer_load_dwordx4 a[44:47], v1, s[8:11], s32 offen offset:1024 sc1
    s_add_u32 s32, s33, 817152
    buffer_load_dwordx4 a[48:51], v1, s[8:11], s32 offen sc1
    buffer_load_dwordx4 a[52:55], v1, s[8:11], s32 offen offset:1024 sc1
    s_add_u32 s32, s33, 1218560
    buffer_load_dwordx4 a[56:59], v1, s[8:11], s32 offen sc1
    buffer_load_dwordx4 a[60:63], v1, s[8:11], s32 offen offset:1024 sc1
wl_56:
    s_bitcmp1_b32 s16, 10
    s_cbranch_scc1 wl_57
    s_waitcnt vmcnt(40)
    s_lshl_b32 s33, s16, 1
    s_add_u32 s33, s33, s30
    s_add_u32 s32, s33, 0
    buffer_load_dwordx4 a[64:67], v1, s[8:11], s32 offen sc1
    buffer_load_dwordx4 a[68:71], v1, s[8:11], s32 offen offset:1024 sc1
    s_add_u32 s32, s33, 401408
    buffer_load_dwordx4 a[72:75], v1, s[8:11], s32 offen sc1
    buffer_load_dwordx4 a[76:79], v1, s[8:11], s32 offen offset:1024 sc1
    s_add_u32 s32, s33, 802816
    buffer_load_dwordx4 a[80:83], v1, s[8:11], s32 offen sc1
    buffer_load_dwordx4 a[84:87], v1, s[8:11], s32 offen offset:1024 sc1
    s_add_u32 s32, s33, 1204224
    buffer_load_dwordx4 a[88:91], v1, s[8:11], s32 offen sc1
    buffer_load_dwordx4 a[92:95], v1, s[8:11], s32 offen offset:1024 sc1
    s_add_u32 s32, s33, 14336
    buffer_load_dwordx4 a[96:99], v1, s[8:11], s32 offen sc1
    buffer_load_dwordx4 a[100:103], v1, s[8:11], s32 offen offset:1024 sc1
    s_add_u32 s32, s33, 415744
    buffer_load_dwordx4 a[104:107], v1, s[8:11], s32 offen sc1
    buffer_load_dwordx4 a[108:111], v1, s[8:11], s32 offen offset:1024 sc1
    s_add_u32 s32, s33, 817152
    buffer_load_dwordx4 a[112:115], v1, s[8:11], s32 offen sc1
    buffer_load_dwordx4 a[116:119], v1, s[8:11], s32 offen offset:1024 sc1
    s_add_u32 s32, s33, 1218560
    buffer_load_dwordx4 a[120:123], v1, s[8:11], s32 offen sc1
    buffer_load_dwordx4 a[124:127], v1, s[8:11], s32 offen offset:1024 sc1
wl_57:
    s_bitcmp1_b32 s17, 10
    s_cbranch_scc1 wl_58
    s_waitcnt vmcnt(40)
    s_lshl_b32 s33, s17, 1
    s_add_u32 s33, s33, s30
    s_add_u32 s32, s33, 0
    buffer_load_dwordx4 a[128:131], v1, s[8:11], s32 offen sc1
    buffer_load_dwordx4 a[132:135], v1, s[8:11], s32 offen offset:1024 sc1
    s_add_u32 s32, s33, 401408
    buffer_load_dwordx4 a[136:139], v1, s[8:11], s32 offen sc1
    buffer_load_dwordx4 a[140:143], v1, s[8:11], s32 offen offset:1024 sc1
    s_add_u32 s32, s33, 802816
    buffer_load_dwordx4 a[144:147], v1, s[8:11], s32 offen sc1
    buffer_load_dwordx4 a[148:151], v1, s[8:11], s32 offen offset:1024 sc1
    s_add_u32 s32, s33, 1204224
    buffer_load_dwordx4 a[152:155], v1, s[8:11], s32 offen sc1
    buffer_load_dwordx4 a[156:159], v1, s[8:11], s32 offen offset:1024 sc1
    s_add_u32 s32, s33, 14336
    buffer_load_dwordx4 a[160:163], v1, s[8:11], s32 offen sc1
    buffer_load_dwordx4 a[164:167], v1, s[8:11], s32 offen offset:1024 sc1
    s_add_u32 s32, s33, 415744
    buffer_load_dwordx4 a[168:171], v1, s[8:11], s32 offen sc1
    buffer_load_dwordx4 a[172:175], v1, s[8:11], s32 offen offset:1024 sc1
    s_add_u32 s32, s33, 817152
    buffer_load_dwordx4 a[176:179], v1, s[8:11], s32 offen sc1
    buffer_load_dwordx4 a[180:183], v1, s[8:11], s32 offen offset:1024 sc1
    s_add_u32 s32, s33, 1218560
    buffer_load_dwordx4 a[184:187], v1, s[8:11], s32 offen sc1
    buffer_load_dwordx4 a[188:191], v1, s[8:11], s32 offen offset:1024 sc1
wl_58:
    s_bitcmp1_b32 s18, 10
    s_cbranch_scc1 wl_59
    s_waitcnt vmcnt(40)
    s_lshl_b32 s33, s18, 1
    s_add_u32 s33, s33, s30
    s_add_u32 s32, s33, 0
    buffer_load_dwordx4 a[192:195], v1, s[8:11], s32 offen sc1
    buffer_load_dwordx4 a[196:199], v1, s[8:11], s32 offen offset:1024 sc1
    s_add_u32 s32, s33, 401408
    buffer_load_dwordx4 a[200:203], v1, s[8:11], s32 offen sc1
    buffer_load_dwordx4 a[204:207], v1, s[8:11], s32 offen offset:1024 sc1
    s_add_u32 s32, s33, 802816
    buffer_load_dwordx4 a[208:211], v1, s[8:11], s32 offen sc1
    buffer_load_dwordx4 a[212:215], v1, s[8:11], s32 offen offset:1024 sc1
    s_add_u32 s32, s33, 1204224
    buffer_load_dwordx4 a[216:219], v1, s[8:11], s32 offen sc1
    buffer_load_dwordx4 a[220:223], v1, s[8:11], s32 offen offset:1024 sc1
    s_add_u32 s32, s33, 14336
    buffer_load_dwordx4 a[224:227], v1, s[8:11], s32 offen sc1
    buffer_load_dwordx4 a[228:231], v1, s[8:11], s32 offen offset:1024 sc1
    s_add_u32 s32, s33, 415744
    buffer_load_dwordx4 a[232:235], v1, s[8:11], s32 offen sc1
    buffer_load_dwordx4 a[236:239], v1, s[8:11], s32 offen offset:1024 sc1
    s_add_u32 s32, s33, 817152
    buffer_load_dwordx4 a[240:243], v1, s[8:11], s32 offen sc1
    buffer_load_dwordx4 a[244:247], v1, s[8:11], s32 offen offset:1024 sc1
    s_add_u32 s32, s33, 1218560
    buffer_load_dwordx4 a[248:251], v1, s[8:11], s32 offen sc1
    buffer_load_dwordx4 a[252:255], v1, s[8:11], s32 offen offset:1024 sc1
wl_59:
    s_bitcmp1_b32 s19, 10
    s_cbranch_scc1 wl_60
    s_waitcnt vmcnt(40)
    s_lshl_b32 s33, s19, 1
    s_add_u32 s33, s33, s30
    s_add_u32 s32, s33, 0
    buffer_load_dwordx4 v[120:123], v1, s[8:11], s32 offen sc1
    buffer_load_dwordx4 v[124:127], v1, s[8:11], s32 offen offset:1024 sc1
    s_add_u32 s32, s33, 401408
    buffer_load_dwordx4 v[144:147], v1, s[8:11], s32 offen sc1
    buffer_load_dwordx4 v[148:151], v1, s[8:11], s32 offen offset:1024 sc1
    s_add_u32 s32, s33, 802816
    buffer_load_dwordx4 v[168:171], v1, s[8:11], s32 offen sc1
    buffer_load_dwordx4 v[172:175], v1, s[8:11], s32 offen offset:1024 sc1
    s_add_u32 s32, s33, 1204224
    buffer_load_dwordx4 v[192:195], v1, s[8:11], s32 offen sc1
    buffer_load_dwordx4 v[196:199], v1, s[8:11], s32 offen offset:1024 sc1
    s_add_u32 s32, s33, 14336
    buffer_load_dwordx4 v[216:219], v1, s[8:11], s32 offen sc1
    buffer_load_dwordx4 v[220:223], v1, s[8:11], s32 offen offset:1024 sc1
    s_add_u32 s32, s33, 415744
    buffer_load_dwordx4 v[240:243], v1, s[8:11], s32 offen sc1
    buffer_load_dwordx4 v[244:247], v1, s[8:11], s32 offen offset:1024 sc1
    s_add_u32 s32, s33, 817152
    s_add_u32 m0, s29, 2048
    s_nop 0
    buffer_load_dwordx4 v1, s[8:11], s32 offen sc1 lds
    buffer_load_dwordx4 v1, s[8:11], s32 offen offset:1024 sc1 lds
    s_add_u32 s32, s33, 1218560
    s_add_u32 m0, s29, 8192
    s_nop 0
    buffer_load_dwordx4 v1, s[8:11], s32 offen sc1 lds
    buffer_load_dwordx4 v1, s[8:11], s32 offen offset:1024 sc1 lds
wl_60:
    s_bitcmp1_b32 s20, 10
    s_cbranch_scc1 wl_61
    s_waitcnt vmcnt(40)
    s_lshl_b32 s33, s20, 1
    s_add_u32 s33, s33, s30
    s_add_u32 s32, s33, 0
    buffer_load_dwordx4 v[128:131], v1, s[8:11], s32 offen sc1
    buffer_load_dwordx4 v[132:135], v1, s[8:11], s32 offen offset:1024 sc1
    s_add_u32 s32, s33, 401408
    buffer_load_dwordx4 v[152:155], v1, s[8:11], s32 offen sc1
    buffer_load_dwordx4 v[156:159], v1, s[8:11], s32 offen offset:1024 sc1
    s_add_u32 s32, s33, 802816
    buffer_load_dwordx4 v[176:179], v1, s[8:11], s32 offen sc1
    buffer_load_dwordx4 v[180:183], v1, s[8:11], s32 offen offset:1024 sc1
    s_add_u32 s32, s33, 1204224
    buffer_load_dwordx4 v[200:203], v1, s[8:11], s32 offen sc1
    buffer_load_dwordx4 v[204:207], v1, s[8:11], s32 offen offset:1024 sc1
    s_add_u32 s32, s33, 14336
    buffer_load_dwordx4 v[224:227], v1, s[8:11], s32 offen sc1
    buffer_load_dwordx4 v[228:231], v1, s[8:11], s32 offen offset:1024 sc1
    s_add_u32 s32, s33, 415744
    buffer_load_dwordx4 v[248:251], v1, s[8:11], s32 offen sc1
    buffer_load_dwordx4 v[252:255], v1, s[8:11], s32 offen offset:1024 sc1
    s_add_u32 s32, s33, 817152
    s_add_u32 m0, s29, 4096
    s_nop 0
    buffer_load_dwordx4 v1, s[8:11], s32 offen sc1 lds
    buffer_load_dwordx4 v1, s[8:11], s32 offen offset:1024 sc1 lds
    s_add_u32 s32, s33, 1218560
    s_add_u32 m0, s29, 10240
    s_nop 0
    buffer_load_dwordx4 v1, s[8:11], s32 offen sc1 lds
    buffer_load_dwordx4 v1, s[8:11], s32 offen offset:1024 sc1 lds
wl_61:
    s_bitcmp1_b32 s21, 10
    s_cbranch_scc1 wl_62
    s_waitcnt vmcnt(40)
    s_lshl_b32 s33, s21, 1
    s_add_u32 s33, s33, s30
    s_add_u32 s32, s33, 0
    buffer_load_dwordx4 v[136:139], v1, s[8:11], s32 offen sc1
    buffer_load_dwordx4 v[140:143], v1, s[8:11], s32 offen offset:1024 sc1
    s_add_u32 s32, s33, 401408
    buffer_load_dwordx4 v[160:163], v1, s[8:11], s32 offen sc1
    buffer_load_dwordx4 v[164:167], v1, s[8:11], s32 offen offset:1024 sc1
    s_add_u32 s32, s33, 802816
    buffer_load_dwordx4 v[184:187], v1, s[8:11], s32 offen sc1
    buffer_load_dwordx4 v[188:191], v1, s[8:11], s32 offen offset:1024 sc1
    s_add_u32 s32, s33, 1204224
    buffer_load_dwordx4 v[208:211], v1, s[8:11], s32 offen sc1
    buffer_load_dwordx4 v[212:215], v1, s[8:11], s32 offen offset:1024 sc1
    s_add_u32 s32, s33, 14336
    buffer_load_dwordx4 v[232:235], v1, s[8:11], s32 offen sc1
    buffer_load_dwordx4 v[236:239], v1, s[8:11], s32 offen offset:1024 sc1
    s_add_u32 s32, s33, 415744
    s_add_u32 m0, s29, 0
    s_nop 0
    buffer_load_dwordx4 v1, s[8:11], s32 offen sc1 lds
    buffer_load_dwordx4 v1, s[8:11], s32 offen offset:1024 sc1 lds
    s_add_u32 s32, s33, 817152
    s_add_u32 m0, s29, 6144
    s_nop 0
    buffer_load_dwordx4 v1, s[8:11], s32 offen sc1 lds
    buffer_load_dwordx4 v1, s[8:11], s32 offen offset:1024 sc1 lds
    s_add_u32 s32, s33, 1218560
    s_add_u32 m0, s29, 12288
    s_nop 0
    buffer_load_dwordx4 v1, s[8:11], s32 offen sc1 lds
    buffer_load_dwordx4 v1, s[8:11], s32 offen offset:1024 sc1 lds
wl_62:
    v_min_u32 v23, 55, v0
    v_lshlrev_b32 v23, 2, v23
    s_mul_i32 s31, s34, 56
    s_add_u32 s31, s31, 0xf81000
    s_mov_b32 s32, 0xf80800
    s_mov_b32 s14, 0
wh_63:
    buffer_load_dwordx4 v[24:27], v1, s[8:11], s32 offen sc1
    buffer_load_dword v28, v23, s[8:11], s31 offen sc1
    s_waitcnt vmcnt(0)
    v_min3_u32 v24, v24, v25, v26
    v_min3_u32 v24, v24, v27, v28
    v_cmp_eq_u32 vcc, 0, v24
    s_cbranch_vccz wi_64
    s_sleep 3
    s_add_u32 s14, s14, 1
    s_cmp_lt_u32 s14, 400000
    s_cbranch_scc1 wh_63
    s_endpgm
wi_64:
    s_bitcmp1_b32 s15, 10
    s_cbranch_scc0 wl_65
    s_waitcnt vmcnt(8)
    buffer_load_dword v24, off, s[8:11], s49 sc1
    s_lshl_b32 s33, s15, 1
    s_add_u32 s33, s33, s30
    s_add_u32 s32, s33, 0
    buffer_load_dwordx4 a[0:3], v1, s[8:11], s32 offen sc1
    buffer_load_dwordx4 a[4:7], v1, s[8:11], s32 offen offset:1024 sc1
    s_add_u32 s32, s33, 401408
    buffer_load_dwordx4 a[8:11], v1, s[8:11], s32 offen sc1
    buffer_load_dwordx4 a[12:15], v1, s[8:11], s32 offen offset:1024 sc1
    s_add_u32 s32, s33, 802816
    buffer_load_dwordx4 a[16:19], v1, s[8:11], s32 offen sc1
    buffer_load_dwordx4 a[20:23], v1, s[8:11], s32 offen offset:1024 sc1
    s_add_u32 s32, s33, 1204224
    buffer_load_dwordx4 a[24:27], v1, s[8:11], s32 offen sc1
    buffer_load_dwordx4 a[28:31], v1, s[8:11], s32 offen offset:1024 sc1
    s_add_u32 s32, s33, 14336
    buffer_load_dwordx4 a[32:35], v1, s[8:11], s32 offen sc1
    buffer_load_dwordx4 a[36:39], v1, s[8:11], s32 offen offset:1024 sc1
    s_add_u32 s32, s33, 415744
    buffer_load_dwordx4 a[40:43], v1, s[8:11], s32 offen sc1
    buffer_load_dwordx4 a[44:47], v1, s[8:11], s32 offen offset:1024 sc1
    s_add_u32 s32, s33, 817152
    buffer_load_dwordx4 a[48:51], v1, s[8:11], s32 offen sc1
    buffer_load_dwordx4 a[52:55], v1, s[8:11], s32 offen offset:1024 sc1
    s_add_u32 s32, s33, 1218560
    buffer_load_dwordx4 a[56:59], v1, s[8:11], s32 offen sc1
    buffer_load_dwordx4 a[60:63], v1, s[8:11], s32 offen offset:1024 sc1
wl_65:
    s_bitcmp1_b32 s16, 10
    s_cbranch_scc0 wl_66
    s_waitcnt vmcnt(8)
    buffer_load_dword v24, off, s[8:11], s49 sc1
    s_lshl_b32 s33, s16, 1
    s_add_u32 s33, s33, s30
    s_add_u32 s32, s33, 0
    buffer_load_dwordx4 a[64:67], v1, s[8:11], s32 offen sc1
    buffer_load_dwordx4 a[68:71], v1, s[8:11], s32 offen offset:1024 sc1
    s_add_u32 s32, s33, 401408
    buffer_load_dwordx4 a[72:75], v1, s[8:11], s32 offen sc1
    buffer_load_dwordx4 a[76:79], v1, s[8:11], s32 offen offset:1024 sc1
    s_add_u32 s32, s33, 802816
    buffer_load_dwordx4 a[80:83], v1, s[8:11], s32 offen sc1
    buffer_load_dwordx4 a[84:87], v1, s[8:11], s32 offen offset:1024 sc1
    s_add_u32 s32, s33, 1204224
    buffer_load_dwordx4 a[88:91], v1, s[8:11], s32 offen sc1
    buffer_load_dwordx4 a[92:95], v1, s[8:11], s32 offen offset:1024 sc1
    s_add_u32 s32, s33, 14336
    buffer_load_dwordx4 a[96:99], v1, s[8:11], s32 offen sc1
    buffer_load_dwordx4 a[100:103], v1, s[8:11], s32 offen offset:1024 sc1
    s_add_u32 s32, s33, 415744
    buffer_load_dwordx4 a[104:107], v1, s[8:11], s32 offen sc1
    buffer_load_dwordx4 a[108:111], v1, s[8:11], s32 offen offset:1024 sc1
    s_add_u32 s32, s33, 817152
    buffer_load_dwordx4 a[112:115], v1, s[8:11], s32 offen sc1
    buffer_load_dwordx4 a[116:119], v1, s[8:11], s32 offen offset:1024 sc1
    s_add_u32 s32, s33, 1218560
    buffer_load_dwordx4 a[120:123], v1, s[8:11], s32 offen sc1
    buffer_load_dwordx4 a[124:127], v1, s[8:11], s32 offen offset:1024 sc1
wl_66:
    s_bitcmp1_b32 s17, 10
    s_cbranch_scc0 wl_67
    s_waitcnt vmcnt(8)
    buffer_load_dword v24, off, s[8:11], s49 sc1
    s_lshl_b32 s33, s17, 1
    s_add_u32 s33, s33, s30
    s_add_u32 s32, s33, 0
    buffer_load_dwordx4 a[128:131], v1, s[8:11], s32 offen sc1
    buffer_load_dwordx4 a[132:135], v1, s[8:11], s32 offen offset:1024 sc1
    s_add_u32 s32, s33, 401408
    buffer_load_dwordx4 a[136:139], v1, s[8:11], s32 offen sc1
    buffer_load_dwordx4 a[140:143], v1, s[8:11], s32 offen offset:1024 sc1
    s_add_u32 s32, s33, 802816
    buffer_load_dwordx4 a[144:147], v1, s[8:11], s32 offen sc1
    buffer_load_dwordx4 a[148:151], v1, s[8:11], s32 offen offset:1024 sc1
    s_add_u32 s32, s33, 1204224
    buffer_load_dwordx4 a[152:155], v1, s[8:11], s32 offen sc1
    buffer_load_dwordx4 a[156:159], v1, s[8:11], s32 offen offset:1024 sc1
    s_add_u32 s32, s33, 14336
    buffer_load_dwordx4 a[160:163], v1, s[8:11], s32 offen sc1
    buffer_load_dwordx4 a[164:167], v1, s[8:11], s32 offen offset:1024 sc1
    s_add_u32 s32, s33, 415744
    buffer_load_dwordx4 a[168:171], v1, s[8:11], s32 offen sc1
    buffer_load_dwordx4 a[172:175], v1, s[8:11], s32 offen offset:1024 sc1
    s_add_u32 s32, s33, 817152
    buffer_load_dwordx4 a[176:179], v1, s[8:11], s32 offen sc1
    buffer_load_dwordx4 a[180:183], v1, s[8:11], s32 offen offset:1024 sc1
    s_add_u32 s32, s33, 1218560
    buffer_load_dwordx4 a[184:187], v1, s[8:11], s32 offen sc1
    buffer_load_dwordx4 a[188:191], v1, s[8:11], s32 offen offset:1024 sc1
wl_67:
    s_bitcmp1_b32 s18, 10
    s_cbranch_scc0 wl_68
    s_waitcnt vmcnt(8)
    buffer_load_dword v24, off, s[8:11], s49 sc1
    s_lshl_b32 s33, s18, 1
    s_add_u32 s33, s33, s30
    s_add_u32 s32, s33, 0
    buffer_load_dwordx4 a[192:195], v1, s[8:11], s32 offen sc1
    buffer_load_dwordx4 a[196:199], v1, s[8:11], s32 offen offset:1024 sc1
    s_add_u32 s32, s33, 401408
    buffer_load_dwordx4 a[200:203], v1, s[8:11], s32 offen sc1
    buffer_load_dwordx4 a[204:207], v1, s[8:11], s32 offen offset:1024 sc1
    s_add_u32 s32, s33, 802816
    buffer_load_dwordx4 a[208:211], v1, s[8:11], s32 offen sc1
    buffer_load_dwordx4 a[212:215], v1, s[8:11], s32 offen offset:1024 sc1
    s_add_u32 s32, s33, 1204224
    buffer_load_dwordx4 a[216:219], v1, s[8:11], s32 offen sc1
    buffer_load_dwordx4 a[220:223], v1, s[8:11], s32 offen offset:1024 sc1
    s_add_u32 s32, s33, 14336
    buffer_load_dwordx4 a[224:227], v1, s[8:11], s32 offen sc1
    buffer_load_dwordx4 a[228:231], v1, s[8:11], s32 offen offset:1024 sc1
    s_add_u32 s32, s33, 415744
    buffer_load_dwordx4 a[232:235], v1, s[8:11], s32 offen sc1
    buffer_load_dwordx4 a[236:239], v1, s[8:11], s32 offen offset:1024 sc1
    s_add_u32 s32, s33, 817152
    buffer_load_dwordx4 a[240:243], v1, s[8:11], s32 offen sc1
    buffer_load_dwordx4 a[244:247], v1, s[8:11], s32 offen offset:1024 sc1
    s_add_u32 s32, s33, 1218560
    buffer_load_dwordx4 a[248:251], v1, s[8:11], s32 offen sc1
    buffer_load_dwordx4 a[252:255], v1, s[8:11], s32 offen offset:1024 sc1
wl_68:
    s_bitcmp1_b32 s19, 10
    s_cbranch_scc0 wl_69
    s_waitcnt vmcnt(8)
    buffer_load_dword v24, off, s[8:11], s49 sc1
    s_lshl_b32 s33, s19, 1
    s_add_u32 s33, s33, s30
    s_add_u32 s32, s33, 0
    buffer_load_dwordx4 v[120:123], v1, s[8:11], s32 offen sc1
    buffer_load_dwordx4 v[124:127], v1, s[8:11], s32 offen offset:1024 sc1
    s_add_u32 s32, s33, 401408
    buffer_load_dwordx4 v[144:147], v1, s[8:11], s32 offen sc1
    buffer_load_dwordx4 v[148:151], v1, s[8:11], s32 offen offset:1024 sc1
    s_add_u32 s32, s33, 802816
    buffer_load_dwordx4 v[168:171], v1, s[8:11], s32 offen sc1
    buffer_load_dwordx4 v[172:175], v1, s[8:11], s32 offen offset:1024 sc1
    s_add_u32 s32, s33, 1204224
    buffer_load_dwordx4 v[192:195], v1, s[8:11], s32 offen sc1
    buffer_load_dwordx4 v[196:199], v1, s[8:11], s32 offen offset:1024 sc1
    s_add_u32 s32, s33, 14336
    buffer_load_dwordx4 v[216:219], v1, s[8:11], s32 offen sc1
    buffer_load_dwordx4 v[220:223], v1, s[8:11], s32 offen offset:1024 sc1
    s_add_u32 s32, s33, 415744
    buffer_load_dwordx4 v[240:243], v1, s[8:11], s32 offen sc1
    buffer_load_dwordx4 v[244:247], v1, s[8:11], s32 offen offset:1024 sc1
    s_add_u32 s32, s33, 817152
    s_add_u32 m0, s29, 2048
    s_nop 0
    buffer_load_dwordx4 v1, s[8:11], s32 offen sc1 lds
    buffer_load_dwordx4 v1, s[8:11], s32 offen offset:1024 sc1 lds
    s_add_u32 s32, s33, 1218560
    s_add_u32 m0, s29, 8192
    s_nop 0
    buffer_load_dwordx4 v1, s[8:11], s32 offen sc1 lds
    buffer_load_dwordx4 v1, s[8:11], s32 offen offset:1024 sc1 lds
wl_69:
    s_bitcmp1_b32 s20, 10
    s_cbranch_scc0 wl_70
    s_waitcnt vmcnt(8)
    buffer_load_dword v24, off, s[8:11], s49 sc1
    s_lshl_b32 s33, s20, 1
    s_add_u32 s33, s33, s30
    s_add_u32 s32, s33, 0
    buffer_load_dwordx4 v[128:131], v1, s[8:11], s32 offen sc1
    buffer_load_dwordx4 v[132:135], v1, s[8:11], s32 offen offset:1024 sc1
    s_add_u32 s32, s33, 401408
    buffer_load_dwordx4 v[152:155], v1, s[8:11], s32 offen sc1
    buffer_load_dwordx4 v[156:159], v1, s[8:11], s32 offen offset:1024 sc1
    s_add_u32 s32, s33, 802816
    buffer_load_dwordx4 v[176:179], v1, s[8:11], s32 offen sc1
    buffer_load_dwordx4 v[180:183], v1, s[8:11], s32 offen offset:1024 sc1
    s_add_u32 s32, s33, 1204224
    buffer_load_dwordx4 v[200:203], v1, s[8:11], s32 offen sc1
    buffer_load_dwordx4 v[204:207], v1, s[8:11], s32 offen offset:1024 sc1
    s_add_u32 s32, s33, 14336
    buffer_load_dwordx4 v[224:227], v1, s[8:11], s32 offen sc1
    buffer_load_dwordx4 v[228:231], v1, s[8:11], s32 offen offset:1024 sc1
    s_add_u32 s32, s33, 415744
    buffer_load_dwordx4 v[248:251], v1, s[8:11], s32 offen sc1
    buffer_load_dwordx4 v[252:255], v1, s[8:11], s32 offen offset:1024 sc1
    s_add_u32 s32, s33, 817152
    s_add_u32 m0, s29, 4096
    s_nop 0
    buffer_load_dwordx4 v1, s[8:11], s32 offen sc1 lds
    buffer_load_dwordx4 v1, s[8:11], s32 offen offset:1024 sc1 lds
    s_add_u32 s32, s33, 1218560
    s_add_u32 m0, s29, 10240
    s_nop 0
    buffer_load_dwordx4 v1, s[8:11], s32 offen sc1 lds
    buffer_load_dwordx4 v1, s[8:11], s32 offen offset:1024 sc1 lds
wl_70:
    s_bitcmp1_b32 s21, 10
    s_cbranch_scc0 wl_71
    s_waitcnt vmcnt(8)
    buffer_load_dword v24, off, s[8:11], s49 sc1
    s_lshl_b32 s33, s21, 1
    s_add_u32 s33, s33, s30
    s_add_u32 s32, s33, 0
    buffer_load_dwordx4 v[136:139], v1, s[8:11], s32 offen sc1
    buffer_load_dwordx4 v[140:143], v1, s[8:11], s32 offen offset:1024 sc1
    s_add_u32 s32, s33, 401408
    buffer_load_dwordx4 v[160:163], v1, s[8:11], s32 offen sc1
    buffer_load_dwordx4 v[164:167], v1, s[8:11], s32 offen offset:1024 sc1
    s_add_u32 s32, s33, 802816
    buffer_load_dwordx4 v[184:187], v1, s[8:11], s32 offen sc1
    buffer_load_dwordx4 v[188:191], v1, s[8:11], s32 offen offset:1024 sc1
    s_add_u32 s32, s33, 1204224
    buffer_load_dwordx4 v[208:211], v1, s[8:11], s32 offen sc1
    buffer_load_dwordx4 v[212:215], v1, s[8:11], s32 offen offset:1024 sc1
    s_add_u32 s32, s33, 14336
    buffer_load_dwordx4 v[232:235], v1, s[8:11], s32 offen sc1
    buffer_load_dwordx4 v[236:239], v1, s[8:11], s32 offen offset:1024 sc1
    s_add_u32 s32, s33, 415744
    s_add_u32 m0, s29, 0
    s_nop 0
    buffer_load_dwordx4 v1, s[8:11], s32 offen sc1 lds
    buffer_load_dwordx4 v1, s[8:11], s32 offen offset:1024 sc1 lds
    s_add_u32 s32, s33, 817152
    s_add_u32 m0, s29, 6144
    s_nop 0
    buffer_load_dwordx4 v1, s[8:11], s32 offen sc1 lds
    buffer_load_dwordx4 v1, s[8:11], s32 offen offset:1024 sc1 lds
    s_add_u32 s32, s33, 1218560
    s_add_u32 m0, s29, 12288
    s_nop 0
    buffer_load_dwordx4 v1, s[8:11], s32 offen sc1 lds
    buffer_load_dwordx4 v1, s[8:11], s32 offen offset:1024 sc1 lds
wl_71:
    v_add_u32 v14, s29, v1
    v_add_u32 v4, s17, v1
    v_add_u32 v5, s18, v1
    v_add_u32 v7, s19, v1
    v_add_u32 v12, s20, v1
    v_add_u32 v13, s21, v1
    v_bfe_u32 v3, v0, 4, 2
    v_lshlrev_b32 v6, 7, v3
    v_bfe_u32 v3, v0, 2, 2
    v_lshl_add_u32 v6, v3, 5, v6
    v_bfe_u32 v3, v0, 0, 1
    v_lshl_add_u32 v6, v3, 4, v6
    s_mul_i32 s30, s3, 1536
    s_sub_u32 s30, 8192, s30
    v_add_u32 v6, s30, v6
    v_mov_b32 v18, 0x8000000
    v_cndmask_b32 v6, v18, v6, s[58:59]
    v_bfe_u32 v3, v0, 4, 2
    v_lshlrev_b32 v8, 7, v3
    v_bfe_u32 v3, v0, 0, 4
    v_lshl_add_u32 v8, v3, 2, v8
    s_lshl_b32 s30, s3, 9
    s_add_u32 s30, s30, 7680
    v_add_u32 v8, s30, v8
    v_bfe_u32 v3, v0, 5, 1
    v_lshlrev_b32 v10, 9, v3
    v_bfe_u32 v3, v0, 2, 2
    v_lshl_add_u32 v10, v3, 7, v10
    v_bfe_u32 v3, v0, 0, 1
    v_lshl_add_u32 v10, v3, 6, v10
    v_bfe_u32 v3, v0, 4, 1
    v_lshl_add_u32 v10, v3, 5, v10
    v_bfe_u32 v3, v0, 1, 1
    v_lshl_add_u32 v10, v3, 4, v10
    s_lshl_b32 s48, s3, 11
    s_add_u32 s48, s48, 11776
    v_bfe_u32 v3, v0, 4, 2
    v_lshlrev_b32 v9, 7, v3
    v_bfe_u32 v3, v0, 2, 1
    v_lshl_add_u32 v9, v3, 6, v9
    v_bfe_u32 v3, v0, 0, 2
    v_lshl_add_u32 v9, v3, 4, v9
    v_bfe_u32 v3, v0, 3, 1
    v_lshl_add_u32 v9, v3, 3, v9
    s_and_b32 s31, s3, 1
    s_lshl_b32 s30, s31, 11
    s_add_u32 s30, s30, 7680
    v_add_u32 v9, s30, v9
    s_lshl_b32 s30, s4, 9
    s_lshl_b32 s31, s31, 8
    s_add_u32 s30, s30, s31
    v_lshl_add_u32 v11, v0, 2, s30
    s_lshl_b32 s30, s3, 12
    s_lshl_b32 s31, s4, 15
    s_add_u32 s35, s30, s31
    s_add_u32 s35, s35, 0x2100000
    s_add_u32 s37, s30, 32768
    s_add_u32 s35, s35, 458752
    s_mov_b32 s38, 0x8000000
    s_mov_b32 s6, 0x8000000
    s_mov_b32 s7, 1
    s_waitcnt vmcnt(16)
    v_readfirstlane_b32 s29, v24
    s_cmp_le_u32 s29, 1
    s_cbranch_scc1 dl_73
    s_mov_b32 s31, s37
    s_add_u32 m0, s31, 0
    s_add_u32 s31, s35, -458752
    buffer_load_dwordx4 v1, s[8:11], s31 offen offset:0 sc1 lds
    buffer_load_dwordx4 v1, s[8:11], s31 offen offset:1024 sc1 lds
    buffer_load_dwordx4 v1, s[8:11], s31 offen offset:2048 sc1 lds
    buffer_load_dwordx4 v1, s[8:11], s31 offen offset:3072 sc1 lds
    s_mov_b32 s31, s37
    s_add_u32 m0, s31, 16384
    s_add_u32 s31, s35, -442368
    buffer_load_dwordx4 v1, s[8:11], s31 offen offset:0 sc1 lds
    buffer_load_dwordx4 v1, s[8:11], s31 offen offset:1024 sc1 lds
    buffer_load_dwordx4 v1, s[8:11], s31 offen offset:2048 sc1 lds
    buffer_load_dwordx4 v1, s[8:11], s31 offen offset:3072 sc1 lds
    s_xor_b32 s31, s37, 0x18000
    s_add_u32 m0, s31, 0
    s_add_u32 s31, s35, 0
    buffer_load_dwordx4 v1, s[8:11], s31 offen offset:0 sc1 lds
    buffer_load_dwordx4 v1, s[8:11], s31 offen offset:1024 sc1 lds
    buffer_load_dwordx4 v1, s[8:11], s31 offen offset:2048 sc1 lds
    buffer_load_dwordx4 v1, s[8:11], s31 offen offset:3072 sc1 lds
    s_xor_b32 s31, s37, 0x18000
    s_add_u32 m0, s31, 16384
    s_add_u32 s31, s35, 16384
    buffer_load_dwordx4 v1, s[8:11], s31 offen offset:0 sc1 lds
    buffer_load_dwordx4 v1, s[8:11], s31 offen offset:1024 sc1 lds
    buffer_load_dwordx4 v1, s[8:11], s31 offen offset:2048 sc1 lds
    buffer_load_dwordx4 v1, s[8:11], s31 offen offset:3072 sc1 lds
    s_mov_b32 s7, 0
    s_mov_b32 s38, s35
    s_add_u32 s6, s35, 16384
    s_branch ds_72
dl_73:
    buffer_load_dword v18, off, s[8:11], s49 sc1
    s_waitcnt vmcnt(0)
    v_readfirstlane_b32 s29, v18
    s_cmp_le_u32 s29, 1
    s_cbranch_scc1 ds_72
    s_add_u32 m0, s37, 0
    s_add_u32 s31, s35, -458752
    buffer_load_dwordx4 v1, s[8:11], s31 offen offset:0 sc1 lds
    buffer_load_dwordx4 v1, s[8:11], s31 offen offset:1024 sc1 lds
    buffer_load_dwordx4 v1, s[8:11], s31 offen offset:2048 sc1 lds
    buffer_load_dwordx4 v1, s[8:11], s31 offen offset:3072 sc1 lds
    s_add_u32 m0, s37, 16384
    s_add_u32 s31, s35, -442368
    buffer_load_dwordx4 v1, s[8:11], s31 offen offset:0 sc1 lds
    buffer_load_dwordx4 v1, s[8:11], s31 offen offset:1024 sc1 lds
    buffer_load_dwordx4 v1, s[8:11], s31 offen offset:2048 sc1 lds
    buffer_load_dwordx4 v1, s[8:11], s31 offen offset:3072 sc1 lds
    s_mov_b32 s38, s35
    s_add_u32 s6, s35, 16384
    s_mov_b32 s7, 0
ds_72:
    s_mov_b32 s40, 0x8000000
    s_mov_b32 s13, 0
ij_35:
    s_mov_b32 s12, 0
    s_add_u32 s32, s15, 0xea1800
    s_add_u32 s33, s16, 0xea1800
    v_mov_b32 v20, 0
    v_mov_b32 v21, 0
    v_mov_b32 v22, 0
    v_mov_b32 v23, 0
    v_mov_b32 v24, 0
    v_mov_b32 v25, 0
    v_mov_b32 v26, 0
    v_mov_b32 v27, 0
    v_mov_b32 v28, 0
    v_mov_b32 v29, 0
    v_mov_b32 v30, 0
    v_mov_b32 v31, 0
    v_mov_b32 v32, 0
    v_mov_b32 v33, 0
    v_mov_b32 v34, 0
    v_mov_b32 v35, 0
    v_mov_b32 v36, 0
    v_mov_b32 v37, 0
    v_mov_b32 v38, 0
    v_mov_b32 v39, 0
    v_mov_b32 v40, 0
    v_mov_b32 v41, 0
    v_mov_b32 v42, 0
    v_mov_b32 v43, 0
    v_mov_b32 v44, 0
    v_mov_b32 v45, 0
    v_mov_b32 v46, 0
    v_mov_b32 v47, 0
    s_waitcnt lgkmcnt(0)
    s_cmp_eq_u32 s51, 1
    s_cbranch_scc1 tslow
    s_cmp_eq_u32 s5, 1
    s_cbranch_scc1 cloopF
    s_branch sloopF
tslow:
    s_cmp_eq_u32 s5, 1
    s_cbranch_scc1 cloopS
    s_branch sloopS
tdie:
    s_endpgm
export:
    s_cmp_eq_u32 s30, 31
    s_cbranch_scc1 relay
    v_min_u32 v243, 63, v0
    v_lshlrev_b32 v243, 4, v243
    s_mov_b32 s31, 0xf80800
    s_cmp_eq_u32 s3, 0
    s_cbranch_scc0 wk_75
    s_mov_b32 s14, 0
ww_74:
    buffer_load_dwordx4 v[244:247], v243, s[8:11], s31 offen sc1
    s_waitcnt vmcnt(0)
    v_min3_u32 v244, v244, v245, v246
    v_min_u32 v244, v244, v247
    v_cmp_eq_u32 vcc, 0, v244
    s_cbranch_vccz wk_75
    s_sleep 3
    s_add_u32 s14, s14, 1
    s_cmp_lt_u32 s14, 400000
    s_cbranch_scc1 ww_74
    s_endpgm
wk_75:
    s_barrier
    s_mov_b32 s12, 1
    v_mov_b32 v10, 1
    s_mov_b32 s35, 0x8000000
    v_min_u32 v7, 55, v0
    v_lshlrev_b32 v7, 7, v7
    s_mul_i32 s31, s3, 7168
    s_add_u32 s31, s31, 0xea1800
    buffer_load_dword v9, v7, s[8:11], s31 offen sc1
    s_lshl_b32 s31, s3, 13
    s_add_u32 s31, s31, 0xe27000
    v_lshlrev_b32 v8, 7, v0
    buffer_load_dword v9, v8, s[8:11], s31 offen sc1
    s_add_u32 s31, s31, 8192
    buffer_load_dword v9, v8, s[8:11], s31 offen sc1
exloop:
    s_mul_i32 s30, s12, 7168
    s_add_u32 s34, s30, 0xea1800
    s_add_u32 s32, s34, s15
    s_add_u32 s33, s34, s16
    s_add_u32 s34, s34, 21504
    s_cmp_eq_u32 s3, 0
    s_cselect_b32 s34, s34, 0x8000000
    buffer_load_dword v9, v7, s[8:11], s34 offen sc1
    s_mov_b32 s14, 0
ex_76:
    s_sleep 6
    buffer_load_dwordx4 v[20:23], v1, s[8:11], s32 offen sc1
    buffer_load_dwordx4 v[24:27], v1, s[8:11], s33 offen sc1
    s_add_u32 s14, s14, 1
    s_cmp_lt_u32 s14, 200000
    s_cbranch_scc0 tdie
    s_waitcnt vmcnt(0)
    v_max3_u32 v3, v20, v21, v22
    v_max3_u32 v4, v23, v24, v25
    v_max3_u32 v3, v26, v27, v3
    v_max_u32 v3, v4, v3
    v_cmp_eq_u32 vcc, -1, v3
    s_cbranch_vccnz ex_76
    s_sub_u32 s32, s32, 458752
    s_sub_u32 s33, s33, 458752
    s_barrier
    buffer_store_dwordx4 v[20:23], v1, s[8:11], s32 offen sc1
    buffer_store_dwordx4 v[24:27], v1, s[8:11], s33 offen sc1
    s_lshl_b32 s31, s3, 8
    s_add_u32 s31, s31, s12
    s_cmp_eq_u32 s31, 1
    s_cselect_b32 s31, 0xf81380, s35
    buffer_store_dword v10, off, s[8:11], s31 sc1
    s_add_u32 s12, s12, 1
    s_cmp_lt_u32 s12, 63
    s_cbranch_scc1 exloop
    s_endpgm
relay:
    s_cmp_eq_u32 s3, 0
    s_cbranch_scc0 tdie
    v_min_u32 v20, 31, v0
    v_lshlrev_b32 v20, 2, v20
    s_mov_b32 s14, 0
xc_77:
    buffer_load_dword v3, v20, s[44:47], 0 offen sc1
    s_waitcnt vmcnt(0)
    v_cmp_eq_u32 vcc, 0, v3
    s_cbranch_vccz xo_78
    s_sleep 4
    s_add_u32 s14, s14, 1
    s_cmp_lt_u32 s14, 200000
    s_cbranch_scc1 xc_77
    s_endpgm
xo_78:
    v_readfirstlane_b32 s31, v3
    s_mov_b32 s12, 0
    s_mov_b32 s14, 0
    s_mov_b32 s49, 0xf80000
    v_cmp_ne_u32 s[62:63], s31, v3
    v_and_b32 v3, 31, v0
    v_cmp_gt_u32 s[60:61], 28, v3
    v_lshlrev_b32 v4, 2, v0
    v_lshrrev_b32 v5, 5, v0
    s_mov_b32 s48, 0xf80f80
reloop:
    s_sleep 2
    buffer_load_dword v6, v4, s[8:11], s49 offen sc1
    s_add_u32 s14, s14, 1
    s_cmp_lt_u32 s14, 200000
    s_cbranch_scc0 tdie
    s_mov_b32 s13, s12
    s_waitcnt vmcnt(0)
    v_lshl_add_u32 v6, v6, 1, v5
reinc:
    v_cmp_ge_u32 vcc, s12, v6
    s_nop 1
    s_and_b64 vcc, vcc, s[60:61]
    s_cbranch_scc1 repub
    s_add_u32 s12, s12, 1
    s_cmp_lt_u32 s12, 64
    s_cbranch_scc1 reinc
repub:
    s_cmp_eq_u32 s12, s13
    s_cbranch_scc1 reloop
    v_mov_b32 v7, s12
    s_cmp_eq_u64 s[62:63], 0
    s_cbranch_scc0 reslow
    buffer_store_dword v7, off, s[8:11], s48
    s_branch renext
reslow:
    buffer_store_dword v7, off, s[8:11], s48 sc1
renext:
    s_cmp_lt_u32 s12, 63
    s_cbranch_scc1 reloop
    s_endpgm
.p2align 6
sloopF:
    v_mov_b32 v37, 0
    v_mov_b32 v38, 0
    v_mov_b32 v39, 0
    v_mov_b32 v40, 0
    v_mov_b32 v41, 0
    v_mov_b32 v42, 0
    v_mov_b32 v43, 0
    v_mov_b32 v44, 0
    v_mov_b32 v45, 0
    v_mov_b32 v46, 0
    v_mov_b32 v47, 0
    v_mov_b32 v108, 0
    v_mov_b32 v109, 0
    v_mov_b32 v110, 0
    v_mov_b32 v111, 0
    v_mov_b32 v112, 0
    v_mov_b32 v113, 0
    v_mov_b32 v114, 0
    v_mov_b32 v115, 0
    v_mov_b32 v116, 0
    v_mov_b32 v117, 0
    v_mov_b32 v118, 0
    v_mov_b32 v119, 0
    v_add_u32 v102, s17, v1
    v_add_u32 v103, s18, v1
    v_add_u32 v104, s19, v1
    v_add_u32 v105, s20, v1
    v_add_u32 v106, s21, v1
    v_mov_b32 v48, -1
    v_mov_b32 v49, -1
    v_mov_b32 v50, -1
    v_mov_b32 v51, -1
    v_mov_b32 v52, -1
    v_mov_b32 v53, -1
    v_mov_b32 v54, -1
    v_mov_b32 v55, -1
    s_waitcnt vmcnt(0)
    s_mov_b32 s14, 0
.p2align 6
mf_80:
    buffer_load_dwordx4 v[48:51], v1, s[8:11], s32 offen sc1
    buffer_load_dwordx4 v[52:55], v1, s[8:11], s33 offen sc1
    s_add_u32 s14, s14, 1
    s_cmp_lt_u32 s14, 200000
    s_cbranch_scc0 tdie
mp_79:
    s_waitcnt vmcnt(4)
    v_max3_u32 v3, v48, v49, v50
    v_max3_u32 v100, v51, v52, v53
    v_max3_u32 v3, v54, v55, v3
    v_max_u32 v3, v100, v3
    v_cmp_eq_u32 vcc, -1, v3
    s_cbranch_vccnz mf_80
mo_81:
    v_smfmac_f32_16x16x64_bf16 v[20:23], v[48:51], a[0:7], v2
    ds_write_b128 v16, v[48:51]
    v_smfmac_f32_16x16x64_bf16 v[24:27], v[48:51], a[8:15], v2
    ds_write_b128 v17, v[52:55]
    v_smfmac_f32_16x16x64_bf16 v[20:23], v[52:55], a[16:23], v2
    v_smfmac_f32_16x16x64_bf16 v[24:27], v[52:55], a[24:31], v2
    v_smfmac_f32_16x16x64_bf16 v[28:31], v[48:51], a[32:39], v2
    v_smfmac_f32_16x16x64_bf16 v[32:35], v[48:51], a[40:47], v2
    s_waitcnt lgkmcnt(0)
    s_barrier
    ds_read_b128 v[56:59], v102
    v_smfmac_f32_16x16x64_bf16 v[28:31], v[52:55], a[48:55], v2
    ds_read_b128 v[60:63], v103
    v_smfmac_f32_16x16x64_bf16 v[32:35], v[52:55], a[56:63], v2
    ds_read_b128 v[64:67], v104
    v_smfmac_f32_16x16x64_bf16 v[36:39], v[48:51], a[64:71], v2
    ds_read_b128 v[68:71], v105
    v_smfmac_f32_16x16x64_bf16 v[40:43], v[48:51], a[72:79], v2
    ds_read_b128 v[72:75], v106
    v_smfmac_f32_16x16x64_bf16 v[44:47], v[48:51], a[80:87], v2
    buffer_load_dword v18, off, s[8:11], s49 sc1
    v_smfmac_f32_16x16x64_bf16 v[36:39], v[52:55], a[88:95], v2
    buffer_load_dword v19, v7, s[8:11], s38 offen
    v_smfmac_f32_16x16x64_bf16 v[40:43], v[52:55], a[96:103], v2
    ds_read_b128 v[76:79], v6 offset:0
    v_smfmac_f32_16x16x64_bf16 v[44:47], v[52:55], a[104:111], v2
    ds_read_b128 v[80:83], v6 offset:1024
    s_waitcnt lgkmcnt(6)
    v_smfmac_f32_16x16x64_bf16 v[20:23], v[56:59], a[112:119], v2
    ds_read_b128 v[84:87], v6 offset:16
    v_smfmac_f32_16x16x64_bf16 v[24:27], v[56:59], a[120:127], v2
    ds_read_b128 v[88:91], v6 offset:1040
    v_smfmac_f32_16x16x64_bf16 v[28:31], v[56:59], a[128:135], v2
    ds_read2_b32 v[92:93], v8 offset0:0 offset1:8
    v_smfmac_f32_16x16x64_bf16 v[32:35], v[56:59], a[136:143], v2
    ds_read2_b32 v[94:95], v8 offset0:1 offset1:9
    v_smfmac_f32_16x16x64_bf16 v[36:39], v[56:59], a[144:151], v2
    ds_read2_b32 v[96:97], v8 offset0:128 offset1:136
    v_smfmac_f32_16x16x64_bf16 v[40:43], v[56:59], a[152:159], v2
    ds_read2_b32 v[98:99], v8 offset0:129 offset1:137
    v_smfmac_f32_16x16x64_bf16 v[44:47], v[56:59], a[160:167], v2
    s_waitcnt vmcnt(2)
    ds_read2_b32 v[48:49], v9 offset0:0 offset1:8
    s_and_b32 s30, s12, 3
    s_mul_i32 s22, s30, 10240
    s_waitcnt lgkmcnt(9)
    v_smfmac_f32_16x16x64_bf16 v[20:23], v[60:63], a[168:175], v2
    ds_read2_b32 v[50:51], v9 offset0:1 offset1:9
    s_add_u32 s22, s22, 0xe27000
    s_add_u32 s32, s32, 7168
    v_smfmac_f32_16x16x64_bf16 v[20:23], v[64:67], a[176:183], v2
    ds_read2_b32 v[52:53], v9 offset0:128 offset1:136
    s_add_u32 s33, s33, 7168
    s_add_u32 s31, s12, 3
    v_smfmac_f32_16x16x64_bf16 v[20:23], v[68:71], a[184:191], v2
    ds_read2_b32 v[54:55], v9 offset0:129 offset1:137
    s_and_b32 s31, s31, 3
    s_mul_i32 s24, s31, 10240
    v_smfmac_f32_16x16x64_bf16 v[20:23], v[72:75], a[192:199], v2
    s_add_u32 s24, s24, s27
    s_min_u32 s24, s24, 0x8000000
    v_smfmac_f32_16x16x64_bf16 v[24:27], v[60:63], a[200:207], v2
    v_smfmac_f32_16x16x64_bf16 v[24:27], v[64:67], a[208:215], v2
    v_smfmac_f32_16x16x64_bf16 v[24:27], v[68:71], a[216:223], v2
    v_smfmac_f32_16x16x64_bf16 v[24:27], v[72:75], a[224:231], v2
    v_add_f32 v20, v20, v22
    v_smfmac_f32_16x16x64_bf16 v[28:31], v[60:63], a[232:239], v2
    v_add_f32 v21, v21, v23
    v_smfmac_f32_16x16x64_bf16 v[28:31], v[64:67], a[240:247], v2
    v_cvt_pk_bf16_f32 v20, v20, v21
    v_smfmac_f32_16x16x64_bf16 v[28:31], v[68:71], a[248:255], v2
    ds_write_b32 v4, v20 offset:0
    v_smfmac_f32_16x16x64_bf16 v[28:31], v[72:75], v[120:127], v2
    v_add_f32 v24, v24, v26
    v_smfmac_f32_16x16x64_bf16 v[32:35], v[60:63], v[128:135], v2
    v_add_f32 v25, v25, v27
    v_smfmac_f32_16x16x64_bf16 v[32:35], v[64:67], v[136:143], v2
    v_cvt_pk_bf16_f32 v24, v24, v25
    v_smfmac_f32_16x16x64_bf16 v[32:35], v[68:71], v[144:151], v2
    ds_write_b32 v4, v24 offset:256
    v_smfmac_f32_16x16x64_bf16 v[32:35], v[72:75], v[152:159], v2
    ds_read_b128 v[20:23], v6 offset:2048
    v_add_f32 v28, v28, v30
    v_smfmac_f32_16x16x64_bf16 v[36:39], v[60:63], v[160:167], v2
    ds_read_b128 v[24:27], v6 offset:3072
    v_add_f32 v29, v29, v31
    v_smfmac_f32_16x16x64_bf16 v[36:39], v[64:67], v[168:175], v2
    v_cvt_pk_bf16_f32 v28, v28, v29
    v_smfmac_f32_16x16x64_bf16 v[36:39], v[68:71], v[176:183], v2
    ds_write_b32 v4, v28 offset:512
    v_smfmac_f32_16x16x64_bf16 v[36:39], v[72:75], v[184:191], v2
    v_add_f32 v32, v32, v34
    v_smfmac_f32_16x16x64_bf16 v[40:43], v[60:63], v[192:199], v2
    v_add_f32 v33, v33, v35
    v_smfmac_f32_16x16x64_bf16 v[40:43], v[64:67], v[200:207], v2
    v_cvt_pk_bf16_f32 v32, v32, v33
    v_smfmac_f32_16x16x64_bf16 v[40:43], v[68:71], v[208:215], v2
    ds_write_b32 v4, v32 offset:768
    v_smfmac_f32_16x16x64_bf16 v[40:43], v[72:75], v[216:223], v2
    ds_read_b64_tr_b16 v[100:101], v5
    v_add_f32 v36, v36, v38
    v_smfmac_f32_16x16x64_bf16 v[44:47], v[60:63], v[224:231], v2
    ds_read_b64_tr_b16 v[102:103], v5 offset:128
    v_add_f32 v37, v37, v39
    v_smfmac_f32_16x16x64_bf16 v[44:47], v[64:67], v[232:239], v2
    ds_read_b128 v[28:31], v6 offset:2064
    v_cvt_pk_bf16_f32 v36, v36, v37
    v_smfmac_f32_16x16x64_bf16 v[44:47], v[68:71], v[240:247], v2
    ds_write_b32 v4, v36 offset:1024
    v_smfmac_f32_16x16x64_bf16 v[44:47], v[72:75], v[248:255], v2
    ds_read_b128 v[32:35], v6 offset:3088
    v_add_f32 v40, v40, v42
    v_add_f32 v41, v41, v43
    v_cvt_pk_bf16_f32 v40, v40, v41
    ds_write_b32 v4, v40 offset:1280
    s_cmp_lt_u32 s3, 2
    s_nop 1
    v_pk_add_f32 v[44:45], v[44:45], v[46:47]
    v_cvt_pk_bf16_f32 v44, v44, v45
    ds_write_b32 v4, v44 offset:1536
    ds_read_b64_tr_b16 v[104:105], v5 offset:1024
    ds_read_b64_tr_b16 v[106:107], v5 offset:1152
    s_waitcnt lgkmcnt(7)
    v_smfmac_f32_16x16x64_bf16 v[108:111], v[100:103], v[76:83], v2
    v_smfmac_f32_16x16x64_bf16 v[112:115], v[100:103], v[84:91], v2
    v_smfmac_f32_16x16x64_bf16 v[116:119], v[100:103], v[92:99], v2
    s_waitcnt lgkmcnt(0)
    v_smfmac_f32_16x16x64_bf16 v[108:111], v[104:107], v[20:27], v2
    v_smfmac_f32_16x16x64_bf16 v[112:115], v[104:107], v[28:35], v2
    v_smfmac_f32_16x16x64_bf16 v[116:119], v[104:107], v[48:55], v2
    s_cbranch_scc0 ns_82
    s_cmp_eq_u32 s3, 0
    s_cbranch_scc0 w1_84
    s_nop 2
    v_add_f32 v80, v109, v111
    v_add_f32 v76, v108, v110
    v_add_f32 v81, v113, v115
    v_add_f32 v77, v112, v114
    v_add_f32 v82, v117, v119
    ds_write_b96 v10, v[80:82] offset:4096
    v_add_f32 v78, v116, v118
sm_85:
    v_mov_b32 v20, 0
    v_mov_b32 v21, 0
    v_mov_b32 v22, 0
    v_mov_b32 v23, 0
    v_mov_b32 v24, 0
    v_mov_b32 v25, 0
    s_waitcnt lgkmcnt(0)
    v_mov_b32 v26, 0
    s_barrier
    ds_read_b128 v[80:83], v11 offset:0
    ds_read_b128 v[84:87], v11 offset:1024
    ds_read_b128 v[88:91], v11 offset:2048
    v_mov_b32 v27, 0
    v_mov_b32 v28, 0
    v_mov_b32 v29, 0
    v_mov_b32 v30, 0
    v_mov_b32 v31, 0
    v_mov_b32 v32, 0
    v_mov_b32 v33, 0
    v_mov_b32 v34, 0
    v_mov_b32 v35, 0
    v_mov_b32 v36, 0
    s_waitcnt lgkmcnt(2)
    v_pk_add_f32 v[76:77], v[76:77], v[80:81]
    v_add_f32 v78, v78, v82
    s_waitcnt lgkmcnt(0)
    v_pk_add_f32 v[84:85], v[84:85], v[88:89]
    v_add_f32 v86, v86, v90
    v_pk_add_f32 v[76:77], v[76:77], v[84:85]
    v_add_f32 v78, v78, v86
    v_max3_f32 v84, v76, v77, v78
    v_sub_f32 v76, v76, v84
    v_sub_f32 v77, v77, v84
    v_max_f32_dpp v85, v84, v84 quad_perm:[1,0,3,2] row_mask:0xf bank_mask:0xf
    v_sub_f32 v78, v78, v84
    v_exp_f32 v76, v76
    v_max_f32_dpp v85, v85, v85 quad_perm:[2,3,0,1] row_mask:0xf bank_mask:0xf
    v_exp_f32 v77, v77
    s_nop 0
    v_max_f32_dpp v85, v85, v85 row_half_mirror row_mask:0xf bank_mask:0xf
    v_exp_f32 v78, v78
    v_add_f32 v86, v76, v77
    v_max_f32_dpp v85, v85, v85 row_mirror row_mask:0xf bank_mask:0xf
    v_sub_f32 v84, v84, v85
    v_exp_f32 v84, v84
    v_fmac_f32 v86, v78, v14
    v_mul_f32 v86, v86, v84
    v_mul_f32 v76, v76, v84
    v_mul_f32 v77, v77, v84
    v_add_f32_dpp v86, v86, v86 quad_perm:[1,0,3,2] row_mask:0xf bank_mask:0xf
    v_mul_f32 v78, v78, v84
    s_nop 0
    v_add_f32_dpp v86, v86, v86 quad_perm:[2,3,0,1] row_mask:0xf bank_mask:0xf
    s_nop 1
    v_add_f32_dpp v86, v86, v86 row_half_mirror row_mask:0xf bank_mask:0xf
    s_nop 1
    v_add_f32_dpp v86, v86, v86 row_mirror row_mask:0xf bank_mask:0xf
    v_rcp_f32 v86, v86
    s_nop 0
    v_mul_f32 v76, v76, v86
    v_mul_f32 v77, v77, v86
    v_cvt_pk_bf16_f32 v88, |v76|, |v77|
    buffer_store_dword v88, v12, s[8:11], s22 offen
    v_mul_f32_dpp v79, v78, v86 row_shl:4 row_mask:0xf bank_mask:0xf bound_ctrl:0
    v_mul_f32 v78, v78, v86
    v_cvt_pk_bf16_f32 v90, |v78|, |v79|
    buffer_store_dword v90, v13, s[8:11], s22 offen
    s_waitcnt vmcnt(3)
    s_barrier
    s_mov_b32 m0, s36
    s_add_u32 s30, s34, 4096
    buffer_load_dwordx4 v1, s[8:11], s34 offen offset:0 sc1 lds
    buffer_load_dwordx4 v1, s[8:11], s34 offen offset:1024 sc1 lds
    buffer_load_dwordx4 v1, s[8:11], s34 offen offset:2048 sc1 lds
    buffer_load_dwordx4 v1, s[8:11], s34 offen offset:3072 sc1 lds
    s_add_u32 m0, s36, 4096
    s_add_u32 s34, s34, 28672
    buffer_load_dwordx4 v1, s[8:11], s30 offen offset:0 sc1 lds
    buffer_load_dwordx4 v1, s[8:11], s30 offen offset:1024 sc1 lds
    buffer_load_dwordx4 v1, s[8:11], s30 offen offset:2048 sc1 lds
jn_83:
    v_add_u32 v7, 28672, v7
    s_mov_b64 exec, s[62:63]
    v_add_u32 v7, 430080, v7
    s_mov_b64 exec, -1
    s_add_u32 s31, s12, 3
    v_readfirstlane_b32 s29, v18
    s_cmp_le_u32 s29, s31
    s_cselect_b32 s38, 0x8000000, 0
    s_cmp_gt_u32 s31, 62
    s_cselect_b32 s38, 0x8000000, s38
    s_add_u32 s12, s12, 1
    s_cmp_lt_u32 s12, 63
    s_cbranch_scc1 sloopF
    s_endpgm
ns_82:
    s_nop 4
    v_add_f32 v76, v108, v110
    v_add_f32 v80, v109, v111
    v_add_f32 v77, v112, v114
    v_add_f32 v81, v113, v115
    v_add_f32 v78, v116, v118
    v_add_f32 v82, v117, v119
    ds_write_b96 v10, v[76:78] offset:0
    ds_write_b96 v10, v[80:82] offset:4096
    v_mov_b32 v92, -1
    v_mov_b32 v93, -1
    v_mov_b32 v94, -1
    v_mov_b32 v95, -1
    s_waitcnt lgkmcnt(0)
    s_barrier
    buffer_store_dwordx4 v[92:95], v1, s[8:11], s24 offen
    s_waitcnt vmcnt(2)
    s_barrier
    s_mov_b32 m0, s36
    s_add_u32 s30, s34, 4096
    buffer_load_dwordx4 v1, s[8:11], s34 offen offset:0 sc1 lds
    buffer_load_dwordx4 v1, s[8:11], s34 offen offset:1024 sc1 lds
    buffer_load_dwordx4 v1, s[8:11], s34 offen offset:2048 sc1 lds
    buffer_load_dwordx4 v1, s[8:11], s34 offen offset:3072 sc1 lds
    s_add_u32 m0, s36, 4096
    s_add_u32 s34, s34, 28672
    buffer_load_dwordx4 v1, s[8:11], s30 offen offset:0 sc1 lds
    buffer_load_dwordx4 v1, s[8:11], s30 offen offset:1024 sc1 lds
    buffer_load_dwordx4 v1, s[8:11], s30 offen offset:2048 sc1 lds
    v_mov_b32 v20, 0
    v_mov_b32 v21, 0
    v_mov_b32 v22, 0
    v_mov_b32 v23, 0
    v_mov_b32 v24, 0
    v_mov_b32 v25, 0
    v_mov_b32 v26, 0
    v_mov_b32 v27, 0
    v_mov_b32 v28, 0
    v_mov_b32 v29, 0
    v_mov_b32 v30, 0
    v_mov_b32 v31, 0
    v_mov_b32 v32, 0
    v_mov_b32 v33, 0
    v_mov_b32 v34, 0
    v_mov_b32 v35, 0
    v_mov_b32 v36, 0
    s_branch jn_83
w1_84:
    s_nop 2
    v_add_f32 v80, v108, v110
    v_add_f32 v76, v109, v111
    v_add_f32 v81, v112, v114
    v_add_f32 v77, v113, v115
    v_add_f32 v82, v116, v118
    ds_write_b96 v10, v[80:82] offset:0
    v_add_f32 v78, v117, v119
    s_branch sm_85
.p2align 6
cloopF:
    s_xor_b32 s37, s37, 0x18000
    s_cmp_lg_u32 s13, 0
    s_cbranch_scc1 dq_86
db_87:
    s_mov_b32 m0, s37
    s_nop 0
    v_mov_b32 v20, 0
    v_mov_b32 v21, 0
    v_mov_b32 v22, 0
    v_mov_b32 v23, 0
    v_mov_b32 v24, 0
    v_mov_b32 v25, 0
    v_mov_b32 v26, 0
    v_mov_b32 v27, 0
    v_mov_b32 v28, 0
    v_mov_b32 v29, 0
    v_mov_b32 v30, 0
    v_mov_b32 v31, 0
    v_mov_b32 v32, 0
    v_mov_b32 v33, 0
    v_mov_b32 v34, 0
    v_mov_b32 v35, 0
    v_mov_b32 v36, 0
    v_mov_b32 v37, 0
    v_mov_b32 v38, 0
    v_mov_b32 v39, 0
    v_mov_b32 v40, 0
    v_mov_b32 v41, 0
    v_mov_b32 v42, 0
    v_mov_b32 v43, 0
    v_mov_b32 v44, 0
    v_mov_b32 v45, 0
    v_mov_b32 v46, 0
    v_mov_b32 v47, 0
    v_mov_b32 v48, 0
    v_mov_b32 v49, 0
    v_mov_b32 v50, 0
    v_mov_b32 v51, 0
    v_mov_b32 v52, -1
    v_mov_b32 v53, -1
    v_mov_b32 v54, -1
    v_mov_b32 v55, -1
    v_mov_b32 v56, -1
    v_mov_b32 v57, -1
    v_mov_b32 v58, -1
    v_mov_b32 v59, -1
    s_waitcnt vmcnt(0)
    s_mov_b32 s14, 0
.p2align 6
mf_89:
    buffer_load_dwordx4 v[52:55], v1, s[8:11], s32 offen sc1
    buffer_load_dwordx4 v[56:59], v1, s[8:11], s33 offen sc1
    s_add_u32 s14, s14, 1
    s_cmp_lt_u32 s14, 200000
    s_cbranch_scc0 tdie
mp_88:
    s_waitcnt vmcnt(0)
    v_max3_u32 v3, v52, v53, v54
    v_max3_u32 v19, v55, v56, v57
    v_max3_u32 v3, v58, v59, v3
    v_max_u32 v3, v19, v3
    v_cmp_eq_u32 vcc, -1, v3
    s_cbranch_vccnz mf_89
mo_90:
    v_smfmac_f32_16x16x64_bf16 v[20:23], v[52:55], a[0:7], v2
    ds_write_b128 v16, v[52:55]
    v_smfmac_f32_16x16x64_bf16 v[24:27], v[52:55], a[8:15], v2
    ds_write_b128 v17, v[56:59]
    v_smfmac_f32_16x16x64_bf16 v[28:31], v[52:55], a[16:23], v2
    v_smfmac_f32_16x16x64_bf16 v[32:35], v[52:55], a[24:31], v2
    v_smfmac_f32_16x16x64_bf16 v[36:39], v[52:55], a[32:39], v2
    v_smfmac_f32_16x16x64_bf16 v[40:43], v[52:55], a[40:47], v2
    s_waitcnt lgkmcnt(0)
    s_barrier
    ds_read_b128 v[60:63], v4
    v_smfmac_f32_16x16x64_bf16 v[44:47], v[52:55], a[48:55], v2
    ds_read_b128 v[64:67], v5
    v_smfmac_f32_16x16x64_bf16 v[48:51], v[52:55], a[56:63], v2
    ds_read_b128 v[68:71], v7
    v_smfmac_f32_16x16x64_bf16 v[20:23], v[56:59], a[64:71], v2
    ds_read_b128 v[72:75], v12
    s_and_b32 s30, s12, 3
    s_mul_i32 s22, s30, 10240
    v_smfmac_f32_16x16x64_bf16 v[24:27], v[56:59], a[72:79], v2
    ds_read_b128 v[76:79], v13
    s_add_u32 s22, s22, 0xe27000
    s_add_u32 s32, s32, 7168
    v_smfmac_f32_16x16x64_bf16 v[28:31], v[56:59], a[80:87], v2
    buffer_load_dword v18, off, s[8:11], s49 sc1
    s_add_u32 s33, s33, 7168
    s_lshl_b32 s31, s3, 11
    v_smfmac_f32_16x16x64_bf16 v[32:35], v[56:59], a[88:95], v2
    s_add_u32 s43, s22, s31
    s_sub_u32 s42, s32, s15
    v_smfmac_f32_16x16x64_bf16 v[36:39], v[56:59], a[96:103], v2
    buffer_load_dwordx4 v1, s[8:11], s38 offen offset:0 sc1 lds
    s_xor_b32 s30, s37, 0x18000
    v_smfmac_f32_16x16x64_bf16 v[40:43], v[56:59], a[104:111], v2
    v_smfmac_f32_16x16x64_bf16 v[44:47], v[56:59], a[112:119], v2
    v_smfmac_f32_16x16x64_bf16 v[48:51], v[56:59], a[120:127], v2
    s_waitcnt lgkmcnt(4)
    v_smfmac_f32_16x16x64_bf16 v[20:23], v[60:63], a[128:135], v2
    buffer_load_dwordx4 v1, s[8:11], s38 offen offset:1024 sc1 lds
    v_smfmac_f32_16x16x64_bf16 v[24:27], v[60:63], a[136:143], v2
    ds_read_b128 v[80:83], v14 offset:0
    v_smfmac_f32_16x16x64_bf16 v[28:31], v[60:63], a[144:151], v2
    ds_read_b128 v[84:87], v14 offset:1024
    v_smfmac_f32_16x16x64_bf16 v[32:35], v[60:63], a[152:159], v2
    ds_read_b128 v[88:91], v14 offset:2048
    v_smfmac_f32_16x16x64_bf16 v[36:39], v[60:63], a[160:167], v2
    buffer_load_dwordx4 v1, s[8:11], s38 offen offset:2048 sc1 lds
    v_add_u32 v15, s30, v1
    v_smfmac_f32_16x16x64_bf16 v[40:43], v[60:63], a[168:175], v2
    ds_read_b128 v[92:95], v14 offset:3072
    v_lshrrev_b32 v3, 4, v0
    v_smfmac_f32_16x16x64_bf16 v[44:47], v[60:63], a[176:183], v2
    ds_read_b128 v[96:99], v14 offset:4096
    v_lshl_add_u32 v3, v3, 2, s48
    v_smfmac_f32_16x16x64_bf16 v[48:51], v[60:63], a[184:191], v2
    ds_read_b128 v[100:103], v14 offset:5120
    v_and_b32 v19, 15, v0
    s_waitcnt lgkmcnt(6)
    v_smfmac_f32_16x16x64_bf16 v[20:23], v[64:67], a[192:199], v2
    buffer_load_dwordx4 v1, s[8:11], s38 offen offset:3072 sc1 lds
    s_add_u32 m0, s37, 16384
    v_lshl_add_u32 v19, v19, 4, v3
    v_smfmac_f32_16x16x64_bf16 v[24:27], v[64:67], a[200:207], v2
    ds_read_b128 v[104:107], v14 offset:6144
    v_add_u32 v3, s48, v1
    v_smfmac_f32_16x16x64_bf16 v[28:31], v[64:67], a[208:215], v2
    ds_read_b128 v[108:111], v14 offset:7168
    v_smfmac_f32_16x16x64_bf16 v[32:35], v[64:67], a[216:223], v2
    ds_read_b128 v[112:115], v14 offset:8192
    v_smfmac_f32_16x16x64_bf16 v[36:39], v[64:67], a[224:231], v2
    buffer_load_dwordx4 v1, s[8:11], s6 offen offset:0 sc1 lds
    v_smfmac_f32_16x16x64_bf16 v[40:43], v[64:67], a[232:239], v2
    ds_read_b128 v[116:119], v14 offset:9216
    v_smfmac_f32_16x16x64_bf16 v[44:47], v[64:67], a[240:247], v2
    s_waitcnt vmcnt(6)
    ds_read_b128 v[52:55], v14 offset:10240
    v_smfmac_f32_16x16x64_bf16 v[48:51], v[64:67], a[248:255], v2
    ds_read_b128 v[56:59], v14 offset:11264
    v_smfmac_f32_16x16x64_bf16 v[20:23], v[68:71], v[120:127], v2
    buffer_load_dwordx4 v1, s[8:11], s6 offen offset:1024 sc1 lds
    v_smfmac_f32_16x16x64_bf16 v[20:23], v[72:75], v[128:135], v2
    ds_read_b128 v[60:63], v14 offset:12288
    v_smfmac_f32_16x16x64_bf16 v[20:23], v[76:79], v[136:143], v2
    ds_read_b128 v[64:67], v14 offset:13312
    v_smfmac_f32_16x16x64_bf16 v[24:27], v[68:71], v[144:151], v2
    v_smfmac_f32_16x16x64_bf16 v[24:27], v[72:75], v[152:159], v2
    buffer_load_dwordx4 v1, s[8:11], s6 offen offset:2048 sc1 lds
    v_smfmac_f32_16x16x64_bf16 v[24:27], v[76:79], v[160:167], v2
    v_smfmac_f32_16x16x64_bf16 v[28:31], v[68:71], v[168:175], v2
    v_add_f32 v20, v20, v22
    v_smfmac_f32_16x16x64_bf16 v[28:31], v[72:75], v[176:183], v2
    v_add_f32 v21, v21, v23
    v_smfmac_f32_16x16x64_bf16 v[28:31], v[76:79], v[184:191], v2
    buffer_load_dwordx4 v1, s[8:11], s6 offen offset:3072 sc1 lds
    v_cvt_pk_bf16_f32 v20, v20, v21
    v_smfmac_f32_16x16x64_bf16 v[32:35], v[68:71], v[192:199], v2
    ds_write_b32 v19, v20 offset:0
    v_add_f32 v24, v24, v26
    v_smfmac_f32_16x16x64_bf16 v[32:35], v[72:75], v[200:207], v2
    v_add_f32 v25, v25, v27
    v_smfmac_f32_16x16x64_bf16 v[32:35], v[76:79], v[208:215], v2
    v_cvt_pk_bf16_f32 v24, v24, v25
    v_smfmac_f32_16x16x64_bf16 v[36:39], v[68:71], v[216:223], v2
    ds_write_b32 v19, v24 offset:256
    v_add_f32 v28, v28, v30
    v_smfmac_f32_16x16x64_bf16 v[36:39], v[72:75], v[224:231], v2
    v_add_f32 v29, v29, v31
    v_smfmac_f32_16x16x64_bf16 v[36:39], v[76:79], v[232:239], v2
    v_cvt_pk_bf16_f32 v28, v28, v29
    v_smfmac_f32_16x16x64_bf16 v[40:43], v[68:71], v[240:247], v2
    ds_write_b32 v19, v28 offset:512
    v_add_f32 v32, v32, v34
    v_smfmac_f32_16x16x64_bf16 v[40:43], v[72:75], v[248:255], v2
    v_add_f32 v33, v33, v35
    s_waitcnt lgkmcnt(3)
    v_smfmac_f32_16x16x64_bf16 v[40:43], v[76:79], v[80:87], v2
    v_cvt_pk_bf16_f32 v32, v32, v33
    v_smfmac_f32_16x16x64_bf16 v[44:47], v[68:71], v[88:95], v2
    ds_write_b32 v19, v32 offset:768
    v_add_f32 v36, v36, v38
    v_smfmac_f32_16x16x64_bf16 v[44:47], v[72:75], v[96:103], v2
    v_add_f32 v37, v37, v39
    v_smfmac_f32_16x16x64_bf16 v[44:47], v[76:79], v[104:111], v2
    v_cvt_pk_bf16_f32 v36, v36, v37
    v_smfmac_f32_16x16x64_bf16 v[48:51], v[68:71], v[112:119], v2
    ds_write_b32 v19, v36 offset:1024
    v_add_f32 v40, v40, v42
    v_smfmac_f32_16x16x64_bf16 v[48:51], v[72:75], v[52:59], v2
    v_add_f32 v41, v41, v43
    v_smfmac_f32_16x16x64_bf16 v[48:51], v[76:79], v[60:67], v2
    v_cvt_pk_bf16_f32 v40, v40, v41
    s_cmp_eq_u32 s7, 1
    s_cbranch_scc1 d0_91
d1_92:
    ds_read_b128 v[80:83], v15 offset:0
    ds_read_b128 v[84:87], v15 offset:1024
    ds_read_b128 v[88:91], v15 offset:2048
    ds_read_b128 v[92:95], v15 offset:3072
    ds_read_b128 v[96:99], v15 offset:16384
    ds_read_b128 v[100:103], v15 offset:17408
    ds_read_b128 v[104:107], v15 offset:18432
    ds_read_b128 v[108:111], v15 offset:19456
    buffer_load_dwordx4 v[60:63], v6, s[8:11], s43 offen offset:0 sc1
    buffer_load_dwordx4 v[64:67], v10, s[8:11], s43 offen offset:0 sc1
    buffer_load_dwordx4 v[68:71], v10, s[8:11], s43 offen offset:1024 sc1
    ds_write_b32 v19, v40 offset:1280
    v_add_f32 v44, v44, v46
    v_add_f32 v45, v45, v47
    v_cvt_pk_bf16_f32 v44, v44, v45
    ds_write_b32 v19, v44 offset:1536
    v_add_f32 v48, v48, v50
    v_add_f32 v49, v49, v51
    v_cvt_pk_bf16_f32 v48, v48, v49
    ds_write_b32 v19, v48 offset:1792
    ds_read_b128 v[52:55], v3
    ds_read_b128 v[56:59], v3 offset:1024
    v_add_u32 v15, 2048, v8
    s_waitcnt vmcnt(3)
    s_add_u32 s35, s35, 458752
    s_add_u32 s31, s12, 2
    v_readfirstlane_b32 s29, v18
    s_cmp_le_u32 s29, s31
    s_cselect_b32 s13, 1, 0
    s_add_u32 s6, s35, 16384
    s_cmp_gt_u32 s31, 62
    s_cselect_b32 s38, 0x8000000, s35
    s_cselect_b32 s6, 0x8000000, s6
    s_cselect_b32 s13, 0, s13
    s_mov_b32 s14, 0
    s_waitcnt lgkmcnt(0)
.p2align 6
pr_93:
    buffer_load_dwordx4 v[60:63], v6, s[8:11], s43 offen offset:0 sc1
    buffer_load_dwordx4 v[64:67], v10, s[8:11], s43 offen offset:0 sc1
    buffer_load_dwordx4 v[68:71], v10, s[8:11], s43 offen offset:1024 sc1
    s_add_u32 s14, s14, 1
    s_cmp_lt_u32 s14, 200000
    s_cbranch_scc0 tdie
    s_cmp_lt_u32 s3, 2
    s_waitcnt vmcnt(3)
    v_or3_b32 v3, v60, v61, v62
    v_or3_b32 v3, v63, v64, v3
    v_mfma_f32_16x16x32_bf16 v[72:75], v[60:63], v[52:55], 0
    v_or3_b32 v3, v65, v66, v3
    v_mfma_f32_16x16x32_bf16 v[76:79], v[60:63], v[56:59], 0
    v_or3_b32 v3, v67, v68, v3
    v_smfmac_f32_16x16x64_bf16 v[72:75], v[64:67], v[80:87], v2
    v_or3_b32 v3, v69, v70, v3
    v_smfmac_f32_16x16x64_bf16 v[76:79], v[64:67], v[96:103], v2
    v_or_b32 v3, v71, v3
    v_smfmac_f32_16x16x64_bf16 v[72:75], v[68:71], v[88:95], v2
    v_cmp_gt_i32 vcc, 0, v3
    v_smfmac_f32_16x16x64_bf16 v[76:79], v[68:71], v[104:111], v2
    s_cbranch_vccnz pr_93
    s_nop 4
    v_pk_add_f32 v[72:73], v[72:73], v[74:75]
    s_nop 0
    v_pk_add_f32 v[76:77], v[76:77], v[78:79]
    ds_write2_b32 v8, v72, v73 offset0:0 offset1:16
    ds_write2_b32 v15, v76, v77 offset0:0 offset1:16
    s_cbranch_scc0 nr_95
    s_waitcnt lgkmcnt(0)
    s_barrier
    ds_read_b64 v[112:113], v9 offset:0
    ds_read_b64 v[114:115], v9 offset:512
    ds_read_b64 v[116:117], v9 offset:1024
    ds_read_b64 v[118:119], v9 offset:1536
    s_waitcnt lgkmcnt(2)
    v_pk_add_f32 v[112:113], v[112:113], v[114:115]
    s_waitcnt lgkmcnt(0)
    v_pk_add_f32 v[116:117], v[116:117], v[118:119]
    v_pk_add_f32 v[112:113], v[112:113], v[116:117]
    v_cvt_pk_bf16_f32 v112, v112, v113
    v_min_u32 v112, -2, v112
    buffer_store_dword v112, v11, s[8:11], s42 offen
    s_barrier
    s_mov_b32 s40, 0xe9fc00
jr_96:
    s_add_u32 s12, s12, 1
    s_cmp_lt_u32 s12, 63
    s_cbranch_scc1 cloopF
    buffer_store_dword v112, v11, s[8:11], s40 offen sc1
    s_endpgm
dq_86:
    s_add_u32 s31, s12, 1
    s_mov_b32 s14, 0
dw_97:
    buffer_load_dword v18, off, s[8:11], s49 sc1
    s_waitcnt vmcnt(0)
    v_readfirstlane_b32 s29, v18
    s_cmp_le_u32 s29, s31
    s_cbranch_scc0 dk_98
    s_sleep 1
    s_add_u32 s14, s14, 1
    s_cmp_lt_u32 s14, 200000
    s_cbranch_scc1 dw_97
    s_endpgm
dk_98:
    s_branch db_87
d0_91:
    s_waitcnt vmcnt(0)
    v_and_b32 v18, 1, v0
    v_lshlrev_b32 v18, 2, v18
    v_bfe_u32 v80, v0, 1, 1
    v_lshl_add_u32 v80, v80, 7, v18
    s_lshl_b32 s31, s4, 3
    s_add_u32 s31, s31, 0xf80000
    s_mov_b32 s14, 0
dz_99:
    buffer_load_dword v18, v80, s[8:11], s31 offen sc1
    s_add_u32 s14, s14, 1
    s_cmp_lt_u32 s14, 200000
    s_cbranch_scc0 tdie
    s_waitcnt vmcnt(0)
    v_cmp_eq_u32 vcc, 0, v18
    s_cbranch_vccnz dz_99
    s_xor_b32 s31, s37, 0x18000
    s_add_u32 m0, s31, 0
    s_add_u32 s31, s35, -458752
    buffer_load_dwordx4 v1, s[8:11], s31 offen offset:0 sc1 lds
    buffer_load_dwordx4 v1, s[8:11], s31 offen offset:1024 sc1 lds
    buffer_load_dwordx4 v1, s[8:11], s31 offen offset:2048 sc1 lds
    buffer_load_dwordx4 v1, s[8:11], s31 offen offset:3072 sc1 lds
    s_xor_b32 s31, s37, 0x18000
    s_add_u32 m0, s31, 16384
    s_add_u32 s31, s35, -442368
    buffer_load_dwordx4 v1, s[8:11], s31 offen offset:0 sc1 lds
    buffer_load_dwordx4 v1, s[8:11], s31 offen offset:1024 sc1 lds
    buffer_load_dwordx4 v1, s[8:11], s31 offen offset:2048 sc1 lds
    buffer_load_dwordx4 v1, s[8:11], s31 offen offset:3072 sc1 lds
    s_mov_b32 s31, s37
    s_add_u32 m0, s31, 0
    s_add_u32 s31, s35, 0
    buffer_load_dwordx4 v1, s[8:11], s31 offen offset:0 sc1 lds
    buffer_load_dwordx4 v1, s[8:11], s31 offen offset:1024 sc1 lds
    buffer_load_dwordx4 v1, s[8:11], s31 offen offset:2048 sc1 lds
    buffer_load_dwordx4 v1, s[8:11], s31 offen offset:3072 sc1 lds
    s_mov_b32 s31, s37
    s_add_u32 m0, s31, 16384
    s_add_u32 s31, s35, 16384
    buffer_load_dwordx4 v1, s[8:11], s31 offen offset:0 sc1 lds
    buffer_load_dwordx4 v1, s[8:11], s31 offen offset:1024 sc1 lds
    buffer_load_dwordx4 v1, s[8:11], s31 offen offset:2048 sc1 lds
    buffer_load_dwordx4 v1, s[8:11], s31 offen offset:3072 sc1 lds
    buffer_load_dword v18, off, s[8:11], s49 sc1
    s_waitcnt vmcnt(9)
    s_mov_b32 s7, 0
    s_branch d1_92
nr_95:
    s_waitcnt lgkmcnt(0)
    s_barrier
    s_barrier
    s_branch jr_96
.p2align 6
sloopS:
    v_mov_b32 v37, 0
    v_mov_b32 v38, 0
    v_mov_b32 v39, 0
    v_mov_b32 v40, 0
    v_mov_b32 v41, 0
    v_mov_b32 v42, 0
    v_mov_b32 v43, 0
    v_mov_b32 v44, 0
    v_mov_b32 v45, 0
    v_mov_b32 v46, 0
    v_mov_b32 v47, 0
    v_mov_b32 v108, 0
    v_mov_b32 v109, 0
    v_mov_b32 v110, 0
    v_mov_b32 v111, 0
    v_mov_b32 v112, 0
    v_mov_b32 v113, 0
    v_mov_b32 v114, 0
    v_mov_b32 v115, 0
    v_mov_b32 v116, 0
    v_mov_b32 v117, 0
    v_mov_b32 v118, 0
    v_mov_b32 v119, 0
    v_add_u32 v102, s17, v1
    v_add_u32 v103, s18, v1
    v_add_u32 v104, s19, v1
    v_add_u32 v105, s20, v1
    v_add_u32 v106, s21, v1
    v_mov_b32 v48, -1
    v_mov_b32 v49, -1
    v_mov_b32 v50, -1
    v_mov_b32 v51, -1
    v_mov_b32 v52, -1
    v_mov_b32 v53, -1
    v_mov_b32 v54, -1
    v_mov_b32 v55, -1
    s_waitcnt vmcnt(0)
    s_mov_b32 s14, 0
.p2align 6
mf_101:
    buffer_load_dwordx4 v[48:51], v1, s[8:11], s32 offen sc1
    buffer_load_dwordx4 v[52:55], v1, s[8:11], s33 offen sc1
    s_add_u32 s14, s14, 1
    s_cmp_lt_u32 s14, 200000
    s_cbranch_scc0 tdie
mp_100:
    s_waitcnt vmcnt(4)
    v_max3_u32 v3, v48, v49, v50
    v_max3_u32 v100, v51, v52, v53
    v_max3_u32 v3, v54, v55, v3
    v_max_u32 v3, v100, v3
    v_cmp_eq_u32 vcc, -1, v3
    s_cbranch_vccnz mf_101
mo_102:
    v_smfmac_f32_16x16x64_bf16 v[20:23], v[48:51], a[0:7], v2
    ds_write_b128 v16, v[48:51]
    v_smfmac_f32_16x16x64_bf16 v[24:27], v[48:51], a[8:15], v2
    ds_write_b128 v17, v[52:55]
    v_smfmac_f32_16x16x64_bf16 v[20:23], v[52:55], a[16:23], v2
    v_smfmac_f32_16x16x64_bf16 v[24:27], v[52:55], a[24:31], v2
    v_smfmac_f32_16x16x64_bf16 v[28:31], v[48:51], a[32:39], v2
    v_smfmac_f32_16x16x64_bf16 v[32:35], v[48:51], a[40:47], v2
    s_waitcnt lgkmcnt(0)
    s_barrier
    ds_read_b128 v[56:59], v102
    v_smfmac_f32_16x16x64_bf16 v[28:31], v[52:55], a[48:55], v2
    ds_read_b128 v[60:63], v103
    v_smfmac_f32_16x16x64_bf16 v[32:35], v[52:55], a[56:63], v2
    ds_read_b128 v[64:67], v104
    v_smfmac_f32_16x16x64_bf16 v[36:39], v[48:51], a[64:71], v2
    ds_read_b128 v[68:71], v105
    v_smfmac_f32_16x16x64_bf16 v[40:43], v[48:51], a[72:79], v2
    ds_read_b128 v[72:75], v106
    v_smfmac_f32_16x16x64_bf16 v[44:47], v[48:51], a[80:87], v2
    buffer_load_dword v18, off, s[8:11], s49 sc1
    v_smfmac_f32_16x16x64_bf16 v[36:39], v[52:55], a[88:95], v2
    buffer_load_dword v19, v7, s[8:11], s38 offen
    v_smfmac_f32_16x16x64_bf16 v[40:43], v[52:55], a[96:103], v2
    ds_read_b128 v[76:79], v6 offset:0
    v_smfmac_f32_16x16x64_bf16 v[44:47], v[52:55], a[104:111], v2
    ds_read_b128 v[80:83], v6 offset:1024
    s_waitcnt lgkmcnt(6)
    v_smfmac_f32_16x16x64_bf16 v[20:23], v[56:59], a[112:119], v2
    ds_read_b128 v[84:87], v6 offset:16
    v_smfmac_f32_16x16x64_bf16 v[24:27], v[56:59], a[120:127], v2
    ds_read_b128 v[88:91], v6 offset:1040
    v_smfmac_f32_16x16x64_bf16 v[28:31], v[56:59], a[128:135], v2
    ds_read2_b32 v[92:93], v8 offset0:0 offset1:8
    v_smfmac_f32_16x16x64_bf16 v[32:35], v[56:59], a[136:143], v2
    ds_read2_b32 v[94:95], v8 offset0:1 offset1:9
    v_smfmac_f32_16x16x64_bf16 v[36:39], v[56:59], a[144:151], v2
    ds_read2_b32 v[96:97], v8 offset0:128 offset1:136
    v_smfmac_f32_16x16x64_bf16 v[40:43], v[56:59], a[152:159], v2
    ds_read2_b32 v[98:99], v8 offset0:129 offset1:137
    v_smfmac_f32_16x16x64_bf16 v[44:47], v[56:59], a[160:167], v2
    s_waitcnt vmcnt(2)
    ds_read2_b32 v[48:49], v9 offset0:0 offset1:8
    s_and_b32 s30, s12, 3
    s_mul_i32 s22, s30, 10240
    s_waitcnt lgkmcnt(9)
    v_smfmac_f32_16x16x64_bf16 v[20:23], v[60:63], a[168:175], v2
    ds_read2_b32 v[50:51], v9 offset0:1 offset1:9
    s_add_u32 s22, s22, 0xe27000
    s_add_u32 s32, s32, 7168
    v_smfmac_f32_16x16x64_bf16 v[20:23], v[64:67], a[176:183], v2
    ds_read2_b32 v[52:53], v9 offset0:128 offset1:136
    s_add_u32 s33, s33, 7168
    s_add_u32 s31, s12, 3
    v_smfmac_f32_16x16x64_bf16 v[20:23], v[68:71], a[184:191], v2
    ds_read2_b32 v[54:55], v9 offset0:129 offset1:137
    s_and_b32 s31, s31, 3
    s_mul_i32 s24, s31, 10240
    v_smfmac_f32_16x16x64_bf16 v[20:23], v[72:75], a[192:199], v2
    s_add_u32 s24, s24, s27
    s_min_u32 s24, s24, 0x8000000
    v_smfmac_f32_16x16x64_bf16 v[24:27], v[60:63], a[200:207], v2
    v_smfmac_f32_16x16x64_bf16 v[24:27], v[64:67], a[208:215], v2
    v_smfmac_f32_16x16x64_bf16 v[24:27], v[68:71], a[216:223], v2
    v_smfmac_f32_16x16x64_bf16 v[24:27], v[72:75], a[224:231], v2
    v_add_f32 v20, v20, v22
    v_smfmac_f32_16x16x64_bf16 v[28:31], v[60:63], a[232:239], v2
    v_add_f32 v21, v21, v23
    v_smfmac_f32_16x16x64_bf16 v[28:31], v[64:67], a[240:247], v2
    v_cvt_pk_bf16_f32 v20, v20, v21
    v_smfmac_f32_16x16x64_bf16 v[28:31], v[68:71], a[248:255], v2
    ds_write_b32 v4, v20 offset:0
    v_smfmac_f32_16x16x64_bf16 v[28:31], v[72:75], v[120:127], v2
    v_add_f32 v24, v24, v26
    v_smfmac_f32_16x16x64_bf16 v[32:35], v[60:63], v[128:135], v2
    v_add_f32 v25, v25, v27
    v_smfmac_f32_16x16x64_bf16 v[32:35], v[64:67], v[136:143], v2
    v_cvt_pk_bf16_f32 v24, v24, v25
    v_smfmac_f32_16x16x64_bf16 v[32:35], v[68:71], v[144:151], v2
    ds_write_b32 v4, v24 offset:256
    v_smfmac_f32_16x16x64_bf16 v[32:35], v[72:75], v[152:159], v2
    ds_read_b128 v[20:23], v6 offset:2048
    v_add_f32 v28, v28, v30
    v_smfmac_f32_16x16x64_bf16 v[36:39], v[60:63], v[160:167], v2
    ds_read_b128 v[24:27], v6 offset:3072
    v_add_f32 v29, v29, v31
    v_smfmac_f32_16x16x64_bf16 v[36:39], v[64:67], v[168:175], v2
    v_cvt_pk_bf16_f32 v28, v28, v29
    v_smfmac_f32_16x16x64_bf16 v[36:39], v[68:71], v[176:183], v2
    ds_write_b32 v4, v28 offset:512
    v_smfmac_f32_16x16x64_bf16 v[36:39], v[72:75], v[184:191], v2
    v_add_f32 v32, v32, v34
    v_smfmac_f32_16x16x64_bf16 v[40:43], v[60:63], v[192:199], v2
    v_add_f32 v33, v33, v35
    v_smfmac_f32_16x16x64_bf16 v[40:43], v[64:67], v[200:207], v2
    v_cvt_pk_bf16_f32 v32, v32, v33
    v_smfmac_f32_16x16x64_bf16 v[40:43], v[68:71], v[208:215], v2
    ds_write_b32 v4, v32 offset:768
    v_smfmac_f32_16x16x64_bf16 v[40:43], v[72:75], v[216:223], v2
    ds_read_b64_tr_b16 v[100:101], v5
    v_add_f32 v36, v36, v38
    v_smfmac_f32_16x16x64_bf16 v[44:47], v[60:63], v[224:231], v2
    ds_read_b64_tr_b16 v[102:103], v5 offset:128
    v_add_f32 v37, v37, v39
    v_smfmac_f32_16x16x64_bf16 v[44:47], v[64:67], v[232:239], v2
    ds_read_b128 v[28:31], v6 offset:2064
    v_cvt_pk_bf16_f32 v36, v36, v37
    v_smfmac_f32_16x16x64_bf16 v[44:47], v[68:71], v[240:247], v2
    ds_write_b32 v4, v36 offset:1024
    v_smfmac_f32_16x16x64_bf16 v[44:47], v[72:75], v[248:255], v2
    ds_read_b128 v[32:35], v6 offset:3088
    v_add_f32 v40, v40, v42
    v_add_f32 v41, v41, v43
    v_cvt_pk_bf16_f32 v40, v40, v41
    ds_write_b32 v4, v40 offset:1280
    s_cmp_lt_u32 s3, 2
    s_nop 1
    v_pk_add_f32 v[44:45], v[44:45], v[46:47]
    v_cvt_pk_bf16_f32 v44, v44, v45
    ds_write_b32 v4, v44 offset:1536
    ds_read_b64_tr_b16 v[104:105], v5 offset:1024
    ds_read_b64_tr_b16 v[106:107], v5 offset:1152
    s_waitcnt lgkmcnt(7)
    v_smfmac_f32_16x16x64_bf16 v[108:111], v[100:103], v[76:83], v2
    v_smfmac_f32_16x16x64_bf16 v[112:115], v[100:103], v[84:91], v2
    v_smfmac_f32_16x16x64_bf16 v[116:119], v[100:103], v[92:99], v2
    s_waitcnt lgkmcnt(0)
    v_smfmac_f32_16x16x64_bf16 v[108:111], v[104:107], v[20:27], v2
    v_smfmac_f32_16x16x64_bf16 v[112:115], v[104:107], v[28:35], v2
    v_smfmac_f32_16x16x64_bf16 v[116:119], v[104:107], v[48:55], v2
    s_cbranch_scc0 ns_103
    s_cmp_eq_u32 s3, 0
    s_cbranch_scc0 w1_105
    s_nop 2
    v_add_f32 v80, v109, v111
    v_add_f32 v76, v108, v110
    v_add_f32 v81, v113, v115
    v_add_f32 v77, v112, v114
    v_add_f32 v82, v117, v119
    ds_write_b96 v10, v[80:82] offset:4096
    v_add_f32 v78, v116, v118
sm_106:
    v_mov_b32 v20, 0
    v_mov_b32 v21, 0
    v_mov_b32 v22, 0
    v_mov_b32 v23, 0
    v_mov_b32 v24, 0
    v_mov_b32 v25, 0
    s_waitcnt lgkmcnt(0)
    v_mov_b32 v26, 0
    s_barrier
    ds_read_b128 v[80:83], v11 offset:0
    ds_read_b128 v[84:87], v11 offset:1024
    ds_read_b128 v[88:91], v11 offset:2048
    v_mov_b32 v27, 0
    v_mov_b32 v28, 0
    v_mov_b32 v29, 0
    v_mov_b32 v30, 0
    v_mov_b32 v31, 0
    v_mov_b32 v32, 0
    v_mov_b32 v33, 0
    v_mov_b32 v34, 0
    v_mov_b32 v35, 0
    v_mov_b32 v36, 0
    s_waitcnt lgkmcnt(2)
    v_pk_add_f32 v[76:77], v[76:77], v[80:81]
    v_add_f32 v78, v78, v82
    s_waitcnt lgkmcnt(0)
    v_pk_add_f32 v[84:85], v[84:85], v[88:89]
    v_add_f32 v86, v86, v90
    v_pk_add_f32 v[76:77], v[76:77], v[84:85]
    v_add_f32 v78, v78, v86
    v_max3_f32 v84, v76, v77, v78
    v_sub_f32 v76, v76, v84
    v_sub_f32 v77, v77, v84
    v_max_f32_dpp v85, v84, v84 quad_perm:[1,0,3,2] row_mask:0xf bank_mask:0xf
    v_sub_f32 v78, v78, v84
    v_exp_f32 v76, v76
    v_max_f32_dpp v85, v85, v85 quad_perm:[2,3,0,1] row_mask:0xf bank_mask:0xf
    v_exp_f32 v77, v77
    s_nop 0
    v_max_f32_dpp v85, v85, v85 row_half_mirror row_mask:0xf bank_mask:0xf
    v_exp_f32 v78, v78
    v_add_f32 v86, v76, v77
    v_max_f32_dpp v85, v85, v85 row_mirror row_mask:0xf bank_mask:0xf
    v_sub_f32 v84, v84, v85
    v_exp_f32 v84, v84
    v_fmac_f32 v86, v78, v14
    v_mul_f32 v86, v86, v84
    v_mul_f32 v76, v76, v84
    v_mul_f32 v77, v77, v84
    v_add_f32_dpp v86, v86, v86 quad_perm:[1,0,3,2] row_mask:0xf bank_mask:0xf
    v_mul_f32 v78, v78, v84
    s_nop 0
    v_add_f32_dpp v86, v86, v86 quad_perm:[2,3,0,1] row_mask:0xf bank_mask:0xf
    s_nop 1
    v_add_f32_dpp v86, v86, v86 row_half_mirror row_mask:0xf bank_mask:0xf
    s_nop 1
    v_add_f32_dpp v86, v86, v86 row_mirror row_mask:0xf bank_mask:0xf
    v_rcp_f32 v86, v86
    s_nop 0
    v_mul_f32 v76, v76, v86
    v_mul_f32 v77, v77, v86
    v_cvt_pk_bf16_f32 v88, |v76|, |v77|
    buffer_store_dword v88, v12, s[8:11], s22 offen sc1
    v_mul_f32_dpp v79, v78, v86 row_shl:4 row_mask:0xf bank_mask:0xf bound_ctrl:0
    v_mul_f32 v78, v78, v86
    v_cvt_pk_bf16_f32 v90, |v78|, |v79|
    buffer_store_dword v90, v13, s[8:11], s22 offen sc1
    s_waitcnt vmcnt(3)
    s_barrier
    s_mov_b32 m0, s36
    s_add_u32 s30, s34, 4096
    buffer_load_dwordx4 v1, s[8:11], s34 offen offset:0 sc1 lds
    buffer_load_dwordx4 v1, s[8:11], s34 offen offset:1024 sc1 lds
    buffer_load_dwordx4 v1, s[8:11], s34 offen offset:2048 sc1 lds
    buffer_load_dwordx4 v1, s[8:11], s34 offen offset:3072 sc1 lds
    s_add_u32 m0, s36, 4096
    s_add_u32 s34, s34, 28672
    buffer_load_dwordx4 v1, s[8:11], s30 offen offset:0 sc1 lds
    buffer_load_dwordx4 v1, s[8:11], s30 offen offset:1024 sc1 lds
    buffer_load_dwordx4 v1, s[8:11], s30 offen offset:2048 sc1 lds
jn_104:
    v_add_u32 v7, 28672, v7
    s_mov_b64 exec, s[62:63]
    v_add_u32 v7, 430080, v7
    s_mov_b64 exec, -1
    s_add_u32 s31, s12, 3
    v_readfirstlane_b32 s29, v18
    s_cmp_le_u32 s29, s31
    s_cselect_b32 s38, 0x8000000, 0
    s_cmp_gt_u32 s31, 62
    s_cselect_b32 s38, 0x8000000, s38
    s_add_u32 s12, s12, 1
    s_cmp_lt_u32 s12, 63
    s_cbranch_scc1 sloopS
    s_endpgm
ns_103:
    s_nop 4
    v_add_f32 v76, v108, v110
    v_add_f32 v80, v109, v111
    v_add_f32 v77, v112, v114
    v_add_f32 v81, v113, v115
    v_add_f32 v78, v116, v118
    v_add_f32 v82, v117, v119
    ds_write_b96 v10, v[76:78] offset:0
    ds_write_b96 v10, v[80:82] offset:4096
    v_mov_b32 v92, -1
    v_mov_b32 v93, -1
    v_mov_b32 v94, -1
    v_mov_b32 v95, -1
    s_waitcnt lgkmcnt(0)
    s_barrier
    buffer_store_dwordx4 v[92:95], v1, s[8:11], s24 offen sc1
    s_waitcnt vmcnt(2)
    s_barrier
    s_mov_b32 m0, s36
    s_add_u32 s30, s34, 4096
    buffer_load_dwordx4 v1, s[8:11], s34 offen offset:0 sc1 lds
    buffer_load_dwordx4 v1, s[8:11], s34 offen offset:1024 sc1 lds
    buffer_load_dwordx4 v1, s[8:11], s34 offen offset:2048 sc1 lds
    buffer_load_dwordx4 v1, s[8:11], s34 offen offset:3072 sc1 lds
    s_add_u32 m0, s36, 4096
    s_add_u32 s34, s34, 28672
    buffer_load_dwordx4 v1, s[8:11], s30 offen offset:0 sc1 lds
    buffer_load_dwordx4 v1, s[8:11], s30 offen offset:1024 sc1 lds
    buffer_load_dwordx4 v1, s[8:11], s30 offen offset:2048 sc1 lds
    v_mov_b32 v20, 0
    v_mov_b32 v21, 0
    v_mov_b32 v22, 0
    v_mov_b32 v23, 0
    v_mov_b32 v24, 0
    v_mov_b32 v25, 0
    v_mov_b32 v26, 0
    v_mov_b32 v27, 0
    v_mov_b32 v28, 0
    v_mov_b32 v29, 0
    v_mov_b32 v30, 0
    v_mov_b32 v31, 0
    v_mov_b32 v32, 0
    v_mov_b32 v33, 0
    v_mov_b32 v34, 0
    v_mov_b32 v35, 0
    v_mov_b32 v36, 0
    s_branch jn_104
w1_105:
    s_nop 2
    v_add_f32 v80, v108, v110
    v_add_f32 v76, v109, v111
    v_add_f32 v81, v112, v114
    v_add_f32 v77, v113, v115
    v_add_f32 v82, v116, v118
    ds_write_b96 v10, v[80:82] offset:0
    v_add_f32 v78, v117, v119
    s_branch sm_106
.p2align 6
cloopS:
    s_xor_b32 s37, s37, 0x18000
    s_cmp_lg_u32 s13, 0
    s_cbranch_scc1 dq_107
db_108:
    s_mov_b32 m0, s37
    s_nop 0
    v_mov_b32 v20, 0
    v_mov_b32 v21, 0
    v_mov_b32 v22, 0
    v_mov_b32 v23, 0
    v_mov_b32 v24, 0
    v_mov_b32 v25, 0
    v_mov_b32 v26, 0
    v_mov_b32 v27, 0
    v_mov_b32 v28, 0
    v_mov_b32 v29, 0
    v_mov_b32 v30, 0
    v_mov_b32 v31, 0
    v_mov_b32 v32, 0
    v_mov_b32 v33, 0
    v_mov_b32 v34, 0
    v_mov_b32 v35, 0
    v_mov_b32 v36, 0
    v_mov_b32 v37, 0
    v_mov_b32 v38, 0
    v_mov_b32 v39, 0
    v_mov_b32 v40, 0
    v_mov_b32 v41, 0
    v_mov_b32 v42, 0
    v_mov_b32 v43, 0
    v_mov_b32 v44, 0
    v_mov_b32 v45, 0
    v_mov_b32 v46, 0
    v_mov_b32 v47, 0
    v_mov_b32 v48, 0
    v_mov_b32 v49, 0
    v_mov_b32 v50, 0
    v_mov_b32 v51, 0
    v_mov_b32 v52, -1
    v_mov_b32 v53, -1
    v_mov_b32 v54, -1
    v_mov_b32 v55, -1
    v_mov_b32 v56, -1
    v_mov_b32 v57, -1
    v_mov_b32 v58, -1
    v_mov_b32 v59, -1
    s_waitcnt vmcnt(0)
    s_mov_b32 s14, 0
.p2align 6
mf_110:
    buffer_load_dwordx4 v[52:55], v1, s[8:11], s32 offen sc1
    buffer_load_dwordx4 v[56:59], v1, s[8:11], s33 offen sc1
    s_add_u32 s14, s14, 1
    s_cmp_lt_u32 s14, 200000
    s_cbranch_scc0 tdie
mp_109:
    s_waitcnt vmcnt(0)
    v_max3_u32 v3, v52, v53, v54
    v_max3_u32 v19, v55, v56, v57
    v_max3_u32 v3, v58, v59, v3
    v_max_u32 v3, v19, v3
    v_cmp_eq_u32 vcc, -1, v3
    s_cbranch_vccnz mf_110
mo_111:
    v_smfmac_f32_16x16x64_bf16 v[20:23], v[52:55], a[0:7], v2
    ds_write_b128 v16, v[52:55]
    v_smfmac_f32_16x16x64_bf16 v[24:27], v[52:55], a[8:15], v2
    ds_write_b128 v17, v[56:59]
    v_smfmac_f32_16x16x64_bf16 v[28:31], v[52:55], a[16:23], v2
    v_smfmac_f32_16x16x64_bf16 v[32:35], v[52:55], a[24:31], v2
    v_smfmac_f32_16x16x64_bf16 v[36:39], v[52:55], a[32:39], v2
    v_smfmac_f32_16x16x64_bf16 v[40:43], v[52:55], a[40:47], v2
    s_waitcnt lgkmcnt(0)
    s_barrier
    ds_read_b128 v[60:63], v4
    v_smfmac_f32_16x16x64_bf16 v[44:47], v[52:55], a[48:55], v2
    ds_read_b128 v[64:67], v5
    v_smfmac_f32_16x16x64_bf16 v[48:51], v[52:55], a[56:63], v2
    ds_read_b128 v[68:71], v7
    v_smfmac_f32_16x16x64_bf16 v[20:23], v[56:59], a[64:71], v2
    ds_read_b128 v[72:75], v12
    s_and_b32 s30, s12, 3
    s_mul_i32 s22, s30, 10240
    v_smfmac_f32_16x16x64_bf16 v[24:27], v[56:59], a[72:79], v2
    ds_read_b128 v[76:79], v13
    s_add_u32 s22, s22, 0xe27000
    s_add_u32 s32, s32, 7168
    v_smfmac_f32_16x16x64_bf16 v[28:31], v[56:59], a[80:87], v2
    buffer_load_dword v18, off, s[8:11], s49 sc1
    s_add_u32 s33, s33, 7168
    s_lshl_b32 s31, s3, 11
    v_smfmac_f32_16x16x64_bf16 v[32:35], v[56:59], a[88:95], v2
    s_add_u32 s43, s22, s31
    s_sub_u32 s42, s32, s15
    v_smfmac_f32_16x16x64_bf16 v[36:39], v[56:59], a[96:103], v2
    buffer_load_dwordx4 v1, s[8:11], s38 offen offset:0 sc1 lds
    s_xor_b32 s30, s37, 0x18000
    v_smfmac_f32_16x16x64_bf16 v[40:43], v[56:59], a[104:111], v2
    v_smfmac_f32_16x16x64_bf16 v[44:47], v[56:59], a[112:119], v2
    v_smfmac_f32_16x16x64_bf16 v[48:51], v[56:59], a[120:127], v2
    s_waitcnt lgkmcnt(4)
    v_smfmac_f32_16x16x64_bf16 v[20:23], v[60:63], a[128:135], v2
    buffer_load_dwordx4 v1, s[8:11], s38 offen offset:1024 sc1 lds
    v_smfmac_f32_16x16x64_bf16 v[24:27], v[60:63], a[136:143], v2
    ds_read_b128 v[80:83], v14 offset:0
    v_smfmac_f32_16x16x64_bf16 v[28:31], v[60:63], a[144:151], v2
    ds_read_b128 v[84:87], v14 offset:1024
    v_smfmac_f32_16x16x64_bf16 v[32:35], v[60:63], a[152:159], v2
    ds_read_b128 v[88:91], v14 offset:2048
    v_smfmac_f32_16x16x64_bf16 v[36:39], v[60:63], a[160:167], v2
    buffer_load_dwordx4 v1, s[8:11], s38 offen offset:2048 sc1 lds
    v_add_u32 v15, s30, v1
    v_smfmac_f32_16x16x64_bf16 v[40:43], v[60:63], a[168:175], v2
    ds_read_b128 v[92:95], v14 offset:3072
    v_lshrrev_b32 v3, 4, v0
    v_smfmac_f32_16x16x64_bf16 v[44:47], v[60:63], a[176:183], v2
    ds_read_b128 v[96:99], v14 offset:4096
    v_lshl_add_u32 v3, v3, 2, s48
    v_smfmac_f32_16x16x64_bf16 v[48:51], v[60:63], a[184:191], v2
    ds_read_b128 v[100:103], v14 offset:5120
    v_and_b32 v19, 15, v0
    s_waitcnt lgkmcnt(6)
    v_smfmac_f32_16x16x64_bf16 v[20:23], v[64:67], a[192:199], v2
    buffer_load_dwordx4 v1, s[8:11], s38 offen offset:3072 sc1 lds
    s_add_u32 m0, s37, 16384
    v_lshl_add_u32 v19, v19, 4, v3
    v_smfmac_f32_16x16x64_bf16 v[24:27], v[64:67], a[200:207], v2
    ds_read_b128 v[104:107], v14 offset:6144
    v_add_u32 v3, s48, v1
    v_smfmac_f32_16x16x64_bf16 v[28:31], v[64:67], a[208:215], v2
    ds_read_b128 v[108:111], v14 offset:7168
    v_smfmac_f32_16x16x64_bf16 v[32:35], v[64:67], a[216:223], v2
    ds_read_b128 v[112:115], v14 offset:8192
    v_smfmac_f32_16x16x64_bf16 v[36:39], v[64:67], a[224:231], v2
    buffer_load_dwordx4 v1, s[8:11], s6 offen offset:0 sc1 lds
    v_smfmac_f32_16x16x64_bf16 v[40:43], v[64:67], a[232:239], v2
    ds_read_b128 v[116:119], v14 offset:9216
    v_smfmac_f32_16x16x64_bf16 v[44:47], v[64:67], a[240:247], v2
    s_waitcnt vmcnt(6)
    ds_read_b128 v[52:55], v14 offset:10240
    v_smfmac_f32_16x16x64_bf16 v[48:51], v[64:67], a[248:255], v2
    ds_read_b128 v[56:59], v14 offset:11264
    v_smfmac_f32_16x16x64_bf16 v[20:23], v[68:71], v[120:127], v2
    buffer_load_dwordx4 v1, s[8:11], s6 offen offset:1024 sc1 lds
    v_smfmac_f32_16x16x64_bf16 v[20:23], v[72:75], v[128:135], v2
    ds_read_b128 v[60:63], v14 offset:12288
    v_smfmac_f32_16x16x64_bf16 v[20:23], v[76:79], v[136:143], v2
    ds_read_b128 v[64:67], v14 offset:13312
    v_smfmac_f32_16x16x64_bf16 v[24:27], v[68:71], v[144:151], v2
    v_smfmac_f32_16x16x64_bf16 v[24:27], v[72:75], v[152:159], v2
    buffer_load_dwordx4 v1, s[8:11], s6 offen offset:2048 sc1 lds
    v_smfmac_f32_16x16x64_bf16 v[24:27], v[76:79], v[160:167], v2
    v_smfmac_f32_16x16x64_bf16 v[28:31], v[68:71], v[168:175], v2
    v_add_f32 v20, v20, v22
    v_smfmac_f32_16x16x64_bf16 v[28:31], v[72:75], v[176:183], v2
    v_add_f32 v21, v21, v23
    v_smfmac_f32_16x16x64_bf16 v[28:31], v[76:79], v[184:191], v2
    buffer_load_dwordx4 v1, s[8:11], s6 offen offset:3072 sc1 lds
    v_cvt_pk_bf16_f32 v20, v20, v21
    v_smfmac_f32_16x16x64_bf16 v[32:35], v[68:71], v[192:199], v2
    ds_write_b32 v19, v20 offset:0
    v_add_f32 v24, v24, v26
    v_smfmac_f32_16x16x64_bf16 v[32:35], v[72:75], v[200:207], v2
    v_add_f32 v25, v25, v27
    v_smfmac_f32_16x16x64_bf16 v[32:35], v[76:79], v[208:215], v2
    v_cvt_pk_bf16_f32 v24, v24, v25
    v_smfmac_f32_16x16x64_bf16 v[36:39], v[68:71], v[216:223], v2
    ds_write_b32 v19, v24 offset:256
    v_add_f32 v28, v28, v30
    v_smfmac_f32_16x16x64_bf16 v[36:39], v[72:75], v[224:231], v2
    v_add_f32 v29, v29, v31
    v_smfmac_f32_16x16x64_bf16 v[36:39], v[76:79], v[232:239], v2
    v_cvt_pk_bf16_f32 v28, v28, v29
    v_smfmac_f32_16x16x64_bf16 v[40:43], v[68:71], v[240:247], v2
    ds_write_b32 v19, v28 offset:512
    v_add_f32 v32, v32, v34
    v_smfmac_f32_16x16x64_bf16 v[40:43], v[72:75], v[248:255], v2
    v_add_f32 v33, v33, v35
    s_waitcnt lgkmcnt(3)
    v_smfmac_f32_16x16x64_bf16 v[40:43], v[76:79], v[80:87], v2
    v_cvt_pk_bf16_f32 v32, v32, v33
    v_smfmac_f32_16x16x64_bf16 v[44:47], v[68:71], v[88:95], v2
    ds_write_b32 v19, v32 offset:768
    v_add_f32 v36, v36, v38
    v_smfmac_f32_16x16x64_bf16 v[44:47], v[72:75], v[96:103], v2
    v_add_f32 v37, v37, v39
    v_smfmac_f32_16x16x64_bf16 v[44:47], v[76:79], v[104:111], v2
    v_cvt_pk_bf16_f32 v36, v36, v37
    v_smfmac_f32_16x16x64_bf16 v[48:51], v[68:71], v[112:119], v2
    ds_write_b32 v19, v36 offset:1024
    v_add_f32 v40, v40, v42
    v_smfmac_f32_16x16x64_bf16 v[48:51], v[72:75], v[52:59], v2
    v_add_f32 v41, v41, v43
    v_smfmac_f32_16x16x64_bf16 v[48:51], v[76:79], v[60:67], v2
    v_cvt_pk_bf16_f32 v40, v40, v41
    s_cmp_eq_u32 s7, 1
    s_cbranch_scc1 d0_112
d1_113:
    ds_read_b128 v[80:83], v15 offset:0
    ds_read_b128 v[84:87], v15 offset:1024
    ds_read_b128 v[88:91], v15 offset:2048
    ds_read_b128 v[92:95], v15 offset:3072
    ds_read_b128 v[96:99], v15 offset:16384
    ds_read_b128 v[100:103], v15 offset:17408
    ds_read_b128 v[104:107], v15 offset:18432
    ds_read_b128 v[108:111], v15 offset:19456
    buffer_load_dwordx4 v[60:63], v6, s[8:11], s43 offen offset:0 sc1
    buffer_load_dwordx4 v[64:67], v10, s[8:11], s43 offen offset:0 sc1
    buffer_load_dwordx4 v[68:71], v10, s[8:11], s43 offen offset:1024 sc1
    ds_write_b32 v19, v40 offset:1280
    v_add_f32 v44, v44, v46
    v_add_f32 v45, v45, v47
    v_cvt_pk_bf16_f32 v44, v44, v45
    ds_write_b32 v19, v44 offset:1536
    v_add_f32 v48, v48, v50
    v_add_f32 v49, v49, v51
    v_cvt_pk_bf16_f32 v48, v48, v49
    ds_write_b32 v19, v48 offset:1792
    ds_read_b128 v[52:55], v3
    ds_read_b128 v[56:59], v3 offset:1024
    v_add_u32 v15, 2048, v8
    s_waitcnt vmcnt(3)
    s_add_u32 s35, s35, 458752
    s_add_u32 s31, s12, 2
    v_readfirstlane_b32 s29, v18
    s_cmp_le_u32 s29, s31
    s_cselect_b32 s13, 1, 0
    s_add_u32 s6, s35, 16384
    s_cmp_gt_u32 s31, 62
    s_cselect_b32 s38, 0x8000000, s35
    s_cselect_b32 s6, 0x8000000, s6
    s_cselect_b32 s13, 0, s13
    s_mov_b32 s14, 0
    s_waitcnt lgkmcnt(0)
.p2align 6
pr_114:
    buffer_load_dwordx4 v[60:63], v6, s[8:11], s43 offen offset:0 sc1
    buffer_load_dwordx4 v[64:67], v10, s[8:11], s43 offen offset:0 sc1
    buffer_load_dwordx4 v[68:71], v10, s[8:11], s43 offen offset:1024 sc1
    s_add_u32 s14, s14, 1
    s_cmp_lt_u32 s14, 200000
    s_cbranch_scc0 tdie
    s_cmp_lt_u32 s3, 2
    s_waitcnt vmcnt(3)
    v_or3_b32 v3, v60, v61, v62
    v_or3_b32 v3, v63, v64, v3
    v_mfma_f32_16x16x32_bf16 v[72:75], v[60:63], v[52:55], 0
    v_or3_b32 v3, v65, v66, v3
    v_mfma_f32_16x16x32_bf16 v[76:79], v[60:63], v[56:59], 0
    v_or3_b32 v3, v67, v68, v3
    v_smfmac_f32_16x16x64_bf16 v[72:75], v[64:67], v[80:87], v2
    v_or3_b32 v3, v69, v70, v3
    v_smfmac_f32_16x16x64_bf16 v[76:79], v[64:67], v[96:103], v2
    v_or_b32 v3, v71, v3
    v_smfmac_f32_16x16x64_bf16 v[72:75], v[68:71], v[88:95], v2
    v_cmp_gt_i32 vcc, 0, v3
    v_smfmac_f32_16x16x64_bf16 v[76:79], v[68:71], v[104:111], v2
    s_cbranch_vccnz pr_114
    s_nop 4
    v_pk_add_f32 v[72:73], v[72:73], v[74:75]
    s_nop 0
    v_pk_add_f32 v[76:77], v[76:77], v[78:79]
    ds_write2_b32 v8, v72, v73 offset0:0 offset1:16
    ds_write2_b32 v15, v76, v77 offset0:0 offset1:16
    s_cbranch_scc0 nr_116
    s_waitcnt lgkmcnt(0)
    s_barrier
    ds_read_b64 v[112:113], v9 offset:0
    ds_read_b64 v[114:115], v9 offset:512
    ds_read_b64 v[116:117], v9 offset:1024
    ds_read_b64 v[118:119], v9 offset:1536
    s_waitcnt lgkmcnt(2)
    v_pk_add_f32 v[112:113], v[112:113], v[114:115]
    s_waitcnt lgkmcnt(0)
    v_pk_add_f32 v[116:117], v[116:117], v[118:119]
    v_pk_add_f32 v[112:113], v[112:113], v[116:117]
    v_cvt_pk_bf16_f32 v112, v112, v113
    v_min_u32 v112, -2, v112
    buffer_store_dword v112, v11, s[8:11], s42 offen sc1
    s_barrier
    s_mov_b32 s40, 0xe9fc00
jr_117:
    s_add_u32 s12, s12, 1
    s_cmp_lt_u32 s12, 63
    s_cbranch_scc1 cloopS
    buffer_store_dword v112, v11, s[8:11], s40 offen sc1
    s_endpgm
dq_107:
    s_add_u32 s31, s12, 1
    s_mov_b32 s14, 0
dw_118:
    buffer_load_dword v18, off, s[8:11], s49 sc1
    s_waitcnt vmcnt(0)
    v_readfirstlane_b32 s29, v18
    s_cmp_le_u32 s29, s31
    s_cbranch_scc0 dk_119
    s_sleep 1
    s_add_u32 s14, s14, 1
    s_cmp_lt_u32 s14, 200000
    s_cbranch_scc1 dw_118
    s_endpgm
dk_119:
    s_branch db_108
d0_112:
    s_waitcnt vmcnt(0)
    v_and_b32 v18, 1, v0
    v_lshlrev_b32 v18, 2, v18
    v_bfe_u32 v80, v0, 1, 1
    v_lshl_add_u32 v80, v80, 7, v18
    s_lshl_b32 s31, s4, 3
    s_add_u32 s31, s31, 0xf80000
    s_mov_b32 s14, 0
dz_120:
    buffer_load_dword v18, v80, s[8:11], s31 offen sc1
    s_add_u32 s14, s14, 1
    s_cmp_lt_u32 s14, 200000
    s_cbranch_scc0 tdie
    s_waitcnt vmcnt(0)
    v_cmp_eq_u32 vcc, 0, v18
    s_cbranch_vccnz dz_120
    s_xor_b32 s31, s37, 0x18000
    s_add_u32 m0, s31, 0
    s_add_u32 s31, s35, -458752
    buffer_load_dwordx4 v1, s[8:11], s31 offen offset:0 sc1 lds
    buffer_load_dwordx4 v1, s[8:11], s31 offen offset:1024 sc1 lds
    buffer_load_dwordx4 v1, s[8:11], s31 offen offset:2048 sc1 lds
    buffer_load_dwordx4 v1, s[8:11], s31 offen offset:3072 sc1 lds
    s_xor_b32 s31, s37, 0x18000
    s_add_u32 m0, s31, 16384
    s_add_u32 s31, s35, -442368
    buffer_load_dwordx4 v1, s[8:11], s31 offen offset:0 sc1 lds
    buffer_load_dwordx4 v1, s[8:11], s31 offen offset:1024 sc1 lds
    buffer_load_dwordx4 v1, s[8:11], s31 offen offset:2048 sc1 lds
    buffer_load_dwordx4 v1, s[8:11], s31 offen offset:3072 sc1 lds
    s_mov_b32 s31, s37
    s_add_u32 m0, s31, 0
    s_add_u32 s31, s35, 0
    buffer_load_dwordx4 v1, s[8:11], s31 offen offset:0 sc1 lds
    buffer_load_dwordx4 v1, s[8:11], s31 offen offset:1024 sc1 lds
    buffer_load_dwordx4 v1, s[8:11], s31 offen offset:2048 sc1 lds
    buffer_load_dwordx4 v1, s[8:11], s31 offen offset:3072 sc1 lds
    s_mov_b32 s31, s37
    s_add_u32 m0, s31, 16384
    s_add_u32 s31, s35, 16384
    buffer_load_dwordx4 v1, s[8:11], s31 offen offset:0 sc1 lds
    buffer_load_dwordx4 v1, s[8:11], s31 offen offset:1024 sc1 lds
    buffer_load_dwordx4 v1, s[8:11], s31 offen offset:2048 sc1 lds
    buffer_load_dwordx4 v1, s[8:11], s31 offen offset:3072 sc1 lds
    buffer_load_dword v18, off, s[8:11], s49 sc1
    s_waitcnt vmcnt(9)
    s_mov_b32 s7, 0
    s_branch d1_113
nr_116:
    s_waitcnt lgkmcnt(0)
    s_barrier
    s_barrier
    s_branch jr_117
role_d:
    s_lshr_b32 s6, s30, 1
    s_and_b32 s12, s30, 1
    v_lshlrev_b32 v1, 4, v0
    v_and_b32 v2, 15, v0
    v_lshrrev_b32 v3, 4, v0
    s_lshl_b32 s34, s3, 2
    s_cmp_eq_u32 s3, 0
    s_cbranch_scc0 wd_122
    v_min_u32 v23, 55, v0
    v_lshlrev_b32 v23, 4, v23
    s_mov_b32 s31, 0xf81000
    s_mov_b32 s32, 0xf80800
    s_mov_b32 s14, 0
wc_121:
    buffer_load_dwordx4 v[24:27], v1, s[8:11], s32 offen sc1
    s_waitcnt vmcnt(0)
    v_min3_u32 v24, v24, v25, v26
    v_min_u32 v24, v24, v27
    v_cmp_eq_u32 vcc, 0, v24
    s_cbranch_vccz wd_122
    s_sleep 4
    s_add_u32 s14, s14, 1
    s_cmp_lt_u32 s14, 400000
    s_cbranch_scc1 wc_121
    s_endpgm
wd_122:
    s_barrier
    s_mul_i32 s33, s34, 28
    s_add_u32 s33, s33, s6
    s_mul_i32 s33, s33, 14336
    s_add_u32 s33, s33, 0x620000
    s_mov_b32 s20, s33
    s_mov_b32 s21, s34
    s_add_u32 s32, s20, 0
    buffer_load_dwordx4 a[0:3], v1, s[8:11], s32 offen offset:0 sc1
    buffer_load_dwordx4 a[4:7], v1, s[8:11], s32 offen offset:1024 sc1
    s_add_u32 s32, s20, 4096
    buffer_load_dwordx4 a[16:19], v1, s[8:11], s32 offen offset:0 sc1
    buffer_load_dwordx4 a[20:23], v1, s[8:11], s32 offen offset:1024 sc1
    s_add_u32 s32, s20, 8192
    buffer_load_dwordx4 a[32:35], v1, s[8:11], s32 offen offset:0 sc1
    buffer_load_dwordx4 a[36:39], v1, s[8:11], s32 offen offset:1024 sc1
    s_add_u32 s32, s20, 12288
    buffer_load_dwordx4 a[48:51], v1, s[8:11], s32 offen offset:0 sc1
    buffer_load_dwordx4 a[52:55], v1, s[8:11], s32 offen offset:1024 sc1
    s_add_u32 s32, s20, 401408
    buffer_load_dwordx4 a[56:59], v1, s[8:11], s32 offen offset:0 sc1
    buffer_load_dwordx4 a[60:63], v1, s[8:11], s32 offen offset:1024 sc1
    s_add_u32 s32, s20, 405504
    buffer_load_dwordx4 a[72:75], v1, s[8:11], s32 offen offset:0 sc1
    buffer_load_dwordx4 a[76:79], v1, s[8:11], s32 offen offset:1024 sc1
    s_add_u32 s32, s20, 409600
    buffer_load_dwordx4 a[88:91], v1, s[8:11], s32 offen offset:0 sc1
    buffer_load_dwordx4 a[92:95], v1, s[8:11], s32 offen offset:1024 sc1
    s_add_u32 s32, s20, 413696
    buffer_load_dwordx4 a[104:107], v1, s[8:11], s32 offen offset:0 sc1
    buffer_load_dwordx4 a[108:111], v1, s[8:11], s32 offen offset:1024 sc1
    s_add_u32 s32, s20, 802816
    buffer_load_dwordx4 a[112:115], v1, s[8:11], s32 offen offset:0 sc1
    buffer_load_dwordx4 a[116:119], v1, s[8:11], s32 offen offset:1024 sc1
    s_add_u32 s32, s20, 806912
    buffer_load_dwordx4 a[128:131], v1, s[8:11], s32 offen offset:0 sc1
    buffer_load_dwordx4 a[132:135], v1, s[8:11], s32 offen offset:1024 sc1
    s_add_u32 s32, s20, 811008
    buffer_load_dwordx4 a[144:147], v1, s[8:11], s32 offen offset:0 sc1
    buffer_load_dwordx4 a[148:151], v1, s[8:11], s32 offen offset:1024 sc1
    s_add_u32 s32, s20, 815104
    buffer_load_dwordx4 a[160:163], v1, s[8:11], s32 offen offset:0 sc1
    buffer_load_dwordx4 a[164:167], v1, s[8:11], s32 offen offset:1024 sc1
    s_add_u32 s32, s20, 1204224
    buffer_load_dwordx4 a[168:171], v1, s[8:11], s32 offen offset:0 sc1
    buffer_load_dwordx4 a[172:175], v1, s[8:11], s32 offen offset:1024 sc1
    s_add_u32 s32, s20, 1208320
    buffer_load_dwordx4 a[184:187], v1, s[8:11], s32 offen offset:0 sc1
    buffer_load_dwordx4 a[188:191], v1, s[8:11], s32 offen offset:1024 sc1
    s_add_u32 s32, s20, 1212416
    buffer_load_dwordx4 a[200:203], v1, s[8:11], s32 offen offset:0 sc1
    buffer_load_dwordx4 a[204:207], v1, s[8:11], s32 offen offset:1024 sc1
    s_add_u32 s32, s20, 1216512
    buffer_load_dwordx4 a[216:219], v1, s[8:11], s32 offen offset:0 sc1
    buffer_load_dwordx4 a[220:223], v1, s[8:11], s32 offen offset:1024 sc1
    s_mul_i32 s30, s3, 7168
    s_mul_i32 s34, s12, 28672
    s_add_u32 s34, s34, s30
    s_add_u32 s34, s34, 0xc40000
    s_lshr_b32 s31, s3, 1
    s_lshl_b32 s31, s31, 6
    s_add_u32 s36, s30, s31
    s_add_u32 s36, s36, 0
    s_mov_b32 s50, 28800
    s_mov_b32 m0, s36
    s_add_u32 s30, s34, 4096
    buffer_load_dwordx4 v1, s[8:11], s34 offen offset:0 sc1 lds
    buffer_load_dwordx4 v1, s[8:11], s34 offen offset:1024 sc1 lds
    buffer_load_dwordx4 v1, s[8:11], s34 offen offset:2048 sc1 lds
    buffer_load_dwordx4 v1, s[8:11], s34 offen offset:3072 sc1 lds
    s_add_u32 m0, s36, 4096
    s_nop 0
    buffer_load_dwordx4 v1, s[8:11], s30 offen offset:0 sc1 lds
    buffer_load_dwordx4 v1, s[8:11], s30 offen offset:1024 sc1 lds
    buffer_load_dwordx4 v1, s[8:11], s30 offen offset:2048 sc1 lds
    s_cmp_eq_u32 s3, 0
    s_cbranch_scc0 wd_124
    v_min_u32 v23, 55, v0
    v_lshlrev_b32 v23, 4, v23
    s_mov_b32 s31, 0xf81000
    s_mov_b32 s32, 0xf80800
    s_mov_b32 s14, 0
wc_123:
    buffer_load_dwordx4 v[24:27], v23, s[8:11], s31 offen sc1
    s_waitcnt vmcnt(0)
    v_min3_u32 v24, v24, v25, v26
    v_min_u32 v24, v24, v27
    v_cmp_eq_u32 vcc, 0, v24
    s_cbranch_vccz wd_124
    s_sleep 4
    s_add_u32 s14, s14, 1
    s_cmp_lt_u32 s14, 400000
    s_cbranch_scc1 wc_123
    s_endpgm
wd_124:
    s_barrier
    s_add_u32 s32, s20, 2048
    buffer_load_dwordx4 a[8:11], v1, s[8:11], s32 offen offset:0 sc1
    buffer_load_dwordx4 a[12:15], v1, s[8:11], s32 offen offset:1024 sc1
    s_add_u32 s32, s20, 6144
    buffer_load_dwordx4 a[24:27], v1, s[8:11], s32 offen offset:0 sc1
    buffer_load_dwordx4 a[28:31], v1, s[8:11], s32 offen offset:1024 sc1
    s_add_u32 s32, s20, 10240
    buffer_load_dwordx4 a[40:43], v1, s[8:11], s32 offen offset:0 sc1
    buffer_load_dwordx4 a[44:47], v1, s[8:11], s32 offen offset:1024 sc1
    s_add_u32 s32, s20, 403456
    buffer_load_dwordx4 a[64:67], v1, s[8:11], s32 offen offset:0 sc1
    buffer_load_dwordx4 a[68:71], v1, s[8:11], s32 offen offset:1024 sc1
    s_add_u32 s32, s20, 407552
    buffer_load_dwordx4 a[80:83], v1, s[8:11], s32 offen offset:0 sc1
    buffer_load_dwordx4 a[84:87], v1, s[8:11], s32 offen offset:1024 sc1
    s_add_u32 s32, s20, 411648
    buffer_load_dwordx4 a[96:99], v1, s[8:11], s32 offen offset:0 sc1
    buffer_load_dwordx4 a[100:103], v1, s[8:11], s32 offen offset:1024 sc1
    s_add_u32 s32, s20, 804864
    buffer_load_dwordx4 a[120:123], v1, s[8:11], s32 offen offset:0 sc1
    buffer_load_dwordx4 a[124:127], v1, s[8:11], s32 offen offset:1024 sc1
    s_add_u32 s32, s20, 808960
    buffer_load_dwordx4 a[136:139], v1, s[8:11], s32 offen offset:0 sc1
    buffer_load_dwordx4 a[140:143], v1, s[8:11], s32 offen offset:1024 sc1
    s_add_u32 s32, s20, 813056
    buffer_load_dwordx4 a[152:155], v1, s[8:11], s32 offen offset:0 sc1
    buffer_load_dwordx4 a[156:159], v1, s[8:11], s32 offen offset:1024 sc1
    s_add_u32 s32, s20, 1206272
    buffer_load_dwordx4 a[176:179], v1, s[8:11], s32 offen offset:0 sc1
    buffer_load_dwordx4 a[180:183], v1, s[8:11], s32 offen offset:1024 sc1
    s_add_u32 s32, s20, 1210368
    buffer_load_dwordx4 a[192:195], v1, s[8:11], s32 offen offset:0 sc1
    buffer_load_dwordx4 a[196:199], v1, s[8:11], s32 offen offset:1024 sc1
    s_add_u32 s32, s20, 1214464
    buffer_load_dwordx4 a[208:211], v1, s[8:11], s32 offen offset:0 sc1
    buffer_load_dwordx4 a[212:215], v1, s[8:11], s32 offen offset:1024 sc1
    v_lshrrev_b32 v7, 3, v2
    s_movk_i32 s30, 14400
    v_mul_u32_u24 v6, s30, v7
    v_bfe_u32 v7, v0, 2, 1
    v_lshl_add_u32 v6, v7, 7, v6
    v_and_b32 v7, 3, v0
    v_lshl_add_u32 v6, v7, 4, v6
    v_add_u32 v6, 0, v6
    v_lshl_add_u32 v6, v3, 8, v6
    s_lshl_b32 s35, s12, 7
    s_lshl_b32 s31, s6, 2
    s_add_u32 s35, s35, s31
    s_add_u32 s35, s35, 0xf80000
    s_lshl_b32 s15, s3, 11
    s_add_u32 s16, s15, 1024
    s_cmp_eq_u32 s3, 3
    s_cselect_b32 s16, 0, s16
    s_add_u32 s31, s15, 65536
    v_add_u32 v9, s31, v1
    s_add_u32 s31, s16, 65536
    v_add_u32 v10, s31, v1
    v_lshrrev_b32 v4, 1, v3
    v_lshlrev_b32 v8, 8, v4
    v_bfe_u32 v4, v0, 1, 2
    v_lshl_add_u32 v8, v4, 6, v8
    v_and_b32 v4, 1, v0
    v_lshl_add_u32 v8, v4, 4, v8
    v_and_b32 v4, 1, v3
    v_lshl_add_u32 v8, v4, 3, v8
    v_add_u32 v8, 65536, v8
    v_lshlrev_b32 v11, 4, v2
    v_lshl_add_u32 v11, v4, 3, v11
    v_lshrrev_b32 v4, 1, v3
    v_lshl_add_u32 v11, v4, 8, v11
    v_cmp_gt_u32 s[60:61], 32, v0
    s_mov_b32 s17, s12
    s_lshl_b32 s19, s12, 9
    s_lshl_b32 s31, s6, 4
    s_add_u32 s19, s19, s31
    s_lshl_b32 s31, s3, 2
    s_add_u32 s19, s19, s31
    s_add_u32 s19, s19, 0xf80400
    s_mov_b32 s18, 0
    s_mov_b32 s13, 0
    s_waitcnt vmcnt(0)
    s_branch rd_in
rd_loop:
    s_waitcnt vmcnt(4)
rd_in:
    s_barrier
    s_add_u32 s34, s34, 57344
    s_add_u32 s36, s36, s50
    s_mov_b32 m0, s36
    s_add_u32 s30, s34, 4096
    buffer_load_dwordx4 v1, s[8:11], s34 offen offset:0 sc1 lds
    buffer_load_dwordx4 v1, s[8:11], s34 offen offset:1024 sc1 lds
    buffer_load_dwordx4 v1, s[8:11], s34 offen offset:2048 sc1 lds
    buffer_load_dwordx4 v1, s[8:11], s34 offen offset:3072 sc1 lds
    s_add_u32 m0, s36, 4096
    s_nop 0
    buffer_load_dwordx4 v1, s[8:11], s30 offen offset:0 sc1 lds
    buffer_load_dwordx4 v1, s[8:11], s30 offen offset:1024 sc1 lds
    buffer_load_dwordx4 v1, s[8:11], s30 offen offset:2048 sc1 lds
    ds_read_b128 v[64:67], v6 offset:0
    ds_read_b128 v[68:71], v6 offset:64
    ds_read_b128 v[72:75], v6 offset:1024
    ds_read_b128 v[76:79], v6 offset:1088
    ds_read_b128 v[80:83], v6 offset:2048
    ds_read_b128 v[84:87], v6 offset:2112
    ds_read_b128 v[88:91], v6 offset:3072
    ds_read_b128 v[92:95], v6 offset:3136
    s_waitcnt lgkmcnt(6)
    v_mfma_f32_16x16x32_bf16 v[32:35], v[64:67], a[0:3], 0
    v_mfma_f32_16x16x32_bf16 v[36:39], v[68:71], a[0:3], 0
    v_mfma_f32_16x16x32_bf16 v[40:43], v[64:67], a[56:59], 0
    v_mfma_f32_16x16x32_bf16 v[44:47], v[68:71], a[56:59], 0
    v_mfma_f32_16x16x32_bf16 v[48:51], v[64:67], a[112:115], 0
    v_mfma_f32_16x16x32_bf16 v[52:55], v[68:71], a[112:115], 0
    v_mfma_f32_16x16x32_bf16 v[56:59], v[64:67], a[168:171], 0
    v_mfma_f32_16x16x32_bf16 v[60:63], v[68:71], a[168:171], 0
    ds_read_b128 v[64:67], v6 offset:4096
    ds_read_b128 v[68:71], v6 offset:4160
    s_waitcnt lgkmcnt(6)
    v_mfma_f32_16x16x32_bf16 v[32:35], v[72:75], a[4:7], v[32:35]
    v_mfma_f32_16x16x32_bf16 v[36:39], v[76:79], a[4:7], v[36:39]
    v_mfma_f32_16x16x32_bf16 v[40:43], v[72:75], a[60:63], v[40:43]
    v_mfma_f32_16x16x32_bf16 v[44:47], v[76:79], a[60:63], v[44:47]
    v_mfma_f32_16x16x32_bf16 v[48:51], v[72:75], a[116:119], v[48:51]
    v_mfma_f32_16x16x32_bf16 v[52:55], v[76:79], a[116:119], v[52:55]
    v_mfma_f32_16x16x32_bf16 v[56:59], v[72:75], a[172:175], v[56:59]
    v_mfma_f32_16x16x32_bf16 v[60:63], v[76:79], a[172:175], v[60:63]
    ds_read_b128 v[72:75], v6 offset:5120
    ds_read_b128 v[76:79], v6 offset:5184
    s_waitcnt lgkmcnt(6)
    v_mfma_f32_16x16x32_bf16 v[32:35], v[80:83], a[8:11], v[32:35]
    v_mfma_f32_16x16x32_bf16 v[36:39], v[84:87], a[8:11], v[36:39]
    v_mfma_f32_16x16x32_bf16 v[40:43], v[80:83], a[64:67], v[40:43]
    v_mfma_f32_16x16x32_bf16 v[44:47], v[84:87], a[64:67], v[44:47]
    v_mfma_f32_16x16x32_bf16 v[48:51], v[80:83], a[120:123], v[48:51]
    v_mfma_f32_16x16x32_bf16 v[52:55], v[84:87], a[120:123], v[52:55]
    v_mfma_f32_16x16x32_bf16 v[56:59], v[80:83], a[176:179], v[56:59]
    v_mfma_f32_16x16x32_bf16 v[60:63], v[84:87], a[176:179], v[60:63]
    ds_read_b128 v[80:83], v6 offset:6144
    ds_read_b128 v[84:87], v6 offset:6208
    s_waitcnt lgkmcnt(6)
    v_mfma_f32_16x16x32_bf16 v[32:35], v[88:91], a[12:15], v[32:35]
    v_mfma_f32_16x16x32_bf16 v[36:39], v[92:95], a[12:15], v[36:39]
    v_mfma_f32_16x16x32_bf16 v[40:43], v[88:91], a[68:71], v[40:43]
    v_mfma_f32_16x16x32_bf16 v[44:47], v[92:95], a[68:71], v[44:47]
    v_mfma_f32_16x16x32_bf16 v[48:51], v[88:91], a[124:127], v[48:51]
    v_mfma_f32_16x16x32_bf16 v[52:55], v[92:95], a[124:127], v[52:55]
    v_mfma_f32_16x16x32_bf16 v[56:59], v[88:91], a[180:183], v[56:59]
    v_mfma_f32_16x16x32_bf16 v[60:63], v[92:95], a[180:183], v[60:63]
    ds_read_b128 v[88:91], v6 offset:7168
    ds_read_b128 v[92:95], v6 offset:7232
    s_waitcnt lgkmcnt(6)
    v_mfma_f32_16x16x32_bf16 v[32:35], v[64:67], a[16:19], v[32:35]
    v_mfma_f32_16x16x32_bf16 v[36:39], v[68:71], a[16:19], v[36:39]
    v_mfma_f32_16x16x32_bf16 v[40:43], v[64:67], a[72:75], v[40:43]
    v_mfma_f32_16x16x32_bf16 v[44:47], v[68:71], a[72:75], v[44:47]
    v_mfma_f32_16x16x32_bf16 v[48:51], v[64:67], a[128:131], v[48:51]
    v_mfma_f32_16x16x32_bf16 v[52:55], v[68:71], a[128:131], v[52:55]
    v_mfma_f32_16x16x32_bf16 v[56:59], v[64:67], a[184:187], v[56:59]
    v_mfma_f32_16x16x32_bf16 v[60:63], v[68:71], a[184:187], v[60:63]
    ds_read_b128 v[64:67], v6 offset:8192
    ds_read_b128 v[68:71], v6 offset:8256
    s_waitcnt lgkmcnt(6)
    v_mfma_f32_16x16x32_bf16 v[32:35], v[72:75], a[20:23], v[32:35]
    v_mfma_f32_16x16x32_bf16 v[36:39], v[76:79], a[20:23], v[36:39]
    v_mfma_f32_16x16x32_bf16 v[40:43], v[72:75], a[76:79], v[40:43]
    v_mfma_f32_16x16x32_bf16 v[44:47], v[76:79], a[76:79], v[44:47]
    v_mfma_f32_16x16x32_bf16 v[48:51], v[72:75], a[132:135], v[48:51]
    v_mfma_f32_16x16x32_bf16 v[52:55], v[76:79], a[132:135], v[52:55]
    v_mfma_f32_16x16x32_bf16 v[56:59], v[72:75], a[188:191], v[56:59]
    v_mfma_f32_16x16x32_bf16 v[60:63], v[76:79], a[188:191], v[60:63]
    ds_read_b128 v[72:75], v6 offset:9216
    ds_read_b128 v[76:79], v6 offset:9280
    s_waitcnt lgkmcnt(6)
    v_mfma_f32_16x16x32_bf16 v[32:35], v[80:83], a[24:27], v[32:35]
    v_mfma_f32_16x16x32_bf16 v[36:39], v[84:87], a[24:27], v[36:39]
    v_mfma_f32_16x16x32_bf16 v[40:43], v[80:83], a[80:83], v[40:43]
    v_mfma_f32_16x16x32_bf16 v[44:47], v[84:87], a[80:83], v[44:47]
    v_mfma_f32_16x16x32_bf16 v[48:51], v[80:83], a[136:139], v[48:51]
    v_mfma_f32_16x16x32_bf16 v[52:55], v[84:87], a[136:139], v[52:55]
    v_mfma_f32_16x16x32_bf16 v[56:59], v[80:83], a[192:195], v[56:59]
    v_mfma_f32_16x16x32_bf16 v[60:63], v[84:87], a[192:195], v[60:63]
    ds_read_b128 v[80:83], v6 offset:10240
    ds_read_b128 v[84:87], v6 offset:10304
    s_waitcnt lgkmcnt(6)
    v_mfma_f32_16x16x32_bf16 v[32:35], v[88:91], a[28:31], v[32:35]
    v_mfma_f32_16x16x32_bf16 v[36:39], v[92:95], a[28:31], v[36:39]
    v_mfma_f32_16x16x32_bf16 v[40:43], v[88:91], a[84:87], v[40:43]
    v_mfma_f32_16x16x32_bf16 v[44:47], v[92:95], a[84:87], v[44:47]
    v_mfma_f32_16x16x32_bf16 v[48:51], v[88:91], a[140:143], v[48:51]
    v_mfma_f32_16x16x32_bf16 v[52:55], v[92:95], a[140:143], v[52:55]
    v_mfma_f32_16x16x32_bf16 v[56:59], v[88:91], a[196:199], v[56:59]
    v_mfma_f32_16x16x32_bf16 v[60:63], v[92:95], a[196:199], v[60:63]
    ds_read_b128 v[88:91], v6 offset:11264
    ds_read_b128 v[92:95], v6 offset:11328
    s_waitcnt lgkmcnt(6)
    v_mfma_f32_16x16x32_bf16 v[32:35], v[64:67], a[32:35], v[32:35]
    v_mfma_f32_16x16x32_bf16 v[36:39], v[68:71], a[32:35], v[36:39]
    v_mfma_f32_16x16x32_bf16 v[40:43], v[64:67], a[88:91], v[40:43]
    v_mfma_f32_16x16x32_bf16 v[44:47], v[68:71], a[88:91], v[44:47]
    v_mfma_f32_16x16x32_bf16 v[48:51], v[64:67], a[144:147], v[48:51]
    v_mfma_f32_16x16x32_bf16 v[52:55], v[68:71], a[144:147], v[52:55]
    v_mfma_f32_16x16x32_bf16 v[56:59], v[64:67], a[200:203], v[56:59]
    v_mfma_f32_16x16x32_bf16 v[60:63], v[68:71], a[200:203], v[60:63]
    s_waitcnt vmcnt(7)
    s_barrier
    s_cmp_eq_u32 s3, 0
    s_cbranch_scc0 pb_125
    v_mov_b32 v4, s13
    v_mov_b32 v5, 0
    buffer_store_dword v4, v5, s[8:11], s35 offen sc1
pb_125:
    ds_read_b128 v[64:67], v6 offset:12288
    ds_read_b128 v[68:71], v6 offset:12352
    s_waitcnt lgkmcnt(6)
    v_mfma_f32_16x16x32_bf16 v[32:35], v[72:75], a[36:39], v[32:35]
    v_mfma_f32_16x16x32_bf16 v[36:39], v[76:79], a[36:39], v[36:39]
    v_mfma_f32_16x16x32_bf16 v[40:43], v[72:75], a[92:95], v[40:43]
    v_mfma_f32_16x16x32_bf16 v[44:47], v[76:79], a[92:95], v[44:47]
    v_mfma_f32_16x16x32_bf16 v[48:51], v[72:75], a[148:151], v[48:51]
    v_mfma_f32_16x16x32_bf16 v[52:55], v[76:79], a[148:151], v[52:55]
    v_mfma_f32_16x16x32_bf16 v[56:59], v[72:75], a[204:207], v[56:59]
    v_mfma_f32_16x16x32_bf16 v[60:63], v[76:79], a[204:207], v[60:63]
    ds_read_b128 v[72:75], v6 offset:13312
    ds_read_b128 v[76:79], v6 offset:13376
    s_waitcnt lgkmcnt(6)
    v_mfma_f32_16x16x32_bf16 v[32:35], v[80:83], a[40:43], v[32:35]
    v_mfma_f32_16x16x32_bf16 v[36:39], v[84:87], a[40:43], v[36:39]
    v_mfma_f32_16x16x32_bf16 v[40:43], v[80:83], a[96:99], v[40:43]
    v_mfma_f32_16x16x32_bf16 v[44:47], v[84:87], a[96:99], v[44:47]
    v_mfma_f32_16x16x32_bf16 v[48:51], v[80:83], a[152:155], v[48:51]
    v_mfma_f32_16x16x32_bf16 v[52:55], v[84:87], a[152:155], v[52:55]
    v_mfma_f32_16x16x32_bf16 v[56:59], v[80:83], a[208:211], v[56:59]
    v_mfma_f32_16x16x32_bf16 v[60:63], v[84:87], a[208:211], v[60:63]
    s_waitcnt lgkmcnt(4)
    v_mfma_f32_16x16x32_bf16 v[32:35], v[88:91], a[44:47], v[32:35]
    v_mfma_f32_16x16x32_bf16 v[36:39], v[92:95], a[44:47], v[36:39]
    v_mfma_f32_16x16x32_bf16 v[40:43], v[88:91], a[100:103], v[40:43]
    v_mfma_f32_16x16x32_bf16 v[44:47], v[92:95], a[100:103], v[44:47]
    v_mfma_f32_16x16x32_bf16 v[48:51], v[88:91], a[156:159], v[48:51]
    v_mfma_f32_16x16x32_bf16 v[52:55], v[92:95], a[156:159], v[52:55]
    v_mfma_f32_16x16x32_bf16 v[56:59], v[88:91], a[212:215], v[56:59]
    v_mfma_f32_16x16x32_bf16 v[60:63], v[92:95], a[212:215], v[60:63]
    s_waitcnt lgkmcnt(2)
    v_mfma_f32_16x16x32_bf16 v[32:35], v[64:67], a[48:51], v[32:35]
    v_mfma_f32_16x16x32_bf16 v[36:39], v[68:71], a[48:51], v[36:39]
    v_mfma_f32_16x16x32_bf16 v[40:43], v[64:67], a[104:107], v[40:43]
    v_mfma_f32_16x16x32_bf16 v[44:47], v[68:71], a[104:107], v[44:47]
    v_mfma_f32_16x16x32_bf16 v[48:51], v[64:67], a[160:163], v[48:51]
    v_mfma_f32_16x16x32_bf16 v[52:55], v[68:71], a[160:163], v[52:55]
    v_mfma_f32_16x16x32_bf16 v[56:59], v[64:67], a[216:219], v[56:59]
    v_mfma_f32_16x16x32_bf16 v[60:63], v[68:71], a[216:219], v[60:63]
    s_waitcnt lgkmcnt(0)
    v_mfma_f32_16x16x32_bf16 v[32:35], v[72:75], a[52:55], v[32:35]
    v_mfma_f32_16x16x32_bf16 v[36:39], v[76:79], a[52:55], v[36:39]
    v_mfma_f32_16x16x32_bf16 v[40:43], v[72:75], a[108:111], v[40:43]
    v_mfma_f32_16x16x32_bf16 v[44:47], v[76:79], a[108:111], v[44:47]
    v_mfma_f32_16x16x32_bf16 v[48:51], v[72:75], a[164:167], v[48:51]
    v_mfma_f32_16x16x32_bf16 v[52:55], v[76:79], a[164:167], v[52:55]
    v_mfma_f32_16x16x32_bf16 v[56:59], v[72:75], a[220:223], v[56:59]
    v_mfma_f32_16x16x32_bf16 v[60:63], v[76:79], a[220:223], v[60:63]
    v_add_u32 v6, s50, v6
    s_sub_u32 s50, 0, s50
    s_nop 6
    s_mul_i32 s30, s12, 458752
    s_lshl_b32 s31, s6, 14
    s_add_u32 s30, s30, s31
    s_lshl_b32 s31, s3, 12
    s_add_u32 s30, s30, s31
    s_add_u32 s30, s30, 0x2100000
    v_cvt_pk_bf16_f32 v96, v32, v33
    v_cvt_pk_bf16_f32 v97, v34, v35
    v_cvt_pk_bf16_f32 v98, v36, v37
    v_cvt_pk_bf16_f32 v99, v38, v39
    buffer_store_dwordx4 v[96:99], v1, s[8:11], s30 offen offset:0 sc1
    v_cvt_pk_bf16_f32 v100, v40, v41
    v_cvt_pk_bf16_f32 v101, v42, v43
    v_cvt_pk_bf16_f32 v102, v44, v45
    v_cvt_pk_bf16_f32 v103, v46, v47
    buffer_store_dwordx4 v[100:103], v1, s[8:11], s30 offen offset:1024 sc1
    v_cvt_pk_bf16_f32 v104, v48, v49
    v_cvt_pk_bf16_f32 v105, v50, v51
    v_cvt_pk_bf16_f32 v106, v52, v53
    v_cvt_pk_bf16_f32 v107, v54, v55
    buffer_store_dwordx4 v[104:107], v1, s[8:11], s30 offen offset:2048 sc1
    v_cvt_pk_bf16_f32 v108, v56, v57
    v_cvt_pk_bf16_f32 v109, v58, v59
    v_cvt_pk_bf16_f32 v110, v60, v61
    v_cvt_pk_bf16_f32 v111, v62, v63
    buffer_store_dwordx4 v[108:111], v1, s[8:11], s30 offen offset:3072 sc1
    s_add_u32 s13, s13, 1
    s_add_u32 s12, s12, 2
    s_cmp_eq_u32 s13, 1
    s_cbranch_scc0 fp_126
    s_waitcnt vmcnt(0)
    s_barrier
    s_cmp_eq_u32 s3, 0
    s_cbranch_scc0 pb_127
    v_mov_b32 v4, s13
    v_mov_b32 v5, 0
    buffer_store_dword v4, v5, s[8:11], s35 offen sc1
pb_127:
fp_126:
    s_cmp_le_u32 s13, 6
    s_cbranch_scc1 rd_loop
rv_loop:
    s_mul_i32 s39, s17, 7168
    s_add_u32 s39, s39, 0xe31800
    s_add_u32 s32, s39, s15
    s_add_u32 s33, s39, s16
    s_mov_b32 s14, 0
xm_128:
    buffer_load_dwordx4 v[64:67], v1, s[8:11], s32 offen sc1
    buffer_load_dwordx4 v[68:71], v1, s[8:11], s33 offen sc1
    s_waitcnt vmcnt(0)
    v_max3_u32 v4, v64, v65, v66
    v_max3_u32 v5, v67, v68, v69
    v_max3_u32 v4, v70, v71, v4
    v_max_u32 v4, v4, v5
    v_cmp_eq_u32 vcc, -1, v4
    s_cbranch_vccz xk_129
    s_sleep 2
    s_add_u32 s14, s14, 1
    s_cmp_lt_u32 s14, 400000
    s_cbranch_scc1 xm_128
    s_endpgm
xk_129:
    ds_write_b128 v9, v[64:67]
    ds_write_b128 v10, v[68:71]
    s_waitcnt lgkmcnt(0)
    s_barrier
    s_cmp_eq_u32 s3, 0
    s_cbranch_scc0 pb_130
    v_mov_b32 v4, s13
    v_mov_b32 v5, 0
    buffer_store_dword v4, v5, s[8:11], s35 offen sc1
pb_130:
    ds_read2_b32 v[120:121], v8 offset0:0 offset1:8
    ds_read2_b32 v[122:123], v8 offset0:1 offset1:9
    ds_read2_b32 v[124:125], v8 offset0:128 offset1:136
    ds_read2_b32 v[126:127], v8 offset0:129 offset1:137
    v_add_u32 v8, 1024, v8
    ds_read2_b32 v[128:129], v8 offset0:0 offset1:8
    ds_read2_b32 v[130:131], v8 offset0:1 offset1:9
    ds_read2_b32 v[132:133], v8 offset0:128 offset1:136
    ds_read2_b32 v[134:135], v8 offset0:129 offset1:137
    s_waitcnt lgkmcnt(6)
    v_mfma_f32_16x16x32_bf16 v[32:35], v[120:123], a[0:3], 0
    v_mfma_f32_16x16x32_bf16 v[36:39], v[120:123], a[56:59], 0
    v_mfma_f32_16x16x32_bf16 v[40:43], v[120:123], a[112:115], 0
    v_mfma_f32_16x16x32_bf16 v[44:47], v[120:123], a[168:171], 0
    v_add_u32 v8, 1024, v8
    ds_read2_b32 v[136:137], v8 offset0:0 offset1:8
    ds_read2_b32 v[138:139], v8 offset0:1 offset1:9
    s_waitcnt lgkmcnt(6)
    v_mfma_f32_16x16x32_bf16 v[32:35], v[124:127], a[4:7], v[32:35]
    v_mfma_f32_16x16x32_bf16 v[36:39], v[124:127], a[60:63], v[36:39]
    v_mfma_f32_16x16x32_bf16 v[40:43], v[124:127], a[116:119], v[40:43]
    v_mfma_f32_16x16x32_bf16 v[44:47], v[124:127], a[172:175], v[44:47]
    ds_read2_b32 v[140:141], v8 offset0:128 offset1:136
    ds_read2_b32 v[142:143], v8 offset0:129 offset1:137
    s_waitcnt lgkmcnt(6)
    v_mfma_f32_16x16x32_bf16 v[32:35], v[128:131], a[8:11], v[32:35]
    v_mfma_f32_16x16x32_bf16 v[36:39], v[128:131], a[64:67], v[36:39]
    v_mfma_f32_16x16x32_bf16 v[40:43], v[128:131], a[120:123], v[40:43]
    v_mfma_f32_16x16x32_bf16 v[44:47], v[128:131], a[176:179], v[44:47]
    v_add_u32 v8, 1024, v8
    ds_read2_b32 v[144:145], v8 offset0:0 offset1:8
    ds_read2_b32 v[146:147], v8 offset0:1 offset1:9
    s_waitcnt lgkmcnt(6)
    v_mfma_f32_16x16x32_bf16 v[32:35], v[132:135], a[12:15], v[32:35]
    v_mfma_f32_16x16x32_bf16 v[36:39], v[132:135], a[68:71], v[36:39]
    v_mfma_f32_16x16x32_bf16 v[40:43], v[132:135], a[124:127], v[40:43]
    v_mfma_f32_16x16x32_bf16 v[44:47], v[132:135], a[180:183], v[44:47]
    ds_read2_b32 v[148:149], v8 offset0:128 offset1:136
    ds_read2_b32 v[150:151], v8 offset0:129 offset1:137
    s_waitcnt lgkmcnt(6)
    v_mfma_f32_16x16x32_bf16 v[32:35], v[136:139], a[16:19], v[32:35]
    v_mfma_f32_16x16x32_bf16 v[36:39], v[136:139], a[72:75], v[36:39]
    v_mfma_f32_16x16x32_bf16 v[40:43], v[136:139], a[128:131], v[40:43]
    v_mfma_f32_16x16x32_bf16 v[44:47], v[136:139], a[184:187], v[44:47]
    v_add_u32 v8, 1024, v8
    ds_read2_b32 v[152:153], v8 offset0:0 offset1:8
    ds_read2_b32 v[154:155], v8 offset0:1 offset1:9
    s_waitcnt lgkmcnt(6)
    v_mfma_f32_16x16x32_bf16 v[32:35], v[140:143], a[20:23], v[32:35]
    v_mfma_f32_16x16x32_bf16 v[36:39], v[140:143], a[76:79], v[36:39]
    v_mfma_f32_16x16x32_bf16 v[40:43], v[140:143], a[132:135], v[40:43]
    v_mfma_f32_16x16x32_bf16 v[44:47], v[140:143], a[188:191], v[44:47]
    ds_read2_b32 v[156:157], v8 offset0:128 offset1:136
    ds_read2_b32 v[158:159], v8 offset0:129 offset1:137
    s_waitcnt lgkmcnt(6)
    v_mfma_f32_16x16x32_bf16 v[32:35], v[144:147], a[24:27], v[32:35]
    v_mfma_f32_16x16x32_bf16 v[36:39], v[144:147], a[80:83], v[36:39]
    v_mfma_f32_16x16x32_bf16 v[40:43], v[144:147], a[136:139], v[40:43]
    v_mfma_f32_16x16x32_bf16 v[44:47], v[144:147], a[192:195], v[44:47]
    v_add_u32 v8, 1024, v8
    ds_read2_b32 v[160:161], v8 offset0:0 offset1:8
    ds_read2_b32 v[162:163], v8 offset0:1 offset1:9
    s_waitcnt lgkmcnt(6)
    v_mfma_f32_16x16x32_bf16 v[32:35], v[148:151], a[28:31], v[32:35]
    v_mfma_f32_16x16x32_bf16 v[36:39], v[148:151], a[84:87], v[36:39]
    v_mfma_f32_16x16x32_bf16 v[40:43], v[148:151], a[140:143], v[40:43]
    v_mfma_f32_16x16x32_bf16 v[44:47], v[148:151], a[196:199], v[44:47]
    ds_read2_b32 v[164:165], v8 offset0:128 offset1:136
    ds_read2_b32 v[166:167], v8 offset0:129 offset1:137
    s_waitcnt lgkmcnt(6)
    v_mfma_f32_16x16x32_bf16 v[32:35], v[152:155], a[32:35], v[32:35]
    v_mfma_f32_16x16x32_bf16 v[36:39], v[152:155], a[88:91], v[36:39]
    v_mfma_f32_16x16x32_bf16 v[40:43], v[152:155], a[144:147], v[40:43]
    v_mfma_f32_16x16x32_bf16 v[44:47], v[152:155], a[200:203], v[44:47]
    v_add_u32 v8, 1024, v8
    ds_read2_b32 v[168:169], v8 offset0:0 offset1:8
    ds_read2_b32 v[170:171], v8 offset0:1 offset1:9
    s_waitcnt lgkmcnt(6)
    v_mfma_f32_16x16x32_bf16 v[32:35], v[156:159], a[36:39], v[32:35]
    v_mfma_f32_16x16x32_bf16 v[36:39], v[156:159], a[92:95], v[36:39]
    v_mfma_f32_16x16x32_bf16 v[40:43], v[156:159], a[148:151], v[40:43]
    v_mfma_f32_16x16x32_bf16 v[44:47], v[156:159], a[204:207], v[44:47]
    ds_read2_b32 v[172:173], v8 offset0:128 offset1:136
    ds_read2_b32 v[174:175], v8 offset0:129 offset1:137
    s_waitcnt lgkmcnt(6)
    v_mfma_f32_16x16x32_bf16 v[32:35], v[160:163], a[40:43], v[32:35]
    v_mfma_f32_16x16x32_bf16 v[36:39], v[160:163], a[96:99], v[36:39]
    v_mfma_f32_16x16x32_bf16 v[40:43], v[160:163], a[152:155], v[40:43]
    v_mfma_f32_16x16x32_bf16 v[44:47], v[160:163], a[208:211], v[44:47]
    s_waitcnt lgkmcnt(4)
    v_mfma_f32_16x16x32_bf16 v[32:35], v[164:167], a[44:47], v[32:35]
    v_mfma_f32_16x16x32_bf16 v[36:39], v[164:167], a[100:103], v[36:39]
    v_mfma_f32_16x16x32_bf16 v[40:43], v[164:167], a[156:159], v[40:43]
    v_mfma_f32_16x16x32_bf16 v[44:47], v[164:167], a[212:215], v[44:47]
    s_waitcnt lgkmcnt(2)
    v_mfma_f32_16x16x32_bf16 v[32:35], v[168:171], a[48:51], v[32:35]
    v_mfma_f32_16x16x32_bf16 v[36:39], v[168:171], a[104:107], v[36:39]
    v_mfma_f32_16x16x32_bf16 v[40:43], v[168:171], a[160:163], v[40:43]
    v_mfma_f32_16x16x32_bf16 v[44:47], v[168:171], a[216:219], v[44:47]
    s_waitcnt lgkmcnt(0)
    v_mfma_f32_16x16x32_bf16 v[32:35], v[172:175], a[52:55], v[32:35]
    v_mfma_f32_16x16x32_bf16 v[36:39], v[172:175], a[108:111], v[36:39]
    v_mfma_f32_16x16x32_bf16 v[40:43], v[172:175], a[164:167], v[40:43]
    v_mfma_f32_16x16x32_bf16 v[44:47], v[172:175], a[220:223], v[44:47]
    v_subrev_u32 v8, 6144, v8
    v_xor_b32 v8, 0x2000, v8
    v_xor_b32 v9, 0x2000, v9
    v_xor_b32 v10, 0x2000, v10
    s_mul_i32 s30, s17, 114688
    s_lshl_b32 s31, s6, 12
    s_add_u32 s30, s30, s31
    s_lshl_b32 s31, s3, 10
    s_add_u32 s30, s30, s31
    s_add_u32 s30, s30, 0x1000000
    s_add_u32 s18, s18, 1
    s_nop 1
    v_cndmask_b32 v32, v36, v32, s[60:61]
    v_cndmask_b32 v33, v37, v33, s[60:61]
    v_cndmask_b32 v34, v38, v34, s[60:61]
    v_cndmask_b32 v35, v39, v35, s[60:61]
    v_cvt_pk_bf16_f32 v96, v32, v33
    v_cvt_pk_bf16_f32 v97, v34, v35
    buffer_store_dwordx2 v[96:97], v11, s[8:11], s30 offen offset:0 sc1
    v_cndmask_b32 v40, v44, v40, s[60:61]
    v_cndmask_b32 v41, v45, v41, s[60:61]
    v_cndmask_b32 v42, v46, v42, s[60:61]
    v_cndmask_b32 v43, v47, v43, s[60:61]
    v_cvt_pk_bf16_f32 v98, v40, v41
    v_cvt_pk_bf16_f32 v99, v42, v43
    buffer_store_dwordx2 v[98:99], v11, s[8:11], s30 offen offset:512 sc1
    v_mov_b32 v4, s18
    s_waitcnt vmcnt(0)
    buffer_store_dword v4, off, s[8:11], s19 sc1
    s_add_u32 s17, s17, 2
    s_cmp_lt_u32 s12, 64
    s_cbranch_scc1 rd_loop
    s_cmp_lt_u32 s17, 64
    s_cbranch_scc1 rv_loop
    s_endpgm
role_xs:
    s_mul_i32 s4, s30, 16385
    s_lshr_b32 s4, s4, 16
    s_mul_i32 s31, s4, 4
    s_sub_u32 s12, s30, s31
    v_lshlrev_b32 v1, 4, v0
    v_and_b32 v2, 15, v0
    v_lshrrev_b32 v3, 4, v0
    s_mul_i32 s31, s4, 28
    s_mul_i32 s32, s3, 7
    s_add_u32 s31, s31, s32
    s_mul_i32 s31, s31, 14336
    buffer_load_dwordx4 a[0:3], v1, s[8:11], s31 offen offset:0 sc1
    buffer_load_dwordx4 a[4:7], v1, s[8:11], s31 offen offset:1024 sc1
    buffer_load_dwordx4 a[8:11], v1, s[8:11], s31 offen offset:2048 sc1
    buffer_load_dwordx4 a[12:15], v1, s[8:11], s31 offen offset:3072 sc1
    s_add_u32 s31, s31, 4096
    buffer_load_dwordx4 a[16:19], v1, s[8:11], s31 offen offset:0 sc1
    buffer_load_dwordx4 a[20:23], v1, s[8:11], s31 offen offset:1024 sc1
    buffer_load_dwordx4 a[24:27], v1, s[8:11], s31 offen offset:2048 sc1
    buffer_load_dwordx4 a[28:31], v1, s[8:11], s31 offen offset:3072 sc1
    s_add_u32 s31, s31, 4096
    buffer_load_dwordx4 a[32:35], v1, s[8:11], s31 offen offset:0 sc1
    buffer_load_dwordx4 a[36:39], v1, s[8:11], s31 offen offset:1024 sc1
    buffer_load_dwordx4 a[40:43], v1, s[8:11], s31 offen offset:2048 sc1
    buffer_load_dwordx4 a[44:47], v1, s[8:11], s31 offen offset:3072 sc1
    s_add_u32 s31, s31, 4096
    buffer_load_dwordx4 a[48:51], v1, s[8:11], s31 offen offset:0 sc1
    buffer_load_dwordx4 a[52:55], v1, s[8:11], s31 offen offset:1024 sc1
    buffer_load_dwordx4 a[56:59], v1, s[8:11], s31 offen offset:2048 sc1
    buffer_load_dwordx4 a[60:63], v1, s[8:11], s31 offen offset:3072 sc1
    s_add_u32 s31, s31, 4096
    buffer_load_dwordx4 a[64:67], v1, s[8:11], s31 offen offset:0 sc1
    buffer_load_dwordx4 a[68:71], v1, s[8:11], s31 offen offset:1024 sc1
    buffer_load_dwordx4 a[72:75], v1, s[8:11], s31 offen offset:2048 sc1
    buffer_load_dwordx4 a[76:79], v1, s[8:11], s31 offen offset:3072 sc1
    s_add_u32 s31, s31, 4096
    buffer_load_dwordx4 a[80:83], v1, s[8:11], s31 offen offset:0 sc1
    buffer_load_dwordx4 a[84:87], v1, s[8:11], s31 offen offset:1024 sc1
    buffer_load_dwordx4 a[88:91], v1, s[8:11], s31 offen offset:2048 sc1
    buffer_load_dwordx4 a[92:95], v1, s[8:11], s31 offen offset:3072 sc1
    s_add_u32 s31, s31, 4096
    buffer_load_dwordx4 a[96:99], v1, s[8:11], s31 offen offset:0 sc1
    buffer_load_dwordx4 a[100:103], v1, s[8:11], s31 offen offset:1024 sc1
    buffer_load_dwordx4 a[104:107], v1, s[8:11], s31 offen offset:2048 sc1
    buffer_load_dwordx4 a[108:111], v1, s[8:11], s31 offen offset:3072 sc1
    s_add_u32 s31, s31, 4096
    buffer_load_dwordx4 a[112:115], v1, s[8:11], s31 offen offset:0 sc1
    buffer_load_dwordx4 a[116:119], v1, s[8:11], s31 offen offset:1024 sc1
    buffer_load_dwordx4 a[120:123], v1, s[8:11], s31 offen offset:2048 sc1
    buffer_load_dwordx4 a[124:127], v1, s[8:11], s31 offen offset:3072 sc1
    s_add_u32 s31, s31, 4096
    buffer_load_dwordx4 a[128:131], v1, s[8:11], s31 offen offset:0 sc1
    buffer_load_dwordx4 a[132:135], v1, s[8:11], s31 offen offset:1024 sc1
    buffer_load_dwordx4 a[136:139], v1, s[8:11], s31 offen offset:2048 sc1
    buffer_load_dwordx4 a[140:143], v1, s[8:11], s31 offen offset:3072 sc1
    s_add_u32 s31, s31, 4096
    buffer_load_dwordx4 a[144:147], v1, s[8:11], s31 offen offset:0 sc1
    buffer_load_dwordx4 a[148:151], v1, s[8:11], s31 offen offset:1024 sc1
    buffer_load_dwordx4 a[152:155], v1, s[8:11], s31 offen offset:2048 sc1
    buffer_load_dwordx4 a[156:159], v1, s[8:11], s31 offen offset:3072 sc1
    s_add_u32 s31, s31, 4096
    buffer_load_dwordx4 a[160:163], v1, s[8:11], s31 offen offset:0 sc1
    buffer_load_dwordx4 a[164:167], v1, s[8:11], s31 offen offset:1024 sc1
    buffer_load_dwordx4 a[168:171], v1, s[8:11], s31 offen offset:2048 sc1
    buffer_load_dwordx4 a[172:175], v1, s[8:11], s31 offen offset:3072 sc1
    s_add_u32 s31, s31, 4096
    buffer_load_dwordx4 a[176:179], v1, s[8:11], s31 offen offset:0 sc1
    buffer_load_dwordx4 a[180:183], v1, s[8:11], s31 offen offset:1024 sc1
    buffer_load_dwordx4 a[184:187], v1, s[8:11], s31 offen offset:2048 sc1
    buffer_load_dwordx4 a[188:191], v1, s[8:11], s31 offen offset:3072 sc1
    s_add_u32 s31, s31, 4096
    buffer_load_dwordx4 a[192:195], v1, s[8:11], s31 offen offset:0 sc1
    s_waitcnt vmcnt(40)
    buffer_load_dwordx4 a[196:199], v1, s[8:11], s31 offen offset:1024 sc1
    buffer_load_dwordx4 a[200:203], v1, s[8:11], s31 offen offset:2048 sc1
    buffer_load_dwordx4 a[204:207], v1, s[8:11], s31 offen offset:3072 sc1
    s_add_u32 s31, s31, 4096
    buffer_load_dwordx4 a[208:211], v1, s[8:11], s31 offen offset:0 sc1
    buffer_load_dwordx4 a[212:215], v1, s[8:11], s31 offen offset:1024 sc1
    buffer_load_dwordx4 a[216:219], v1, s[8:11], s31 offen offset:2048 sc1
    buffer_load_dwordx4 a[220:223], v1, s[8:11], s31 offen offset:3072 sc1
    s_add_u32 s31, s31, 4096
    buffer_load_dwordx4 a[224:227], v1, s[8:11], s31 offen offset:0 sc1
    s_waitcnt vmcnt(40)
    buffer_load_dwordx4 a[228:231], v1, s[8:11], s31 offen offset:1024 sc1
    buffer_load_dwordx4 a[232:235], v1, s[8:11], s31 offen offset:2048 sc1
    buffer_load_dwordx4 a[236:239], v1, s[8:11], s31 offen offset:3072 sc1
    s_add_u32 s31, s31, 4096
    buffer_load_dwordx4 a[240:243], v1, s[8:11], s31 offen offset:0 sc1
    buffer_load_dwordx4 a[244:247], v1, s[8:11], s31 offen offset:1024 sc1
    buffer_load_dwordx4 a[248:251], v1, s[8:11], s31 offen offset:2048 sc1
    buffer_load_dwordx4 a[252:255], v1, s[8:11], s31 offen offset:3072 sc1
    s_add_u32 s31, s31, 4096
    buffer_load_dwordx4 v[120:123], v1, s[8:11], s31 offen offset:0 sc1
    s_waitcnt vmcnt(40)
    buffer_load_dwordx4 v[124:127], v1, s[8:11], s31 offen offset:1024 sc1
    buffer_load_dwordx4 v[128:131], v1, s[8:11], s31 offen offset:2048 sc1
    buffer_load_dwordx4 v[132:135], v1, s[8:11], s31 offen offset:3072 sc1
    s_add_u32 s31, s31, 4096
    buffer_load_dwordx4 v[136:139], v1, s[8:11], s31 offen offset:0 sc1
    buffer_load_dwordx4 v[140:143], v1, s[8:11], s31 offen offset:1024 sc1
    buffer_load_dwordx4 v[144:147], v1, s[8:11], s31 offen offset:2048 sc1
    buffer_load_dwordx4 v[148:151], v1, s[8:11], s31 offen offset:3072 sc1
    s_add_u32 s31, s31, 4096
    buffer_load_dwordx4 v[152:155], v1, s[8:11], s31 offen offset:0 sc1
    s_waitcnt vmcnt(40)
    buffer_load_dwordx4 v[156:159], v1, s[8:11], s31 offen offset:1024 sc1
    buffer_load_dwordx4 v[160:163], v1, s[8:11], s31 offen offset:2048 sc1
    buffer_load_dwordx4 v[164:167], v1, s[8:11], s31 offen offset:3072 sc1
    s_add_u32 s31, s31, 4096
    buffer_load_dwordx4 v[168:171], v1, s[8:11], s31 offen offset:0 sc1
    buffer_load_dwordx4 v[172:175], v1, s[8:11], s31 offen offset:1024 sc1
    buffer_load_dwordx4 v[176:179], v1, s[8:11], s31 offen offset:2048 sc1
    buffer_load_dwordx4 v[180:183], v1, s[8:11], s31 offen offset:3072 sc1
    s_add_u32 s31, s31, 4096
    buffer_load_dwordx4 v[184:187], v1, s[8:11], s31 offen offset:0 sc1
    s_waitcnt vmcnt(40)
    buffer_load_dwordx4 v[188:191], v1, s[8:11], s31 offen offset:1024 sc1
    buffer_load_dwordx4 v[192:195], v1, s[8:11], s31 offen offset:2048 sc1
    buffer_load_dwordx4 v[196:199], v1, s[8:11], s31 offen offset:3072 sc1
    s_add_u32 s31, s31, 4096
    buffer_load_dwordx4 v[200:203], v1, s[8:11], s31 offen offset:0 sc1
    buffer_load_dwordx4 v[204:207], v1, s[8:11], s31 offen offset:1024 sc1
    buffer_load_dwordx4 v[208:211], v1, s[8:11], s31 offen offset:2048 sc1
    buffer_load_dwordx4 v[212:215], v1, s[8:11], s31 offen offset:3072 sc1
    s_add_u32 s31, s31, 4096
    buffer_load_dwordx4 v[216:219], v1, s[8:11], s31 offen offset:0 sc1
    s_waitcnt vmcnt(40)
    buffer_load_dwordx4 v[220:223], v1, s[8:11], s31 offen offset:1024 sc1
    buffer_load_dwordx4 v[224:227], v1, s[8:11], s31 offen offset:2048 sc1
    buffer_load_dwordx4 v[228:231], v1, s[8:11], s31 offen offset:3072 sc1
    s_add_u32 s31, s31, 4096
    buffer_load_dwordx4 v[232:235], v1, s[8:11], s31 offen offset:0 sc1
    buffer_load_dwordx4 v[236:239], v1, s[8:11], s31 offen offset:1024 sc1
    buffer_load_dwordx4 v[240:243], v1, s[8:11], s31 offen offset:2048 sc1
    buffer_load_dwordx4 v[244:247], v1, s[8:11], s31 offen offset:3072 sc1
    s_add_u32 s31, s31, 4096
    buffer_load_dwordx4 v[248:251], v1, s[8:11], s31 offen offset:0 sc1
    s_waitcnt vmcnt(40)
    buffer_load_dwordx4 v[252:255], v1, s[8:11], s31 offen offset:1024 sc1
    s_mul_i32 s30, s3, 7168
    s_mul_i32 s34, s12, 28672
    s_add_u32 s34, s34, s30
    s_add_u32 s34, s34, 0xc40000
    s_lshr_b32 s31, s3, 1
    s_lshl_b32 s31, s31, 6
    s_add_u32 s36, s30, s31
    s_add_u32 s36, s36, 0
    s_mov_b32 s50, 28800
    v_mov_b32 v6, v1
    v_lshrrev_b32 v4, 3, v2
    s_movk_i32 s30, 14400
    v_mul_u32_u24 v7, s30, v4
    v_bfe_u32 v4, v0, 2, 1
    v_lshl_add_u32 v7, v4, 7, v7
    v_and_b32 v4, 3, v0
    v_lshl_add_u32 v7, v4, 4, v7
    v_add_u32 v7, 0, v7
    v_lshrrev_b32 v4, 1, v3
    s_mul_i32 s31, s3, 14
    v_add_u32 v4, s31, v4
    v_lshl_add_u32 v7, v4, 8, v7
    v_and_b32 v4, 1, v3
    v_lshl_add_u32 v7, v4, 3, v7
    v_bfe_u32 v4, v0, 1, 2
    v_lshlrev_b32 v8, 6, v4
    v_and_b32 v4, 1, v0
    v_lshl_add_u32 v8, v4, 4, v8
    v_lshl_add_u32 v8, v3, 2, v8
    s_mul_i32 s31, s3, 1792
    s_add_u32 s31, s31, 57600
    v_add_u32 v8, s31, v8
    s_lshl_b32 s15, s3, 11
    s_add_u32 s16, s15, 1024
    s_cmp_eq_u32 s3, 3
    s_cselect_b32 s16, 0, s16
    s_add_u32 s31, s15, 57600
    v_add_u32 v9, s31, v1
    s_add_u32 s31, s16, 57600
    v_add_u32 v10, s31, v1
    s_mul_i32 s31, s3, 6144
    s_add_u32 s31, s31, 64768
    v_add_u32 v11, s31, v1
    s_lshl_b32 s31, s3, 10
    s_add_u32 s31, s31, 64768
    v_add_u32 v12, s31, v1
    s_lshl_b32 s31, s3, 4
    v_add_u32 v4, s31, v2
    v_lshlrev_b32 v5, 3, v3
    v_sub_u32 v4, v4, v5
    v_cmp_gt_i32 s[64:65], 0, v4
    v_cmp_gt_i32 s[66:67], 1, v4
    v_cmp_gt_i32 s[68:69], 2, v4
    v_cmp_gt_i32 s[70:71], 3, v4
    v_cmp_gt_i32 s[72:73], 4, v4
    v_cmp_gt_i32 s[74:75], 5, v4
    v_cmp_gt_i32 s[76:77], 6, v4
    v_cmp_gt_i32 s[78:79], 7, v4
    v_cmp_gt_u32 vcc, 2, v3
    v_mov_b32 v13, 0xff800000
    s_nop 0
    v_cndmask_b32 v14, 0, 1.0, vcc
    s_lshl_b32 s31, s4, 11
    s_lshl_b32 s32, s3, 10
    s_add_u32 s31, s31, s32
    v_add_u32 v15, s31, v1
    s_lshr_b32 s31, s4, 2
    s_lshl_b32 s31, s31, 11
    s_add_u32 s31, s31, s32
    s_and_b32 s32, s4, 3
    s_lshl_b32 s32, s32, 8
    s_add_u32 s31, s31, s32
    s_add_u32 s31, s31, 32768
    v_and_b32 v4, 1, v3
    v_lshlrev_b32 v16, 4, v2
    v_lshl_add_u32 v16, v4, 3, v16
    v_add_u32 v16, s31, v16
    s_lshl_b32 s35, s12, 7
    s_lshl_b32 s31, s4, 3
    s_add_u32 s35, s35, s31
    s_lshl_b32 s31, s3, 2
    s_add_u32 s35, s35, s31
    s_add_u32 s35, s35, 0xf80200
    v_mov_b32 v17, 0
    s_mov_b32 s13, 0
    s_mov_b32 m0, s36
    s_add_u32 s30, s34, 4096
    buffer_load_dwordx4 v1, s[8:11], s34 offen offset:0 sc1 lds
    buffer_load_dwordx4 v1, s[8:11], s34 offen offset:1024 sc1 lds
    buffer_load_dwordx4 v1, s[8:11], s34 offen offset:2048 sc1 lds
    buffer_load_dwordx4 v1, s[8:11], s34 offen offset:3072 sc1 lds
    s_add_u32 m0, s36, 4096
    s_nop 0
    buffer_load_dwordx4 v1, s[8:11], s30 offen offset:0 sc1 lds
    buffer_load_dwordx4 v1, s[8:11], s30 offen offset:1024 sc1 lds
    buffer_load_dwordx4 v1, s[8:11], s30 offen offset:2048 sc1 lds
rx_loop:
    s_waitcnt vmcnt(0)
    s_barrier
    s_add_u32 s34, s34, 114688
    s_add_u32 s36, s36, s50
    s_mov_b32 m0, s36
    s_add_u32 s30, s34, 4096
    buffer_load_dwordx4 v1, s[8:11], s34 offen offset:0 sc1 lds
    buffer_load_dwordx4 v1, s[8:11], s34 offen offset:1024 sc1 lds
    buffer_load_dwordx4 v1, s[8:11], s34 offen offset:2048 sc1 lds
    buffer_load_dwordx4 v1, s[8:11], s34 offen offset:3072 sc1 lds
    s_add_u32 m0, s36, 4096
    s_nop 0
    buffer_load_dwordx4 v1, s[8:11], s30 offen offset:0 sc1 lds
    buffer_load_dwordx4 v1, s[8:11], s30 offen offset:1024 sc1 lds
    buffer_load_dwordx4 v1, s[8:11], s30 offen offset:2048 sc1 lds
    ds_read_b128 v[76:79], v6 offset:0
    ds_read_b128 v[80:83], v6 offset:14400
    ds_read_b128 v[84:87], v6 offset:1024
    ds_read_b128 v[88:91], v6 offset:15424
    s_waitcnt lgkmcnt(2)
    v_mfma_f32_16x16x32_bf16 v[20:23], a[0:3], v[76:79], 0
    v_mfma_f32_16x16x32_bf16 v[24:27], a[0:3], v[80:83], 0
    v_mfma_f32_16x16x32_bf16 v[28:31], a[56:59], v[76:79], 0
    v_mfma_f32_16x16x32_bf16 v[32:35], a[56:59], v[80:83], 0
    v_mfma_f32_16x16x32_bf16 v[36:39], a[112:115], v[76:79], 0
    v_mfma_f32_16x16x32_bf16 v[40:43], a[112:115], v[80:83], 0
    v_mfma_f32_16x16x32_bf16 v[44:47], a[168:171], v[76:79], 0
    v_mfma_f32_16x16x32_bf16 v[48:51], a[168:171], v[80:83], 0
    v_mfma_f32_16x16x32_bf16 v[52:55], a[224:227], v[76:79], 0
    v_mfma_f32_16x16x32_bf16 v[56:59], a[224:227], v[80:83], 0
    v_mfma_f32_16x16x32_bf16 v[60:63], v[144:147], v[76:79], 0
    v_mfma_f32_16x16x32_bf16 v[64:67], v[144:147], v[80:83], 0
    v_mfma_f32_16x16x32_bf16 v[68:71], v[200:203], v[76:79], 0
    v_mfma_f32_16x16x32_bf16 v[72:75], v[200:203], v[80:83], 0
    ds_read_b128 v[76:79], v6 offset:2048
    ds_read_b128 v[80:83], v6 offset:16448
    s_waitcnt lgkmcnt(2)
    v_mfma_f32_16x16x32_bf16 v[20:23], a[4:7], v[84:87], v[20:23]
    v_mfma_f32_16x16x32_bf16 v[24:27], a[4:7], v[88:91], v[24:27]
    v_mfma_f32_16x16x32_bf16 v[28:31], a[60:63], v[84:87], v[28:31]
    v_mfma_f32_16x16x32_bf16 v[32:35], a[60:63], v[88:91], v[32:35]
    v_mfma_f32_16x16x32_bf16 v[36:39], a[116:119], v[84:87], v[36:39]
    v_mfma_f32_16x16x32_bf16 v[40:43], a[116:119], v[88:91], v[40:43]
    v_mfma_f32_16x16x32_bf16 v[44:47], a[172:175], v[84:87], v[44:47]
    v_mfma_f32_16x16x32_bf16 v[48:51], a[172:175], v[88:91], v[48:51]
    v_mfma_f32_16x16x32_bf16 v[52:55], a[228:231], v[84:87], v[52:55]
    v_mfma_f32_16x16x32_bf16 v[56:59], a[228:231], v[88:91], v[56:59]
    v_mfma_f32_16x16x32_bf16 v[60:63], v[148:151], v[84:87], v[60:63]
    v_mfma_f32_16x16x32_bf16 v[64:67], v[148:151], v[88:91], v[64:67]
    v_mfma_f32_16x16x32_bf16 v[68:71], v[204:207], v[84:87], v[68:71]
    v_mfma_f32_16x16x32_bf16 v[72:75], v[204:207], v[88:91], v[72:75]
    ds_read_b128 v[84:87], v6 offset:3072
    ds_read_b128 v[88:91], v6 offset:17472
    s_waitcnt lgkmcnt(2)
    v_mfma_f32_16x16x32_bf16 v[20:23], a[8:11], v[76:79], v[20:23]
    v_mfma_f32_16x16x32_bf16 v[24:27], a[8:11], v[80:83], v[24:27]
    v_mfma_f32_16x16x32_bf16 v[28:31], a[64:67], v[76:79], v[28:31]
    v_mfma_f32_16x16x32_bf16 v[32:35], a[64:67], v[80:83], v[32:35]
    v_mfma_f32_16x16x32_bf16 v[36:39], a[120:123], v[76:79], v[36:39]
    v_mfma_f32_16x16x32_bf16 v[40:43], a[120:123], v[80:83], v[40:43]
    v_mfma_f32_16x16x32_bf16 v[44:47], a[176:179], v[76:79], v[44:47]
    v_mfma_f32_16x16x32_bf16 v[48:51], a[176:179], v[80:83], v[48:51]
    v_mfma_f32_16x16x32_bf16 v[52:55], a[232:235], v[76:79], v[52:55]
    v_mfma_f32_16x16x32_bf16 v[56:59], a[232:235], v[80:83], v[56:59]
    v_mfma_f32_16x16x32_bf16 v[60:63], v[152:155], v[76:79], v[60:63]
    v_mfma_f32_16x16x32_bf16 v[64:67], v[152:155], v[80:83], v[64:67]
    v_mfma_f32_16x16x32_bf16 v[68:71], v[208:211], v[76:79], v[68:71]
    v_mfma_f32_16x16x32_bf16 v[72:75], v[208:211], v[80:83], v[72:75]
    ds_read_b128 v[76:79], v6 offset:4096
    ds_read_b128 v[80:83], v6 offset:18496
    s_waitcnt lgkmcnt(2)
    v_mfma_f32_16x16x32_bf16 v[20:23], a[12:15], v[84:87], v[20:23]
    v_mfma_f32_16x16x32_bf16 v[24:27], a[12:15], v[88:91], v[24:27]
    v_mfma_f32_16x16x32_bf16 v[28:31], a[68:71], v[84:87], v[28:31]
    v_mfma_f32_16x16x32_bf16 v[32:35], a[68:71], v[88:91], v[32:35]
    v_mfma_f32_16x16x32_bf16 v[36:39], a[124:127], v[84:87], v[36:39]
    v_mfma_f32_16x16x32_bf16 v[40:43], a[124:127], v[88:91], v[40:43]
    v_mfma_f32_16x16x32_bf16 v[44:47], a[180:183], v[84:87], v[44:47]
    v_mfma_f32_16x16x32_bf16 v[48:51], a[180:183], v[88:91], v[48:51]
    v_mfma_f32_16x16x32_bf16 v[52:55], a[236:239], v[84:87], v[52:55]
    v_mfma_f32_16x16x32_bf16 v[56:59], a[236:239], v[88:91], v[56:59]
    v_mfma_f32_16x16x32_bf16 v[60:63], v[156:159], v[84:87], v[60:63]
    v_mfma_f32_16x16x32_bf16 v[64:67], v[156:159], v[88:91], v[64:67]
    v_mfma_f32_16x16x32_bf16 v[68:71], v[212:215], v[84:87], v[68:71]
    v_mfma_f32_16x16x32_bf16 v[72:75], v[212:215], v[88:91], v[72:75]
    ds_read_b128 v[84:87], v6 offset:5120
    ds_read_b128 v[88:91], v6 offset:19520
    s_waitcnt lgkmcnt(2)
    v_mfma_f32_16x16x32_bf16 v[20:23], a[16:19], v[76:79], v[20:23]
    v_mfma_f32_16x16x32_bf16 v[24:27], a[16:19], v[80:83], v[24:27]
    v_mfma_f32_16x16x32_bf16 v[28:31], a[72:75], v[76:79], v[28:31]
    v_mfma_f32_16x16x32_bf16 v[32:35], a[72:75], v[80:83], v[32:35]
    v_mfma_f32_16x16x32_bf16 v[36:39], a[128:131], v[76:79], v[36:39]
    v_mfma_f32_16x16x32_bf16 v[40:43], a[128:131], v[80:83], v[40:43]
    v_mfma_f32_16x16x32_bf16 v[44:47], a[184:187], v[76:79], v[44:47]
    v_mfma_f32_16x16x32_bf16 v[48:51], a[184:187], v[80:83], v[48:51]
    v_mfma_f32_16x16x32_bf16 v[52:55], a[240:243], v[76:79], v[52:55]
    v_mfma_f32_16x16x32_bf16 v[56:59], a[240:243], v[80:83], v[56:59]
    v_mfma_f32_16x16x32_bf16 v[60:63], v[160:163], v[76:79], v[60:63]
    v_mfma_f32_16x16x32_bf16 v[64:67], v[160:163], v[80:83], v[64:67]
    v_mfma_f32_16x16x32_bf16 v[68:71], v[216:219], v[76:79], v[68:71]
    v_mfma_f32_16x16x32_bf16 v[72:75], v[216:219], v[80:83], v[72:75]
    ds_read_b128 v[76:79], v6 offset:6144
    ds_read_b128 v[80:83], v6 offset:20544
    s_waitcnt lgkmcnt(2)
    v_mfma_f32_16x16x32_bf16 v[20:23], a[20:23], v[84:87], v[20:23]
    v_mfma_f32_16x16x32_bf16 v[24:27], a[20:23], v[88:91], v[24:27]
    v_mfma_f32_16x16x32_bf16 v[28:31], a[76:79], v[84:87], v[28:31]
    v_mfma_f32_16x16x32_bf16 v[32:35], a[76:79], v[88:91], v[32:35]
    v_mfma_f32_16x16x32_bf16 v[36:39], a[132:135], v[84:87], v[36:39]
    v_mfma_f32_16x16x32_bf16 v[40:43], a[132:135], v[88:91], v[40:43]
    v_mfma_f32_16x16x32_bf16 v[44:47], a[188:191], v[84:87], v[44:47]
    v_mfma_f32_16x16x32_bf16 v[48:51], a[188:191], v[88:91], v[48:51]
    v_mfma_f32_16x16x32_bf16 v[52:55], a[244:247], v[84:87], v[52:55]
    v_mfma_f32_16x16x32_bf16 v[56:59], a[244:247], v[88:91], v[56:59]
    v_mfma_f32_16x16x32_bf16 v[60:63], v[164:167], v[84:87], v[60:63]
    v_mfma_f32_16x16x32_bf16 v[64:67], v[164:167], v[88:91], v[64:67]
    v_mfma_f32_16x16x32_bf16 v[68:71], v[220:223], v[84:87], v[68:71]
    v_mfma_f32_16x16x32_bf16 v[72:75], v[220:223], v[88:91], v[72:75]
    ds_read_b128 v[84:87], v6 offset:7168
    ds_read_b128 v[88:91], v6 offset:21568
    s_waitcnt lgkmcnt(2)
    v_mfma_f32_16x16x32_bf16 v[20:23], a[24:27], v[76:79], v[20:23]
    v_mfma_f32_16x16x32_bf16 v[24:27], a[24:27], v[80:83], v[24:27]
    v_mfma_f32_16x16x32_bf16 v[28:31], a[80:83], v[76:79], v[28:31]
    v_mfma_f32_16x16x32_bf16 v[32:35], a[80:83], v[80:83], v[32:35]
    v_mfma_f32_16x16x32_bf16 v[36:39], a[136:139], v[76:79], v[36:39]
    v_mfma_f32_16x16x32_bf16 v[40:43], a[136:139], v[80:83], v[40:43]
    v_mfma_f32_16x16x32_bf16 v[44:47], a[192:195], v[76:79], v[44:47]
    v_mfma_f32_16x16x32_bf16 v[48:51], a[192:195], v[80:83], v[48:51]
    v_mfma_f32_16x16x32_bf16 v[52:55], a[248:251], v[76:79], v[52:55]
    v_mfma_f32_16x16x32_bf16 v[56:59], a[248:251], v[80:83], v[56:59]
    v_mfma_f32_16x16x32_bf16 v[60:63], v[168:171], v[76:79], v[60:63]
    v_mfma_f32_16x16x32_bf16 v[64:67], v[168:171], v[80:83], v[64:67]
    v_mfma_f32_16x16x32_bf16 v[68:71], v[224:227], v[76:79], v[68:71]
    v_mfma_f32_16x16x32_bf16 v[72:75], v[224:227], v[80:83], v[72:75]
    ds_read_b128 v[76:79], v6 offset:8192
    ds_read_b128 v[80:83], v6 offset:22592
    s_waitcnt lgkmcnt(2)
    v_mfma_f32_16x16x32_bf16 v[20:23], a[28:31], v[84:87], v[20:23]
    v_mfma_f32_16x16x32_bf16 v[24:27], a[28:31], v[88:91], v[24:27]
    v_mfma_f32_16x16x32_bf16 v[28:31], a[84:87], v[84:87], v[28:31]
    v_mfma_f32_16x16x32_bf16 v[32:35], a[84:87], v[88:91], v[32:35]
    v_mfma_f32_16x16x32_bf16 v[36:39], a[140:143], v[84:87], v[36:39]
    v_mfma_f32_16x16x32_bf16 v[40:43], a[140:143], v[88:91], v[40:43]
    v_mfma_f32_16x16x32_bf16 v[44:47], a[196:199], v[84:87], v[44:47]
    v_mfma_f32_16x16x32_bf16 v[48:51], a[196:199], v[88:91], v[48:51]
    v_mfma_f32_16x16x32_bf16 v[52:55], a[252:255], v[84:87], v[52:55]
    v_mfma_f32_16x16x32_bf16 v[56:59], a[252:255], v[88:91], v[56:59]
    v_mfma_f32_16x16x32_bf16 v[60:63], v[172:175], v[84:87], v[60:63]
    v_mfma_f32_16x16x32_bf16 v[64:67], v[172:175], v[88:91], v[64:67]
    v_mfma_f32_16x16x32_bf16 v[68:71], v[228:231], v[84:87], v[68:71]
    v_mfma_f32_16x16x32_bf16 v[72:75], v[228:231], v[88:91], v[72:75]
    ds_read_b128 v[84:87], v6 offset:9216
    ds_read_b128 v[88:91], v6 offset:23616
    s_waitcnt lgkmcnt(2)
    v_mfma_f32_16x16x32_bf16 v[20:23], a[32:35], v[76:79], v[20:23]
    v_mfma_f32_16x16x32_bf16 v[24:27], a[32:35], v[80:83], v[24:27]
    v_mfma_f32_16x16x32_bf16 v[28:31], a[88:91], v[76:79], v[28:31]
    v_mfma_f32_16x16x32_bf16 v[32:35], a[88:91], v[80:83], v[32:35]
    v_mfma_f32_16x16x32_bf16 v[36:39], a[144:147], v[76:79], v[36:39]
    v_mfma_f32_16x16x32_bf16 v[40:43], a[144:147], v[80:83], v[40:43]
    v_mfma_f32_16x16x32_bf16 v[44:47], a[200:203], v[76:79], v[44:47]
    v_mfma_f32_16x16x32_bf16 v[48:51], a[200:203], v[80:83], v[48:51]
    v_mfma_f32_16x16x32_bf16 v[52:55], v[120:123], v[76:79], v[52:55]
    v_mfma_f32_16x16x32_bf16 v[56:59], v[120:123], v[80:83], v[56:59]
    v_mfma_f32_16x16x32_bf16 v[60:63], v[176:179], v[76:79], v[60:63]
    v_mfma_f32_16x16x32_bf16 v[64:67], v[176:179], v[80:83], v[64:67]
    v_mfma_f32_16x16x32_bf16 v[68:71], v[232:235], v[76:79], v[68:71]
    v_mfma_f32_16x16x32_bf16 v[72:75], v[232:235], v[80:83], v[72:75]
    ds_read_b128 v[76:79], v6 offset:10240
    ds_read_b128 v[80:83], v6 offset:24640
    s_waitcnt lgkmcnt(2)
    v_mfma_f32_16x16x32_bf16 v[20:23], a[36:39], v[84:87], v[20:23]
    v_mfma_f32_16x16x32_bf16 v[24:27], a[36:39], v[88:91], v[24:27]
    v_mfma_f32_16x16x32_bf16 v[28:31], a[92:95], v[84:87], v[28:31]
    v_mfma_f32_16x16x32_bf16 v[32:35], a[92:95], v[88:91], v[32:35]
    v_mfma_f32_16x16x32_bf16 v[36:39], a[148:151], v[84:87], v[36:39]
    v_mfma_f32_16x16x32_bf16 v[40:43], a[148:151], v[88:91], v[40:43]
    v_mfma_f32_16x16x32_bf16 v[44:47], a[204:207], v[84:87], v[44:47]
    v_mfma_f32_16x16x32_bf16 v[48:51], a[204:207], v[88:91], v[48:51]
    v_mfma_f32_16x16x32_bf16 v[52:55], v[124:127], v[84:87], v[52:55]
    v_mfma_f32_16x16x32_bf16 v[56:59], v[124:127], v[88:91], v[56:59]
    v_mfma_f32_16x16x32_bf16 v[60:63], v[180:183], v[84:87], v[60:63]
    v_mfma_f32_16x16x32_bf16 v[64:67], v[180:183], v[88:91], v[64:67]
    v_mfma_f32_16x16x32_bf16 v[68:71], v[236:239], v[84:87], v[68:71]
    v_mfma_f32_16x16x32_bf16 v[72:75], v[236:239], v[88:91], v[72:75]
    ds_read_b128 v[84:87], v6 offset:11264
    ds_read_b128 v[88:91], v6 offset:25664
    s_waitcnt lgkmcnt(2)
    v_mfma_f32_16x16x32_bf16 v[20:23], a[40:43], v[76:79], v[20:23]
    v_mfma_f32_16x16x32_bf16 v[24:27], a[40:43], v[80:83], v[24:27]
    v_mfma_f32_16x16x32_bf16 v[28:31], a[96:99], v[76:79], v[28:31]
    v_mfma_f32_16x16x32_bf16 v[32:35], a[96:99], v[80:83], v[32:35]
    v_mfma_f32_16x16x32_bf16 v[36:39], a[152:155], v[76:79], v[36:39]
    v_mfma_f32_16x16x32_bf16 v[40:43], a[152:155], v[80:83], v[40:43]
    v_mfma_f32_16x16x32_bf16 v[44:47], a[208:211], v[76:79], v[44:47]
    v_mfma_f32_16x16x32_bf16 v[48:51], a[208:211], v[80:83], v[48:51]
    v_mfma_f32_16x16x32_bf16 v[52:55], v[128:131], v[76:79], v[52:55]
    v_mfma_f32_16x16x32_bf16 v[56:59], v[128:131], v[80:83], v[56:59]
    v_mfma_f32_16x16x32_bf16 v[60:63], v[184:187], v[76:79], v[60:63]
    v_mfma_f32_16x16x32_bf16 v[64:67], v[184:187], v[80:83], v[64:67]
    v_mfma_f32_16x16x32_bf16 v[68:71], v[240:243], v[76:79], v[68:71]
    v_mfma_f32_16x16x32_bf16 v[72:75], v[240:243], v[80:83], v[72:75]
    ds_read_b128 v[76:79], v6 offset:12288
    ds_read_b128 v[80:83], v6 offset:26688
    s_waitcnt lgkmcnt(2)
    v_mfma_f32_16x16x32_bf16 v[20:23], a[44:47], v[84:87], v[20:23]
    v_mfma_f32_16x16x32_bf16 v[24:27], a[44:47], v[88:91], v[24:27]
    v_mfma_f32_16x16x32_bf16 v[28:31], a[100:103], v[84:87], v[28:31]
    v_mfma_f32_16x16x32_bf16 v[32:35], a[100:103], v[88:91], v[32:35]
    v_mfma_f32_16x16x32_bf16 v[36:39], a[156:159], v[84:87], v[36:39]
    v_mfma_f32_16x16x32_bf16 v[40:43], a[156:159], v[88:91], v[40:43]
    v_mfma_f32_16x16x32_bf16 v[44:47], a[212:215], v[84:87], v[44:47]
    v_mfma_f32_16x16x32_bf16 v[48:51], a[212:215], v[88:91], v[48:51]
    v_mfma_f32_16x16x32_bf16 v[52:55], v[132:135], v[84:87], v[52:55]
    v_mfma_f32_16x16x32_bf16 v[56:59], v[132:135], v[88:91], v[56:59]
    v_mfma_f32_16x16x32_bf16 v[60:63], v[188:191], v[84:87], v[60:63]
    v_mfma_f32_16x16x32_bf16 v[64:67], v[188:191], v[88:91], v[64:67]
    v_mfma_f32_16x16x32_bf16 v[68:71], v[244:247], v[84:87], v[68:71]
    v_mfma_f32_16x16x32_bf16 v[72:75], v[244:247], v[88:91], v[72:75]
    ds_read_b128 v[84:87], v6 offset:13312
    ds_read_b128 v[88:91], v6 offset:27712
    s_waitcnt lgkmcnt(2)
    v_mfma_f32_16x16x32_bf16 v[20:23], a[48:51], v[76:79], v[20:23]
    v_mfma_f32_16x16x32_bf16 v[24:27], a[48:51], v[80:83], v[24:27]
    v_mfma_f32_16x16x32_bf16 v[28:31], a[104:107], v[76:79], v[28:31]
    v_mfma_f32_16x16x32_bf16 v[32:35], a[104:107], v[80:83], v[32:35]
    v_mfma_f32_16x16x32_bf16 v[36:39], a[160:163], v[76:79], v[36:39]
    v_mfma_f32_16x16x32_bf16 v[40:43], a[160:163], v[80:83], v[40:43]
    v_mfma_f32_16x16x32_bf16 v[44:47], a[216:219], v[76:79], v[44:47]
    v_mfma_f32_16x16x32_bf16 v[48:51], a[216:219], v[80:83], v[48:51]
    v_mfma_f32_16x16x32_bf16 v[52:55], v[136:139], v[76:79], v[52:55]
    v_mfma_f32_16x16x32_bf16 v[56:59], v[136:139], v[80:83], v[56:59]
    v_mfma_f32_16x16x32_bf16 v[60:63], v[192:195], v[76:79], v[60:63]
    v_mfma_f32_16x16x32_bf16 v[64:67], v[192:195], v[80:83], v[64:67]
    v_mfma_f32_16x16x32_bf16 v[68:71], v[248:251], v[76:79], v[68:71]
    v_mfma_f32_16x16x32_bf16 v[72:75], v[248:251], v[80:83], v[72:75]
    s_waitcnt lgkmcnt(0)
    v_mfma_f32_16x16x32_bf16 v[20:23], a[52:55], v[84:87], v[20:23]
    v_mfma_f32_16x16x32_bf16 v[24:27], a[52:55], v[88:91], v[24:27]
    v_mfma_f32_16x16x32_bf16 v[28:31], a[108:111], v[84:87], v[28:31]
    v_mfma_f32_16x16x32_bf16 v[32:35], a[108:111], v[88:91], v[32:35]
    v_mfma_f32_16x16x32_bf16 v[36:39], a[164:167], v[84:87], v[36:39]
    v_mfma_f32_16x16x32_bf16 v[40:43], a[164:167], v[88:91], v[40:43]
    v_mfma_f32_16x16x32_bf16 v[44:47], a[220:223], v[84:87], v[44:47]
    v_mfma_f32_16x16x32_bf16 v[48:51], a[220:223], v[88:91], v[48:51]
    v_mfma_f32_16x16x32_bf16 v[52:55], v[140:143], v[84:87], v[52:55]
    v_mfma_f32_16x16x32_bf16 v[56:59], v[140:143], v[88:91], v[56:59]
    v_mfma_f32_16x16x32_bf16 v[60:63], v[196:199], v[84:87], v[60:63]
    v_mfma_f32_16x16x32_bf16 v[64:67], v[196:199], v[88:91], v[64:67]
    v_mfma_f32_16x16x32_bf16 v[68:71], v[252:255], v[84:87], v[68:71]
    v_mfma_f32_16x16x32_bf16 v[72:75], v[252:255], v[88:91], v[72:75]
    s_mul_i32 s39, s12, 7168
    s_add_u32 s39, s39, 0xe31800
    s_add_u32 s32, s39, s15
    s_add_u32 s33, s39, s16
    ds_read_b64 v[76:77], v7 offset:0
    ds_read_b64 v[78:79], v7 offset:64
    ds_read_b64 v[80:81], v7 offset:512
    ds_read_b64 v[82:83], v7 offset:576
    ds_read_b64 v[84:85], v7 offset:1024
    ds_read_b64 v[86:87], v7 offset:1088
    s_nop 2
    v_cvt_pk_bf16_f32 v20, v20, v21
    v_cvt_pk_bf16_f32 v21, v22, v23
    v_cvt_pk_bf16_f32 v24, v24, v25
    v_cvt_pk_bf16_f32 v25, v26, v27
    v_cvt_pk_bf16_f32 v28, v28, v29
    v_cvt_pk_bf16_f32 v29, v30, v31
    v_cvt_pk_bf16_f32 v32, v32, v33
    v_cvt_pk_bf16_f32 v33, v34, v35
    v_cvt_pk_bf16_f32 v36, v36, v37
    v_cvt_pk_bf16_f32 v37, v38, v39
    v_cvt_pk_bf16_f32 v40, v40, v41
    v_cvt_pk_bf16_f32 v41, v42, v43
    v_cvt_pk_bf16_f32 v44, v44, v45
    v_cvt_pk_bf16_f32 v45, v46, v47
    v_cvt_pk_bf16_f32 v48, v48, v49
    v_cvt_pk_bf16_f32 v49, v50, v51
    v_cvt_pk_bf16_f32 v52, v52, v53
    v_cvt_pk_bf16_f32 v53, v54, v55
    v_cvt_pk_bf16_f32 v56, v56, v57
    v_cvt_pk_bf16_f32 v57, v58, v59
    v_cvt_pk_bf16_f32 v60, v60, v61
    v_cvt_pk_bf16_f32 v61, v62, v63
    v_cvt_pk_bf16_f32 v64, v64, v65
    v_cvt_pk_bf16_f32 v65, v66, v67
    v_cvt_pk_bf16_f32 v68, v68, v69
    v_cvt_pk_bf16_f32 v69, v70, v71
    v_cvt_pk_bf16_f32 v72, v72, v73
    v_cvt_pk_bf16_f32 v73, v74, v75
    s_nop 1
    ds_read_b64 v[88:89], v7 offset:1536
    ds_read_b64 v[90:91], v7 offset:1600
    s_waitcnt lgkmcnt(6)
    v_mfma_f32_16x16x16_bf16 v[92:95], v[76:77], v[20:21], 0
    v_mfma_f32_16x16x16_bf16 v[96:99], v[76:77], v[24:25], 0
    v_mfma_f32_16x16x16_bf16 v[100:103], v[78:79], v[20:21], 0
    v_mfma_f32_16x16x16_bf16 v[104:107], v[78:79], v[24:25], 0
    ds_read_b64 v[76:77], v7 offset:2048
    ds_read_b64 v[78:79], v7 offset:2112
    s_waitcnt lgkmcnt(6)
    v_mfma_f32_16x16x16_bf16 v[92:95], v[80:81], v[28:29], v[92:95]
    v_mfma_f32_16x16x16_bf16 v[96:99], v[80:81], v[32:33], v[96:99]
    v_mfma_f32_16x16x16_bf16 v[100:103], v[82:83], v[28:29], v[100:103]
    v_mfma_f32_16x16x16_bf16 v[104:107], v[82:83], v[32:33], v[104:107]
    ds_read_b64 v[80:81], v7 offset:2560
    ds_read_b64 v[82:83], v7 offset:2624
    s_waitcnt lgkmcnt(6)
    v_mfma_f32_16x16x16_bf16 v[92:95], v[84:85], v[36:37], v[92:95]
    v_mfma_f32_16x16x16_bf16 v[96:99], v[84:85], v[40:41], v[96:99]
    v_mfma_f32_16x16x16_bf16 v[100:103], v[86:87], v[36:37], v[100:103]
    v_mfma_f32_16x16x16_bf16 v[104:107], v[86:87], v[40:41], v[104:107]
    ds_read_b64 v[84:85], v7 offset:3072
    ds_read_b64 v[86:87], v7 offset:3136
    s_waitcnt lgkmcnt(6)
    v_mfma_f32_16x16x16_bf16 v[92:95], v[88:89], v[44:45], v[92:95]
    v_mfma_f32_16x16x16_bf16 v[96:99], v[88:89], v[48:49], v[96:99]
    v_mfma_f32_16x16x16_bf16 v[100:103], v[90:91], v[44:45], v[100:103]
    v_mfma_f32_16x16x16_bf16 v[104:107], v[90:91], v[48:49], v[104:107]
    s_waitcnt lgkmcnt(4)
    v_mfma_f32_16x16x16_bf16 v[92:95], v[76:77], v[52:53], v[92:95]
    v_mfma_f32_16x16x16_bf16 v[96:99], v[76:77], v[56:57], v[96:99]
    v_mfma_f32_16x16x16_bf16 v[100:103], v[78:79], v[52:53], v[100:103]
    v_mfma_f32_16x16x16_bf16 v[104:107], v[78:79], v[56:57], v[104:107]
    s_waitcnt lgkmcnt(2)
    v_mfma_f32_16x16x16_bf16 v[92:95], v[80:81], v[60:61], v[92:95]
    v_mfma_f32_16x16x16_bf16 v[96:99], v[80:81], v[64:65], v[96:99]
    v_mfma_f32_16x16x16_bf16 v[100:103], v[82:83], v[60:61], v[100:103]
    v_mfma_f32_16x16x16_bf16 v[104:107], v[82:83], v[64:65], v[104:107]
    s_waitcnt lgkmcnt(0)
    v_mfma_f32_16x16x16_bf16 v[92:95], v[84:85], v[68:69], v[92:95]
    v_mfma_f32_16x16x16_bf16 v[96:99], v[84:85], v[72:73], v[96:99]
    v_mfma_f32_16x16x16_bf16 v[100:103], v[86:87], v[68:69], v[100:103]
    v_mfma_f32_16x16x16_bf16 v[104:107], v[86:87], v[72:73], v[104:107]
    v_add_u32 v6, s50, v6
    v_add_u32 v7, s50, v7
    s_sub_u32 s50, 0, s50
    s_mov_b32 s14, 0
xm_131:
    buffer_load_dwordx4 v[76:79], v1, s[8:11], s32 offen sc1
    buffer_load_dwordx4 v[80:83], v1, s[8:11], s33 offen sc1
    s_waitcnt vmcnt(0)
    v_max3_u32 v4, v76, v77, v78
    v_max3_u32 v5, v79, v80, v81
    v_max3_u32 v4, v82, v83, v4
    v_max_u32 v4, v4, v5
    v_cmp_eq_u32 vcc, -1, v4
    s_cbranch_vccz xk_132
    s_sleep 2
    s_add_u32 s14, s14, 1
    s_cmp_lt_u32 s14, 400000
    s_cbranch_scc1 xm_131
    s_endpgm
xk_132:
    ds_write_b128 v9, v[76:79]
    ds_write_b128 v10, v[80:83]
    ds_write_b128 v11, v[92:95] offset:0
    ds_write_b128 v11, v[96:99] offset:1024
    ds_write_b128 v11, v[100:103] offset:2048
    ds_write_b128 v11, v[104:107] offset:3072
    s_waitcnt lgkmcnt(0)
    s_barrier
    ds_read_b32 v76, v8 offset:0
    ds_read_b32 v77, v8 offset:32
    ds_read_b32 v78, v8 offset:256
    ds_read_b32 v79, v8 offset:288
    ds_read_b32 v80, v8 offset:512
    ds_read_b32 v81, v8 offset:544
    ds_read_b32 v82, v8 offset:768
    ds_read_b32 v83, v8 offset:800
    ds_read_b32 v84, v8 offset:1024
    ds_read_b32 v85, v8 offset:1056
    ds_read_b32 v86, v8 offset:1280
    ds_read_b32 v87, v8 offset:1312
    ds_read_b32 v88, v8 offset:1536
    ds_read_b32 v89, v8 offset:1568
    s_waitcnt lgkmcnt(12)
    v_mfma_f32_16x16x16_bf16 v[108:111], v[76:77], v[20:21], 0
    v_mfma_f32_16x16x16_bf16 v[112:115], v[76:77], v[24:25], 0
    s_waitcnt lgkmcnt(10)
    v_mfma_f32_16x16x16_bf16 v[108:111], v[78:79], v[28:29], v[108:111]
    v_mfma_f32_16x16x16_bf16 v[112:115], v[78:79], v[32:33], v[112:115]
    s_waitcnt lgkmcnt(8)
    v_mfma_f32_16x16x16_bf16 v[108:111], v[80:81], v[36:37], v[108:111]
    v_mfma_f32_16x16x16_bf16 v[112:115], v[80:81], v[40:41], v[112:115]
    s_waitcnt lgkmcnt(6)
    v_mfma_f32_16x16x16_bf16 v[108:111], v[82:83], v[44:45], v[108:111]
    v_mfma_f32_16x16x16_bf16 v[112:115], v[82:83], v[48:49], v[112:115]
    s_waitcnt lgkmcnt(4)
    v_mfma_f32_16x16x16_bf16 v[108:111], v[84:85], v[52:53], v[108:111]
    v_mfma_f32_16x16x16_bf16 v[112:115], v[84:85], v[56:57], v[112:115]
    s_waitcnt lgkmcnt(2)
    v_mfma_f32_16x16x16_bf16 v[108:111], v[86:87], v[60:61], v[108:111]
    v_mfma_f32_16x16x16_bf16 v[112:115], v[86:87], v[64:65], v[112:115]
    s_waitcnt lgkmcnt(0)
    v_mfma_f32_16x16x16_bf16 v[108:111], v[88:89], v[68:69], v[108:111]
    v_mfma_f32_16x16x16_bf16 v[112:115], v[88:89], v[72:73], v[112:115]
    s_nop 7
    ds_write_b128 v11, v[108:111] offset:4096
    ds_write_b128 v11, v[112:115] offset:5120
    s_waitcnt lgkmcnt(0)
    s_barrier
    s_add_u32 s13, s13, 1
    s_cmp_lt_u32 s3, 2
    s_cbranch_scc0 xs_133
    ds_read_b128 v[20:23], v12 offset:0
    ds_read_b128 v[24:27], v12 offset:2048
    ds_read_b128 v[28:31], v12 offset:4096
    ds_read_b128 v[32:35], v12 offset:6144
    ds_read_b128 v[36:39], v12 offset:8192
    ds_read_b128 v[40:43], v12 offset:10240
    ds_read_b128 v[44:47], v12 offset:12288
    ds_read_b128 v[48:51], v12 offset:14336
    ds_read_b128 v[52:55], v12 offset:16384
    ds_read_b128 v[56:59], v12 offset:18432
    ds_read_b128 v[60:63], v12 offset:20480
    ds_read_b128 v[64:67], v12 offset:22528
    s_mul_i32 s30, s12, 40960
    s_add_u32 s30, s30, 0x1e00000
    s_waitcnt lgkmcnt(6)
    v_pk_add_f32 v[20:21], v[20:21], v[32:33]
    v_pk_add_f32 v[22:23], v[22:23], v[34:35]
    v_pk_add_f32 v[24:25], v[24:25], v[36:37]
    v_pk_add_f32 v[26:27], v[26:27], v[38:39]
    v_pk_add_f32 v[28:29], v[28:29], v[40:41]
    v_pk_add_f32 v[30:31], v[30:31], v[42:43]
    s_waitcnt lgkmcnt(3)
    v_pk_add_f32 v[20:21], v[20:21], v[44:45]
    v_pk_add_f32 v[22:23], v[22:23], v[46:47]
    v_pk_add_f32 v[24:25], v[24:25], v[48:49]
    v_pk_add_f32 v[26:27], v[26:27], v[50:51]
    v_pk_add_f32 v[28:29], v[28:29], v[52:53]
    v_pk_add_f32 v[30:31], v[30:31], v[54:55]
    s_waitcnt lgkmcnt(0)
    v_pk_add_f32 v[20:21], v[20:21], v[56:57]
    v_pk_add_f32 v[22:23], v[22:23], v[58:59]
    v_pk_add_f32 v[24:25], v[24:25], v[60:61]
    v_pk_add_f32 v[26:27], v[26:27], v[62:63]
    v_pk_add_f32 v[28:29], v[28:29], v[64:65]
    v_pk_add_f32 v[30:31], v[30:31], v[66:67]
    v_cndmask_b32 v20, v20, v13, s[64:65]
    v_cndmask_b32 v21, v21, v13, s[66:67]
    v_cndmask_b32 v22, v22, v13, s[68:69]
    v_cndmask_b32 v23, v23, v13, s[70:71]
    v_cndmask_b32 v24, v24, v13, s[72:73]
    v_cndmask_b32 v25, v25, v13, s[74:75]
    v_cndmask_b32 v26, v26, v13, s[76:77]
    v_cndmask_b32 v27, v27, v13, s[78:79]
    v_max3_f32 v4, v20, v21, v22
    v_max3_f32 v4, v23, v24, v4
    v_max3_f32 v4, v25, v26, v4
    v_max3_f32 v4, v27, v28, v4
    v_max3_f32 v4, v29, v30, v4
    v_max_f32 v4, v31, v4
    v_mov_b32 v5, v4
    s_nop 1
    v_permlane32_swap_b32 v4, v5
    v_max_f32 v4, v4, v5
    v_mov_b32 v5, v4
    s_nop 1
    v_permlane16_swap_b32 v4, v5
    v_max_f32 v4, v4, v5
    v_sub_f32 v20, v20, v4
    v_sub_f32 v21, v21, v4
    v_sub_f32 v22, v22, v4
    v_sub_f32 v23, v23, v4
    v_sub_f32 v24, v24, v4
    v_sub_f32 v25, v25, v4
    v_sub_f32 v26, v26, v4
    v_sub_f32 v27, v27, v4
    v_sub_f32 v28, v28, v4
    v_sub_f32 v29, v29, v4
    v_sub_f32 v30, v30, v4
    v_sub_f32 v31, v31, v4
    v_exp_f32 v20, v20
    v_exp_f32 v21, v21
    v_exp_f32 v22, v22
    v_exp_f32 v23, v23
    v_exp_f32 v24, v24
    v_exp_f32 v25, v25
    v_exp_f32 v26, v26
    v_exp_f32 v27, v27
    v_exp_f32 v28, v28
    v_exp_f32 v29, v29
    v_exp_f32 v30, v30
    v_exp_f32 v31, v31
    v_add_f32 v4, v20, v21
    v_add_f32 v4, v22, v4
    v_add_f32 v4, v23, v4
    v_add_f32 v4, v24, v4
    v_add_f32 v4, v25, v4
    v_add_f32 v4, v26, v4
    v_add_f32 v4, v27, v4
    v_fmac_f32 v4, v28, v14
    v_fmac_f32 v4, v29, v14
    v_fmac_f32 v4, v30, v14
    v_fmac_f32 v4, v31, v14
    v_mov_b32 v5, v4
    s_nop 1
    v_permlane32_swap_b32 v4, v5
    v_add_f32 v4, v4, v5
    v_mov_b32 v5, v4
    s_nop 1
    v_permlane16_swap_b32 v4, v5
    v_add_f32 v4, v4, v5
    v_rcp_f32 v4, v4
    s_nop 0
    v_mul_f32 v20, v20, v4
    v_mul_f32 v21, v21, v4
    v_mul_f32 v22, v22, v4
    v_mul_f32 v23, v23, v4
    v_mul_f32 v24, v24, v4
    v_mul_f32 v25, v25, v4
    v_mul_f32 v26, v26, v4
    v_mul_f32 v27, v27, v4
    v_mul_f32 v28, v28, v4
    v_mul_f32 v29, v29, v4
    v_mul_f32 v30, v30, v4
    v_mul_f32 v31, v31, v4
    v_cvt_pk_bf16_f32 v40, v20, v21
    v_cvt_pk_bf16_f32 v41, v22, v23
    v_cvt_pk_bf16_f32 v42, v24, v25
    v_cvt_pk_bf16_f32 v43, v26, v27
    v_cvt_pk_bf16_f32 v44, v28, v29
    v_cvt_pk_bf16_f32 v45, v30, v31
    buffer_store_dwordx4 v[40:43], v15, s[8:11], s30 offen sc1
    buffer_store_dwordx2 v[44:45], v16, s[8:11], s30 offen sc1
    v_mov_b32 v4, s13
    s_waitcnt vmcnt(0)
    buffer_store_dword v4, v17, s[8:11], s35 offen sc1
xs_133:
    s_add_u32 s12, s12, 4
    s_cmp_lt_u32 s12, 64
    s_cbranch_scc1 rx_loop
    s_endpgm
role_f1:
    s_lshr_b32 s6, s30, 1
    s_and_b32 s12, s30, 1
    s_load_dwordx4 s[56:59], s[0:1], 64
    v_lshlrev_b32 v1, 4, v0
    v_and_b32 v2, 15, v0
    v_lshrrev_b32 v3, 4, v0
    s_lshl_b32 s31, s3, 2
    v_add_u32 v4, s31, v3
    s_movk_i32 s30, 3584
    v_mul_u32_u24 v5, s30, v4
    v_lshl_add_u32 v5, v2, 4, v5
    s_movk_i32 s30, 272
    v_mul_u32_u24 v7, s30, v4
    v_lshl_add_u32 v7, v2, 4, v7
    v_add_u32 v8, 60928, v7
    v_lshrrev_b32 v9, 2, v2
    v_lshl_add_u32 v9, v3, 3, v9
    v_mul_u32_u24 v9, s30, v9
    v_and_b32 v4, 3, v0
    v_lshl_add_u32 v9, v4, 4, v9
    s_lshl_b32 s31, s3, 6
    v_add_u32 v9, s31, v9
    v_add_u32 v10, 60928, v9
    s_waitcnt lgkmcnt(0)
    s_mov_b32 s16, s56
    s_mov_b32 s17, s57
    s_mov_b32 s18, 0x188000
    s_mov_b32 s19, 0x20000
    s_mov_b32 s20, s58
    s_mov_b32 s21, s59
    s_mov_b32 s22, 0x188000
    s_mov_b32 s23, 0x20000
    s_lshl_b32 s31, s6, 8
    buffer_load_dwordx4 v[16:19], v5, s[16:19], s31 offen
    s_add_u32 s31, s31, 57344
    buffer_load_dwordx4 v[20:23], v5, s[16:19], s31 offen
    s_add_u32 s31, s31, 57344
    buffer_load_dwordx4 v[24:27], v5, s[16:19], s31 offen
    s_add_u32 s31, s31, 57344
    buffer_load_dwordx4 v[28:31], v5, s[16:19], s31 offen
    s_add_u32 s31, s31, 57344
    buffer_load_dwordx4 v[32:35], v5, s[16:19], s31 offen
    s_add_u32 s31, s31, 57344
    buffer_load_dwordx4 v[36:39], v5, s[16:19], s31 offen
    s_add_u32 s31, s31, 57344
    buffer_load_dwordx4 v[40:43], v5, s[16:19], s31 offen
    s_add_u32 s31, s31, 57344
    buffer_load_dwordx4 v[44:47], v5, s[16:19], s31 offen
    s_add_u32 s31, s31, 57344
    buffer_load_dwordx4 v[48:51], v5, s[16:19], s31 offen
    s_add_u32 s31, s31, 57344
    buffer_load_dwordx4 v[52:55], v5, s[16:19], s31 offen
    s_add_u32 s31, s31, 57344
    buffer_load_dwordx4 v[56:59], v5, s[16:19], s31 offen
    s_add_u32 s31, s31, 57344
    buffer_load_dwordx4 v[60:63], v5, s[16:19], s31 offen
    s_add_u32 s31, s31, 57344
    buffer_load_dwordx4 v[64:67], v5, s[16:19], s31 offen
    s_add_u32 s31, s31, 57344
    buffer_load_dwordx4 v[68:71], v5, s[16:19], s31 offen
    s_add_u32 s31, s31, 57344
    buffer_load_dwordx4 v[72:75], v5, s[16:19], s31 offen
    s_add_u32 s31, s31, 57344
    buffer_load_dwordx4 v[76:79], v5, s[16:19], s31 offen
    s_add_u32 s31, s31, 57344
    buffer_load_dwordx4 v[80:83], v5, s[16:19], s31 offen
    s_add_u32 s31, s31, 57344
    buffer_load_dwordx4 v[84:87], v5, s[16:19], s31 offen
    s_add_u32 s31, s31, 57344
    buffer_load_dwordx4 v[88:91], v5, s[16:19], s31 offen
    s_add_u32 s31, s31, 57344
    buffer_load_dwordx4 v[92:95], v5, s[16:19], s31 offen
    s_add_u32 s31, s31, 57344
    buffer_load_dwordx4 v[96:99], v5, s[16:19], s31 offen
    s_add_u32 s31, s31, 57344
    buffer_load_dwordx4 v[100:103], v5, s[16:19], s31 offen
    s_add_u32 s31, s31, 57344
    buffer_load_dwordx4 v[104:107], v5, s[16:19], s31 offen
    s_add_u32 s31, s31, 57344
    buffer_load_dwordx4 v[108:111], v5, s[16:19], s31 offen
    s_add_u32 s31, s31, 57344
    buffer_load_dwordx4 v[112:115], v5, s[16:19], s31 offen
    s_add_u32 s31, s31, 57344
    buffer_load_dwordx4 v[116:119], v5, s[16:19], s31 offen
    s_add_u32 s31, s31, 57344
    buffer_load_dwordx4 v[120:123], v5, s[16:19], s31 offen
    s_add_u32 s31, s31, 57344
    buffer_load_dwordx4 v[124:127], v5, s[16:19], s31 offen
    s_lshl_b32 s31, s6, 8
    buffer_load_dwordx4 v[128:131], v5, s[20:23], s31 offen
    s_add_u32 s31, s31, 57344
    buffer_load_dwordx4 v[132:135], v5, s[20:23], s31 offen
    s_add_u32 s31, s31, 57344
    buffer_load_dwordx4 v[136:139], v5, s[20:23], s31 offen
    s_add_u32 s31, s31, 57344
    buffer_load_dwordx4 v[140:143], v5, s[20:23], s31 offen
    s_add_u32 s31, s31, 57344
    buffer_load_dwordx4 v[144:147], v5, s[20:23], s31 offen
    s_add_u32 s31, s31, 57344
    buffer_load_dwordx4 v[148:151], v5, s[20:23], s31 offen
    s_add_u32 s31, s31, 57344
    buffer_load_dwordx4 v[152:155], v5, s[20:23], s31 offen
    s_add_u32 s31, s31, 57344
    buffer_load_dwordx4 v[156:159], v5, s[20:23], s31 offen
    s_add_u32 s31, s31, 57344
    buffer_load_dwordx4 v[160:163], v5, s[20:23], s31 offen
    s_add_u32 s31, s31, 57344
    buffer_load_dwordx4 v[164:167], v5, s[20:23], s31 offen
    s_add_u32 s31, s31, 57344
    buffer_load_dwordx4 v[168:171], v5, s[20:23], s31 offen
    s_add_u32 s31, s31, 57344
    buffer_load_dwordx4 v[172:175], v5, s[20:23], s31 offen
    s_add_u32 s31, s31, 57344
    buffer_load_dwordx4 v[176:179], v5, s[20:23], s31 offen
    s_add_u32 s31, s31, 57344
    buffer_load_dwordx4 v[180:183], v5, s[20:23], s31 offen
    s_add_u32 s31, s31, 57344
    buffer_load_dwordx4 v[184:187], v5, s[20:23], s31 offen
    s_add_u32 s31, s31, 57344
    buffer_load_dwordx4 v[188:191], v5, s[20:23], s31 offen
    s_add_u32 s31, s31, 57344
    buffer_load_dwordx4 v[192:195], v5, s[20:23], s31 offen
    s_add_u32 s31, s31, 57344
    buffer_load_dwordx4 v[196:199], v5, s[20:23], s31 offen
    s_add_u32 s31, s31, 57344
    buffer_load_dwordx4 v[200:203], v5, s[20:23], s31 offen
    s_add_u32 s31, s31, 57344
    buffer_load_dwordx4 v[204:207], v5, s[20:23], s31 offen
    s_add_u32 s31, s31, 57344
    buffer_load_dwordx4 v[208:211], v5, s[20:23], s31 offen
    s_add_u32 s31, s31, 57344
    buffer_load_dwordx4 v[212:215], v5, s[20:23], s31 offen
    s_add_u32 s31, s31, 57344
    buffer_load_dwordx4 v[216:219], v5, s[20:23], s31 offen
    s_add_u32 s31, s31, 57344
    buffer_load_dwordx4 v[220:223], v5, s[20:23], s31 offen
    s_add_u32 s31, s31, 57344
    buffer_load_dwordx4 v[224:227], v5, s[20:23], s31 offen
    s_add_u32 s31, s31, 57344
    buffer_load_dwordx4 v[228:231], v5, s[20:23], s31 offen
    s_add_u32 s31, s31, 57344
    buffer_load_dwordx4 v[232:235], v5, s[20:23], s31 offen
    s_add_u32 s31, s31, 57344
    buffer_load_dwordx4 v[236:239], v5, s[20:23], s31 offen
    s_waitcnt vmcnt(28)
    ds_write_b128 v7, v[16:19] offset:0
    ds_write_b128 v7, v[20:23] offset:4352
    ds_write_b128 v7, v[24:27] offset:8704
    ds_write_b128 v7, v[28:31] offset:13056
    ds_write_b128 v7, v[32:35] offset:17408
    ds_write_b128 v7, v[36:39] offset:21760
    ds_write_b128 v7, v[40:43] offset:26112
    ds_write_b128 v7, v[44:47] offset:30464
    ds_write_b128 v7, v[48:51] offset:34816
    ds_write_b128 v7, v[52:55] offset:39168
    ds_write_b128 v7, v[56:59] offset:43520
    ds_write_b128 v7, v[60:63] offset:47872
    ds_write_b128 v7, v[64:67] offset:52224
    ds_write_b128 v7, v[68:71] offset:56576
    ds_write_b128 v8, v[72:75] offset:0
    ds_write_b128 v8, v[76:79] offset:4352
    ds_write_b128 v8, v[80:83] offset:8704
    ds_write_b128 v8, v[84:87] offset:13056
    ds_write_b128 v8, v[88:91] offset:17408
    ds_write_b128 v8, v[92:95] offset:21760
    ds_write_b128 v8, v[96:99] offset:26112
    ds_write_b128 v8, v[100:103] offset:30464
    ds_write_b128 v8, v[104:107] offset:34816
    ds_write_b128 v8, v[108:111] offset:39168
    ds_write_b128 v8, v[112:115] offset:43520
    ds_write_b128 v8, v[116:119] offset:47872
    ds_write_b128 v8, v[120:123] offset:52224
    ds_write_b128 v8, v[124:127] offset:56576
    s_waitcnt lgkmcnt(0)
    s_barrier
    ds_read_b64_tr_b16 a[0:1], v9 offset:0
    ds_read_b64_tr_b16 a[2:3], v9 offset:1088
    ds_read_b64_tr_b16 a[4:5], v9 offset:8704
    ds_read_b64_tr_b16 a[6:7], v9 offset:9792
    ds_read_b64_tr_b16 a[8:9], v9 offset:17408
    ds_read_b64_tr_b16 a[10:11], v9 offset:18496
    ds_read_b64_tr_b16 a[12:13], v9 offset:26112
    ds_read_b64_tr_b16 a[14:15], v9 offset:27200
    ds_read_b64_tr_b16 a[16:17], v9 offset:34816
    ds_read_b64_tr_b16 a[18:19], v9 offset:35904
    ds_read_b64_tr_b16 a[20:21], v9 offset:43520
    ds_read_b64_tr_b16 a[22:23], v9 offset:44608
    ds_read_b64_tr_b16 a[24:25], v9 offset:52224
    ds_read_b64_tr_b16 a[26:27], v9 offset:53312
    ds_read_b64_tr_b16 a[28:29], v10 offset:0
    ds_read_b64_tr_b16 a[30:31], v10 offset:1088
    ds_read_b64_tr_b16 a[32:33], v10 offset:8704
    ds_read_b64_tr_b16 a[34:35], v10 offset:9792
    ds_read_b64_tr_b16 a[36:37], v10 offset:17408
    ds_read_b64_tr_b16 a[38:39], v10 offset:18496
    ds_read_b64_tr_b16 a[40:41], v10 offset:26112
    ds_read_b64_tr_b16 a[42:43], v10 offset:27200
    ds_read_b64_tr_b16 a[44:45], v10 offset:34816
    ds_read_b64_tr_b16 a[46:47], v10 offset:35904
    ds_read_b64_tr_b16 a[48:49], v10 offset:43520
    ds_read_b64_tr_b16 a[50:51], v10 offset:44608
    ds_read_b64_tr_b16 a[52:53], v10 offset:52224
    ds_read_b64_tr_b16 a[54:55], v10 offset:53312
    ds_read_b64_tr_b16 a[56:57], v9 offset:8
    ds_read_b64_tr_b16 a[58:59], v9 offset:1096
    ds_read_b64_tr_b16 a[60:61], v9 offset:8712
    ds_read_b64_tr_b16 a[62:63], v9 offset:9800
    ds_read_b64_tr_b16 a[64:65], v9 offset:17416
    ds_read_b64_tr_b16 a[66:67], v9 offset:18504
    ds_read_b64_tr_b16 a[68:69], v9 offset:26120
    ds_read_b64_tr_b16 a[70:71], v9 offset:27208
    ds_read_b64_tr_b16 a[72:73], v9 offset:34824
    ds_read_b64_tr_b16 a[74:75], v9 offset:35912
    ds_read_b64_tr_b16 a[76:77], v9 offset:43528
    ds_read_b64_tr_b16 a[78:79], v9 offset:44616
    ds_read_b64_tr_b16 a[80:81], v9 offset:52232
    ds_read_b64_tr_b16 a[82:83], v9 offset:53320
    ds_read_b64_tr_b16 a[84:85], v10 offset:8
    ds_read_b64_tr_b16 a[86:87], v10 offset:1096
    ds_read_b64_tr_b16 a[88:89], v10 offset:8712
    ds_read_b64_tr_b16 a[90:91], v10 offset:9800
    ds_read_b64_tr_b16 a[92:93], v10 offset:17416
    ds_read_b64_tr_b16 a[94:95], v10 offset:18504
    ds_read_b64_tr_b16 a[96:97], v10 offset:26120
    ds_read_b64_tr_b16 a[98:99], v10 offset:27208
    ds_read_b64_tr_b16 a[100:101], v10 offset:34824
    ds_read_b64_tr_b16 a[102:103], v10 offset:35912
    ds_read_b64_tr_b16 a[104:105], v10 offset:43528
    ds_read_b64_tr_b16 a[106:107], v10 offset:44616
    ds_read_b64_tr_b16 a[108:109], v10 offset:52232
    ds_read_b64_tr_b16 a[110:111], v10 offset:53320
    s_waitcnt lgkmcnt(0)
    s_barrier
    s_waitcnt vmcnt(0)
    ds_write_b128 v7, v[128:131] offset:0
    ds_write_b128 v7, v[132:135] offset:4352
    ds_write_b128 v7, v[136:139] offset:8704
    ds_write_b128 v7, v[140:143] offset:13056
    ds_write_b128 v7, v[144:147] offset:17408
    ds_write_b128 v7, v[148:151] offset:21760
    ds_write_b128 v7, v[152:155] offset:26112
    ds_write_b128 v7, v[156:159] offset:30464
    ds_write_b128 v7, v[160:163] offset:34816
    ds_write_b128 v7, v[164:167] offset:39168
    ds_write_b128 v7, v[168:171] offset:43520
    ds_write_b128 v7, v[172:175] offset:47872
    ds_write_b128 v7, v[176:179] offset:52224
    ds_write_b128 v7, v[180:183] offset:56576
    ds_write_b128 v8, v[184:187] offset:0
    ds_write_b128 v8, v[188:191] offset:4352
    ds_write_b128 v8, v[192:195] offset:8704
    ds_write_b128 v8, v[196:199] offset:13056
    ds_write_b128 v8, v[200:203] offset:17408
    ds_write_b128 v8, v[204:207] offset:21760
    ds_write_b128 v8, v[208:211] offset:26112
    ds_write_b128 v8, v[212:215] offset:30464
    ds_write_b128 v8, v[216:219] offset:34816
    ds_write_b128 v8, v[220:223] offset:39168
    ds_write_b128 v8, v[224:227] offset:43520
    ds_write_b128 v8, v[228:231] offset:47872
    ds_write_b128 v8, v[232:235] offset:52224
    ds_write_b128 v8, v[236:239] offset:56576
    s_waitcnt lgkmcnt(0)
    s_barrier
    ds_read_b64_tr_b16 a[112:113], v9 offset:0
    ds_read_b64_tr_b16 a[114:115], v9 offset:1088
    ds_read_b64_tr_b16 a[116:117], v9 offset:8704
    ds_read_b64_tr_b16 a[118:119], v9 offset:9792
    ds_read_b64_tr_b16 a[120:121], v9 offset:17408
    ds_read_b64_tr_b16 a[122:123], v9 offset:18496
    ds_read_b64_tr_b16 a[124:125], v9 offset:26112
    ds_read_b64_tr_b16 a[126:127], v9 offset:27200
    ds_read_b64_tr_b16 a[128:129], v9 offset:34816
    ds_read_b64_tr_b16 a[130:131], v9 offset:35904
    ds_read_b64_tr_b16 a[132:133], v9 offset:43520
    ds_read_b64_tr_b16 a[134:135], v9 offset:44608
    ds_read_b64_tr_b16 a[136:137], v9 offset:52224
    ds_read_b64_tr_b16 a[138:139], v9 offset:53312
    ds_read_b64_tr_b16 a[140:141], v10 offset:0
    ds_read_b64_tr_b16 a[142:143], v10 offset:1088
    ds_read_b64_tr_b16 a[144:145], v10 offset:8704
    ds_read_b64_tr_b16 a[146:147], v10 offset:9792
    ds_read_b64_tr_b16 a[148:149], v10 offset:17408
    ds_read_b64_tr_b16 a[150:151], v10 offset:18496
    ds_read_b64_tr_b16 a[152:153], v10 offset:26112
    ds_read_b64_tr_b16 a[154:155], v10 offset:27200
    ds_read_b64_tr_b16 a[156:157], v10 offset:34816
    ds_read_b64_tr_b16 a[158:159], v10 offset:35904
    ds_read_b64_tr_b16 a[160:161], v10 offset:43520
    ds_read_b64_tr_b16 a[162:163], v10 offset:44608
    ds_read_b64_tr_b16 a[164:165], v10 offset:52224
    ds_read_b64_tr_b16 a[166:167], v10 offset:53312
    ds_read_b64_tr_b16 a[168:169], v9 offset:8
    ds_read_b64_tr_b16 a[170:171], v9 offset:1096
    ds_read_b64_tr_b16 a[172:173], v9 offset:8712
    ds_read_b64_tr_b16 a[174:175], v9 offset:9800
    ds_read_b64_tr_b16 a[176:177], v9 offset:17416
    ds_read_b64_tr_b16 a[178:179], v9 offset:18504
    ds_read_b64_tr_b16 a[180:181], v9 offset:26120
    ds_read_b64_tr_b16 a[182:183], v9 offset:27208
    ds_read_b64_tr_b16 a[184:185], v9 offset:34824
    ds_read_b64_tr_b16 a[186:187], v9 offset:35912
    ds_read_b64_tr_b16 a[188:189], v9 offset:43528
    ds_read_b64_tr_b16 a[190:191], v9 offset:44616
    ds_read_b64_tr_b16 a[192:193], v9 offset:52232
    ds_read_b64_tr_b16 a[194:195], v9 offset:53320
    ds_read_b64_tr_b16 a[196:197], v10 offset:8
    ds_read_b64_tr_b16 a[198:199], v10 offset:1096
    ds_read_b64_tr_b16 a[200:201], v10 offset:8712
    ds_read_b64_tr_b16 a[202:203], v10 offset:9800
    ds_read_b64_tr_b16 a[204:205], v10 offset:17416
    ds_read_b64_tr_b16 a[206:207], v10 offset:18504
    ds_read_b64_tr_b16 a[208:209], v10 offset:26120
    ds_read_b64_tr_b16 a[210:211], v10 offset:27208
    ds_read_b64_tr_b16 a[212:213], v10 offset:34824
    ds_read_b64_tr_b16 a[214:215], v10 offset:35912
    ds_read_b64_tr_b16 a[216:217], v10 offset:43528
    ds_read_b64_tr_b16 a[218:219], v10 offset:44616
    ds_read_b64_tr_b16 a[220:221], v10 offset:52232
    ds_read_b64_tr_b16 a[222:223], v10 offset:53320
    s_waitcnt lgkmcnt(0)
    s_barrier
    s_mul_i32 s30, s3, 7168
    s_mul_i32 s34, s12, 28672
    s_add_u32 s34, s34, s30
    s_add_u32 s34, s34, 0xc40000
    s_lshr_b32 s31, s3, 1
    s_lshl_b32 s31, s31, 6
    s_add_u32 s36, s30, s31
    s_add_u32 s36, s36, 0
    s_mov_b32 s50, 28800
    v_mov_b32 v6, v1
    s_lshl_b32 s35, s12, 7
    s_lshl_b32 s31, s6, 2
    s_add_u32 s35, s35, s31
    s_add_u32 s35, s35, 0xf80100
    s_mov_b32 m0, s36
    s_add_u32 s30, s34, 4096
    buffer_load_dwordx4 v1, s[8:11], s34 offen offset:0 sc1 lds
    buffer_load_dwordx4 v1, s[8:11], s34 offen offset:1024 sc1 lds
    buffer_load_dwordx4 v1, s[8:11], s34 offen offset:2048 sc1 lds
    buffer_load_dwordx4 v1, s[8:11], s34 offen offset:3072 sc1 lds
    s_add_u32 m0, s36, 4096
    s_nop 0
    buffer_load_dwordx4 v1, s[8:11], s30 offen offset:0 sc1 lds
    buffer_load_dwordx4 v1, s[8:11], s30 offen offset:1024 sc1 lds
    buffer_load_dwordx4 v1, s[8:11], s30 offen offset:2048 sc1 lds
    s_mov_b32 s13, 0
    s_waitcnt vmcnt(0)
    s_branch rf_in
rf_loop:
    s_waitcnt vmcnt(2)
rf_in:
    s_barrier
    s_add_u32 s34, s34, 57344
    s_add_u32 s36, s36, s50
    s_mov_b32 m0, s36
    s_add_u32 s30, s34, 4096
    buffer_load_dwordx4 v1, s[8:11], s34 offen offset:0 sc1 lds
    buffer_load_dwordx4 v1, s[8:11], s34 offen offset:1024 sc1 lds
    buffer_load_dwordx4 v1, s[8:11], s34 offen offset:2048 sc1 lds
    buffer_load_dwordx4 v1, s[8:11], s34 offen offset:3072 sc1 lds
    s_add_u32 m0, s36, 4096
    s_nop 0
    buffer_load_dwordx4 v1, s[8:11], s30 offen offset:0 sc1 lds
    buffer_load_dwordx4 v1, s[8:11], s30 offen offset:1024 sc1 lds
    buffer_load_dwordx4 v1, s[8:11], s30 offen offset:2048 sc1 lds
    ds_read_b128 v[64:67], v6 offset:0
    ds_read_b128 v[68:71], v6 offset:14400
    ds_read_b128 v[72:75], v6 offset:1024
    ds_read_b128 v[76:79], v6 offset:15424
    ds_read_b128 v[80:83], v6 offset:2048
    ds_read_b128 v[84:87], v6 offset:16448
    ds_read_b128 v[88:91], v6 offset:3072
    ds_read_b128 v[92:95], v6 offset:17472
    s_waitcnt lgkmcnt(6)
    v_mfma_f32_16x16x32_bf16 v[32:35], a[0:3], v[64:67], 0
    v_mfma_f32_16x16x32_bf16 v[48:51], a[0:3], v[68:71], 0
    v_mfma_f32_16x16x32_bf16 v[36:39], a[56:59], v[64:67], 0
    v_mfma_f32_16x16x32_bf16 v[52:55], a[56:59], v[68:71], 0
    v_mfma_f32_16x16x32_bf16 v[40:43], a[112:115], v[64:67], 0
    v_mfma_f32_16x16x32_bf16 v[56:59], a[112:115], v[68:71], 0
    v_mfma_f32_16x16x32_bf16 v[44:47], a[168:171], v[64:67], 0
    v_mfma_f32_16x16x32_bf16 v[60:63], a[168:171], v[68:71], 0
    ds_read_b128 v[64:67], v6 offset:4096
    ds_read_b128 v[68:71], v6 offset:18496
    s_waitcnt lgkmcnt(6)
    v_mfma_f32_16x16x32_bf16 v[32:35], a[4:7], v[72:75], v[32:35]
    v_mfma_f32_16x16x32_bf16 v[48:51], a[4:7], v[76:79], v[48:51]
    v_mfma_f32_16x16x32_bf16 v[36:39], a[60:63], v[72:75], v[36:39]
    v_mfma_f32_16x16x32_bf16 v[52:55], a[60:63], v[76:79], v[52:55]
    v_mfma_f32_16x16x32_bf16 v[40:43], a[116:119], v[72:75], v[40:43]
    v_mfma_f32_16x16x32_bf16 v[56:59], a[116:119], v[76:79], v[56:59]
    v_mfma_f32_16x16x32_bf16 v[44:47], a[172:175], v[72:75], v[44:47]
    v_mfma_f32_16x16x32_bf16 v[60:63], a[172:175], v[76:79], v[60:63]
    ds_read_b128 v[72:75], v6 offset:5120
    ds_read_b128 v[76:79], v6 offset:19520
    s_waitcnt lgkmcnt(6)
    v_mfma_f32_16x16x32_bf16 v[32:35], a[8:11], v[80:83], v[32:35]
    v_mfma_f32_16x16x32_bf16 v[48:51], a[8:11], v[84:87], v[48:51]
    v_mfma_f32_16x16x32_bf16 v[36:39], a[64:67], v[80:83], v[36:39]
    v_mfma_f32_16x16x32_bf16 v[52:55], a[64:67], v[84:87], v[52:55]
    v_mfma_f32_16x16x32_bf16 v[40:43], a[120:123], v[80:83], v[40:43]
    v_mfma_f32_16x16x32_bf16 v[56:59], a[120:123], v[84:87], v[56:59]
    v_mfma_f32_16x16x32_bf16 v[44:47], a[176:179], v[80:83], v[44:47]
    v_mfma_f32_16x16x32_bf16 v[60:63], a[176:179], v[84:87], v[60:63]
    ds_read_b128 v[80:83], v6 offset:6144
    ds_read_b128 v[84:87], v6 offset:20544
    s_waitcnt lgkmcnt(6)
    v_mfma_f32_16x16x32_bf16 v[32:35], a[12:15], v[88:91], v[32:35]
    v_mfma_f32_16x16x32_bf16 v[48:51], a[12:15], v[92:95], v[48:51]
    v_mfma_f32_16x16x32_bf16 v[36:39], a[68:71], v[88:91], v[36:39]
    v_mfma_f32_16x16x32_bf16 v[52:55], a[68:71], v[92:95], v[52:55]
    v_mfma_f32_16x16x32_bf16 v[40:43], a[124:127], v[88:91], v[40:43]
    v_mfma_f32_16x16x32_bf16 v[56:59], a[124:127], v[92:95], v[56:59]
    v_mfma_f32_16x16x32_bf16 v[44:47], a[180:183], v[88:91], v[44:47]
    v_mfma_f32_16x16x32_bf16 v[60:63], a[180:183], v[92:95], v[60:63]
    ds_read_b128 v[88:91], v6 offset:7168
    ds_read_b128 v[92:95], v6 offset:21568
    s_waitcnt lgkmcnt(6)
    v_mfma_f32_16x16x32_bf16 v[32:35], a[16:19], v[64:67], v[32:35]
    v_mfma_f32_16x16x32_bf16 v[48:51], a[16:19], v[68:71], v[48:51]
    v_mfma_f32_16x16x32_bf16 v[36:39], a[72:75], v[64:67], v[36:39]
    v_mfma_f32_16x16x32_bf16 v[52:55], a[72:75], v[68:71], v[52:55]
    v_mfma_f32_16x16x32_bf16 v[40:43], a[128:131], v[64:67], v[40:43]
    v_mfma_f32_16x16x32_bf16 v[56:59], a[128:131], v[68:71], v[56:59]
    v_mfma_f32_16x16x32_bf16 v[44:47], a[184:187], v[64:67], v[44:47]
    v_mfma_f32_16x16x32_bf16 v[60:63], a[184:187], v[68:71], v[60:63]
    ds_read_b128 v[64:67], v6 offset:8192
    ds_read_b128 v[68:71], v6 offset:22592
    s_waitcnt lgkmcnt(6)
    v_mfma_f32_16x16x32_bf16 v[32:35], a[20:23], v[72:75], v[32:35]
    v_mfma_f32_16x16x32_bf16 v[48:51], a[20:23], v[76:79], v[48:51]
    v_mfma_f32_16x16x32_bf16 v[36:39], a[76:79], v[72:75], v[36:39]
    v_mfma_f32_16x16x32_bf16 v[52:55], a[76:79], v[76:79], v[52:55]
    v_mfma_f32_16x16x32_bf16 v[40:43], a[132:135], v[72:75], v[40:43]
    v_mfma_f32_16x16x32_bf16 v[56:59], a[132:135], v[76:79], v[56:59]
    v_mfma_f32_16x16x32_bf16 v[44:47], a[188:191], v[72:75], v[44:47]
    v_mfma_f32_16x16x32_bf16 v[60:63], a[188:191], v[76:79], v[60:63]
    ds_read_b128 v[72:75], v6 offset:9216
    ds_read_b128 v[76:79], v6 offset:23616
    s_waitcnt lgkmcnt(6)
    v_mfma_f32_16x16x32_bf16 v[32:35], a[24:27], v[80:83], v[32:35]
    v_mfma_f32_16x16x32_bf16 v[48:51], a[24:27], v[84:87], v[48:51]
    v_mfma_f32_16x16x32_bf16 v[36:39], a[80:83], v[80:83], v[36:39]
    v_mfma_f32_16x16x32_bf16 v[52:55], a[80:83], v[84:87], v[52:55]
    v_mfma_f32_16x16x32_bf16 v[40:43], a[136:139], v[80:83], v[40:43]
    v_mfma_f32_16x16x32_bf16 v[56:59], a[136:139], v[84:87], v[56:59]
    v_mfma_f32_16x16x32_bf16 v[44:47], a[192:195], v[80:83], v[44:47]
    v_mfma_f32_16x16x32_bf16 v[60:63], a[192:195], v[84:87], v[60:63]
    ds_read_b128 v[80:83], v6 offset:10240
    ds_read_b128 v[84:87], v6 offset:24640
    s_waitcnt lgkmcnt(6)
    v_mfma_f32_16x16x32_bf16 v[32:35], a[28:31], v[88:91], v[32:35]
    v_mfma_f32_16x16x32_bf16 v[48:51], a[28:31], v[92:95], v[48:51]
    v_mfma_f32_16x16x32_bf16 v[36:39], a[84:87], v[88:91], v[36:39]
    v_mfma_f32_16x16x32_bf16 v[52:55], a[84:87], v[92:95], v[52:55]
    v_mfma_f32_16x16x32_bf16 v[40:43], a[140:143], v[88:91], v[40:43]
    v_mfma_f32_16x16x32_bf16 v[56:59], a[140:143], v[92:95], v[56:59]
    v_mfma_f32_16x16x32_bf16 v[44:47], a[196:199], v[88:91], v[44:47]
    v_mfma_f32_16x16x32_bf16 v[60:63], a[196:199], v[92:95], v[60:63]
    ds_read_b128 v[88:91], v6 offset:11264
    ds_read_b128 v[92:95], v6 offset:25664
    s_waitcnt lgkmcnt(6)
    v_mfma_f32_16x16x32_bf16 v[32:35], a[32:35], v[64:67], v[32:35]
    v_mfma_f32_16x16x32_bf16 v[48:51], a[32:35], v[68:71], v[48:51]
    v_mfma_f32_16x16x32_bf16 v[36:39], a[88:91], v[64:67], v[36:39]
    v_mfma_f32_16x16x32_bf16 v[52:55], a[88:91], v[68:71], v[52:55]
    v_mfma_f32_16x16x32_bf16 v[40:43], a[144:147], v[64:67], v[40:43]
    v_mfma_f32_16x16x32_bf16 v[56:59], a[144:147], v[68:71], v[56:59]
    v_mfma_f32_16x16x32_bf16 v[44:47], a[200:203], v[64:67], v[44:47]
    v_mfma_f32_16x16x32_bf16 v[60:63], a[200:203], v[68:71], v[60:63]
    s_waitcnt vmcnt(7)
    s_barrier
    s_cmp_eq_u32 s3, 0
    s_cbranch_scc0 pb_134
    v_mov_b32 v4, s13
    v_mov_b32 v5, 0
    buffer_store_dword v4, v5, s[8:11], s35 offen sc1
pb_134:
    ds_read_b128 v[64:67], v6 offset:12288
    ds_read_b128 v[68:71], v6 offset:26688
    s_waitcnt lgkmcnt(6)
    v_mfma_f32_16x16x32_bf16 v[32:35], a[36:39], v[72:75], v[32:35]
    v_mfma_f32_16x16x32_bf16 v[48:51], a[36:39], v[76:79], v[48:51]
    v_mfma_f32_16x16x32_bf16 v[36:39], a[92:95], v[72:75], v[36:39]
    v_mfma_f32_16x16x32_bf16 v[52:55], a[92:95], v[76:79], v[52:55]
    v_mfma_f32_16x16x32_bf16 v[40:43], a[148:151], v[72:75], v[40:43]
    v_mfma_f32_16x16x32_bf16 v[56:59], a[148:151], v[76:79], v[56:59]
    v_mfma_f32_16x16x32_bf16 v[44:47], a[204:207], v[72:75], v[44:47]
    v_mfma_f32_16x16x32_bf16 v[60:63], a[204:207], v[76:79], v[60:63]
    ds_read_b128 v[72:75], v6 offset:13312
    ds_read_b128 v[76:79], v6 offset:27712
    s_waitcnt lgkmcnt(6)
    v_mfma_f32_16x16x32_bf16 v[32:35], a[40:43], v[80:83], v[32:35]
    v_mfma_f32_16x16x32_bf16 v[48:51], a[40:43], v[84:87], v[48:51]
    v_mfma_f32_16x16x32_bf16 v[36:39], a[96:99], v[80:83], v[36:39]
    v_mfma_f32_16x16x32_bf16 v[52:55], a[96:99], v[84:87], v[52:55]
    v_mfma_f32_16x16x32_bf16 v[40:43], a[152:155], v[80:83], v[40:43]
    v_mfma_f32_16x16x32_bf16 v[56:59], a[152:155], v[84:87], v[56:59]
    v_mfma_f32_16x16x32_bf16 v[44:47], a[208:211], v[80:83], v[44:47]
    v_mfma_f32_16x16x32_bf16 v[60:63], a[208:211], v[84:87], v[60:63]
    s_waitcnt lgkmcnt(4)
    v_mfma_f32_16x16x32_bf16 v[32:35], a[44:47], v[88:91], v[32:35]
    v_mfma_f32_16x16x32_bf16 v[48:51], a[44:47], v[92:95], v[48:51]
    v_mfma_f32_16x16x32_bf16 v[36:39], a[100:103], v[88:91], v[36:39]
    v_mfma_f32_16x16x32_bf16 v[52:55], a[100:103], v[92:95], v[52:55]
    v_mfma_f32_16x16x32_bf16 v[40:43], a[156:159], v[88:91], v[40:43]
    v_mfma_f32_16x16x32_bf16 v[56:59], a[156:159], v[92:95], v[56:59]
    v_mfma_f32_16x16x32_bf16 v[44:47], a[212:215], v[88:91], v[44:47]
    v_mfma_f32_16x16x32_bf16 v[60:63], a[212:215], v[92:95], v[60:63]
    s_waitcnt lgkmcnt(2)
    v_mfma_f32_16x16x32_bf16 v[32:35], a[48:51], v[64:67], v[32:35]
    v_mfma_f32_16x16x32_bf16 v[48:51], a[48:51], v[68:71], v[48:51]
    v_mfma_f32_16x16x32_bf16 v[36:39], a[104:107], v[64:67], v[36:39]
    v_mfma_f32_16x16x32_bf16 v[52:55], a[104:107], v[68:71], v[52:55]
    v_mfma_f32_16x16x32_bf16 v[40:43], a[160:163], v[64:67], v[40:43]
    v_mfma_f32_16x16x32_bf16 v[56:59], a[160:163], v[68:71], v[56:59]
    v_mfma_f32_16x16x32_bf16 v[44:47], a[216:219], v[64:67], v[44:47]
    v_mfma_f32_16x16x32_bf16 v[60:63], a[216:219], v[68:71], v[60:63]
    s_waitcnt lgkmcnt(0)
    v_mfma_f32_16x16x32_bf16 v[32:35], a[52:55], v[72:75], v[32:35]
    v_mfma_f32_16x16x32_bf16 v[48:51], a[52:55], v[76:79], v[48:51]
    v_mfma_f32_16x16x32_bf16 v[36:39], a[108:111], v[72:75], v[36:39]
    v_mfma_f32_16x16x32_bf16 v[52:55], a[108:111], v[76:79], v[52:55]
    v_mfma_f32_16x16x32_bf16 v[40:43], a[164:167], v[72:75], v[40:43]
    v_mfma_f32_16x16x32_bf16 v[56:59], a[164:167], v[76:79], v[56:59]
    v_mfma_f32_16x16x32_bf16 v[44:47], a[220:223], v[72:75], v[44:47]
    v_mfma_f32_16x16x32_bf16 v[60:63], a[220:223], v[76:79], v[60:63]
    v_add_u32 v6, s50, v6
    s_sub_u32 s50, 0, s50
    s_nop 6
    s_mul_i32 s30, s12, 114688
    s_lshl_b32 s31, s6, 12
    s_add_u32 s30, s30, s31
    s_lshl_b32 s31, s3, 10
    s_add_u32 s30, s30, s31
    s_add_u32 s30, s30, 0x1700000
    s_add_u32 s31, s30, 57344
    v_mul_f32 v104, 0xbfb8aa3b, v32
    v_mul_f32 v105, 0xbfb8aa3b, v33
    v_mul_f32 v106, 0xbfb8aa3b, v34
    v_mul_f32 v107, 0xbfb8aa3b, v35
    v_mul_f32 v108, 0xbfb8aa3b, v36
    v_mul_f32 v109, 0xbfb8aa3b, v37
    v_mul_f32 v110, 0xbfb8aa3b, v38
    v_mul_f32 v111, 0xbfb8aa3b, v39
    v_exp_f32 v104, v104
    v_exp_f32 v105, v105
    v_exp_f32 v106, v106
    v_exp_f32 v107, v107
    v_exp_f32 v108, v108
    v_exp_f32 v109, v109
    v_exp_f32 v110, v110
    v_exp_f32 v111, v111
    v_mul_f32 v40, v40, v32
    v_mul_f32 v41, v41, v33
    v_mul_f32 v42, v42, v34
    v_mul_f32 v43, v43, v35
    v_mul_f32 v44, v44, v36
    v_mul_f32 v45, v45, v37
    v_mul_f32 v46, v46, v38
    v_mul_f32 v47, v47, v39
    v_add_f32 v104, 1.0, v104
    v_add_f32 v105, 1.0, v105
    v_add_f32 v106, 1.0, v106
    v_add_f32 v107, 1.0, v107
    v_add_f32 v108, 1.0, v108
    v_add_f32 v109, 1.0, v109
    v_add_f32 v110, 1.0, v110
    v_add_f32 v111, 1.0, v111
    v_rcp_f32 v104, v104
    v_rcp_f32 v105, v105
    v_rcp_f32 v106, v106
    v_rcp_f32 v107, v107
    v_rcp_f32 v108, v108
    v_rcp_f32 v109, v109
    v_rcp_f32 v110, v110
    v_rcp_f32 v111, v111
    s_nop 0
    v_mul_f32 v40, v40, v104
    v_mul_f32 v41, v41, v105
    v_mul_f32 v42, v42, v106
    v_mul_f32 v43, v43, v107
    v_mul_f32 v44, v44, v108
    v_mul_f32 v45, v45, v109
    v_mul_f32 v46, v46, v110
    v_mul_f32 v47, v47, v111
    v_cvt_pk_bf16_f32 v96, v40, v41
    v_cvt_pk_bf16_f32 v97, v42, v43
    v_cvt_pk_bf16_f32 v98, v44, v45
    v_cvt_pk_bf16_f32 v99, v46, v47
    buffer_store_dwordx4 v[96:99], v1, s[8:11], s30 offen sc1
    v_mul_f32 v104, 0xbfb8aa3b, v48
    v_mul_f32 v105, 0xbfb8aa3b, v49
    v_mul_f32 v106, 0xbfb8aa3b, v50
    v_mul_f32 v107, 0xbfb8aa3b, v51
    v_mul_f32 v108, 0xbfb8aa3b, v52
    v_mul_f32 v109, 0xbfb8aa3b, v53
    v_mul_f32 v110, 0xbfb8aa3b, v54
    v_mul_f32 v111, 0xbfb8aa3b, v55
    v_exp_f32 v104, v104
    v_exp_f32 v105, v105
    v_exp_f32 v106, v106
    v_exp_f32 v107, v107
    v_exp_f32 v108, v108
    v_exp_f32 v109, v109
    v_exp_f32 v110, v110
    v_exp_f32 v111, v111
    v_mul_f32 v56, v56, v48
    v_mul_f32 v57, v57, v49
    v_mul_f32 v58, v58, v50
    v_mul_f32 v59, v59, v51
    v_mul_f32 v60, v60, v52
    v_mul_f32 v61, v61, v53
    v_mul_f32 v62, v62, v54
    v_mul_f32 v63, v63, v55
    v_add_f32 v104, 1.0, v104
    v_add_f32 v105, 1.0, v105
    v_add_f32 v106, 1.0, v106
    v_add_f32 v107, 1.0, v107
    v_add_f32 v108, 1.0, v108
    v_add_f32 v109, 1.0, v109
    v_add_f32 v110, 1.0, v110
    v_add_f32 v111, 1.0, v111
    v_rcp_f32 v104, v104
    v_rcp_f32 v105, v105
    v_rcp_f32 v106, v106
    v_rcp_f32 v107, v107
    v_rcp_f32 v108, v108
    v_rcp_f32 v109, v109
    v_rcp_f32 v110, v110
    v_rcp_f32 v111, v111
    s_nop 0
    v_mul_f32 v56, v56, v104
    v_mul_f32 v57, v57, v105
    v_mul_f32 v58, v58, v106
    v_mul_f32 v59, v59, v107
    v_mul_f32 v60, v60, v108
    v_mul_f32 v61, v61, v109
    v_mul_f32 v62, v62, v110
    v_mul_f32 v63, v63, v111
    v_cvt_pk_bf16_f32 v100, v56, v57
    v_cvt_pk_bf16_f32 v101, v58, v59
    v_cvt_pk_bf16_f32 v102, v60, v61
    v_cvt_pk_bf16_f32 v103, v62, v63
    buffer_store_dwordx4 v[100:103], v1, s[8:11], s31 offen sc1
    s_add_u32 s13, s13, 1
    s_add_u32 s12, s12, 2
    s_cmp_lt_u32 s12, 64
    s_cbranch_scc1 rf_loop
    s_waitcnt vmcnt(0)
    s_barrier
    s_cmp_eq_u32 s3, 0
    s_cbranch_scc0 pb_135
    v_mov_b32 v4, s13
    v_mov_b32 v5, 0
    buffer_store_dword v4, v5, s[8:11], s35 offen sc1
pb_135:
    s_endpgm
role_fin:
    s_mul_i32 s12, s30, 9363
    s_lshr_b32 s12, s12, 16
    s_mul_i32 s31, s12, 7
    s_sub_u32 s6, s30, s31
    s_load_dwordx2 s[56:57], s[0:1], 80
    s_load_dwordx2 s[58:59], s[0:1], 96
    v_lshlrev_b32 v1, 4, v0
    v_and_b32 v2, 15, v0
    v_lshrrev_b32 v3, 4, v0
    v_lshrrev_b32 v4, 3, v0
    v_and_b32 v5, 7, v0
    s_movk_i32 s30, 896
    v_mul_u32_u24 v6, s30, v4
    v_lshl_add_u32 v6, v5, 4, v6
    s_movk_i32 s30, 144
    v_mul_u32_u24 v7, s30, v4
    v_lshl_add_u32 v7, v5, 4, v7
    s_mul_i32 s31, s3, 32256
    v_add_u32 v7, s31, v7
    v_lshrrev_b32 v8, 2, v2
    v_lshl_add_u32 v8, v3, 3, v8
    v_mul_u32_u24 v8, s30, v8
    v_and_b32 v4, 3, v0
    v_lshl_add_u32 v8, v4, 3, v8
    v_add_u32 v8, s31, v8
    s_waitcnt lgkmcnt(0)
    s_mov_b32 s16, s56
    s_mov_b32 s17, s57
    s_mov_b32 s18, 0x188000
    s_mov_b32 s19, 0x20000
    s_mov_b32 s20, s58
    s_mov_b32 s21, s59
    s_mov_b32 s22, 0x1c0000
    s_mov_b32 s23, 0x20000
    s_mul_i32 s31, s3, 401408
    s_lshl_b32 s32, s6, 7
    s_add_u32 s31, s31, s32
    buffer_load_dwordx4 v[16:19], v6, s[16:19], s31 offen
    s_add_u32 s31, s31, 7168
    buffer_load_dwordx4 v[20:23], v6, s[16:19], s31 offen
    s_add_u32 s31, s31, 7168
    buffer_load_dwordx4 v[24:27], v6, s[16:19], s31 offen
    s_add_u32 s31, s31, 7168
    buffer_load_dwordx4 v[28:31], v6, s[16:19], s31 offen
    s_add_u32 s31, s31, 7168
    buffer_load_dwordx4 v[32:35], v6, s[16:19], s31 offen
    s_add_u32 s31, s31, 7168
    buffer_load_dwordx4 v[36:39], v6, s[16:19], s31 offen
    s_add_u32 s31, s31, 7168
    buffer_load_dwordx4 v[40:43], v6, s[16:19], s31 offen
    s_add_u32 s31, s31, 7168
    buffer_load_dwordx4 v[44:47], v6, s[16:19], s31 offen
    s_add_u32 s31, s31, 7168
    buffer_load_dwordx4 v[48:51], v6, s[16:19], s31 offen
    s_add_u32 s31, s31, 7168
    buffer_load_dwordx4 v[52:55], v6, s[16:19], s31 offen
    s_add_u32 s31, s31, 7168
    buffer_load_dwordx4 v[56:59], v6, s[16:19], s31 offen
    s_add_u32 s31, s31, 7168
    buffer_load_dwordx4 v[60:63], v6, s[16:19], s31 offen
    s_add_u32 s31, s31, 7168
    buffer_load_dwordx4 v[64:67], v6, s[16:19], s31 offen
    s_add_u32 s31, s31, 7168
    buffer_load_dwordx4 v[68:71], v6, s[16:19], s31 offen
    s_add_u32 s31, s31, 7168
    buffer_load_dwordx4 v[72:75], v6, s[16:19], s31 offen
    s_add_u32 s31, s31, 7168
    buffer_load_dwordx4 v[76:79], v6, s[16:19], s31 offen
    s_add_u32 s31, s31, 7168
    buffer_load_dwordx4 v[80:83], v6, s[16:19], s31 offen
    s_add_u32 s31, s31, 7168
    buffer_load_dwordx4 v[84:87], v6, s[16:19], s31 offen
    s_add_u32 s31, s31, 7168
    buffer_load_dwordx4 v[88:91], v6, s[16:19], s31 offen
    s_add_u32 s31, s31, 7168
    buffer_load_dwordx4 v[92:95], v6, s[16:19], s31 offen
    s_add_u32 s31, s31, 7168
    buffer_load_dwordx4 v[96:99], v6, s[16:19], s31 offen
    s_add_u32 s31, s31, 7168
    buffer_load_dwordx4 v[100:103], v6, s[16:19], s31 offen
    s_add_u32 s31, s31, 7168
    buffer_load_dwordx4 v[104:107], v6, s[16:19], s31 offen
    s_add_u32 s31, s31, 7168
    buffer_load_dwordx4 v[108:111], v6, s[16:19], s31 offen
    s_add_u32 s31, s31, 7168
    buffer_load_dwordx4 v[112:115], v6, s[16:19], s31 offen
    s_add_u32 s31, s31, 7168
    buffer_load_dwordx4 v[116:119], v6, s[16:19], s31 offen
    s_add_u32 s31, s31, 7168
    buffer_load_dwordx4 v[120:123], v6, s[16:19], s31 offen
    s_add_u32 s31, s31, 7168
    buffer_load_dwordx4 v[124:127], v6, s[16:19], s31 offen
    s_add_u32 s31, s31, 7168
    buffer_load_dwordx4 v[128:131], v6, s[16:19], s31 offen
    s_add_u32 s31, s31, 7168
    buffer_load_dwordx4 v[132:135], v6, s[16:19], s31 offen
    s_add_u32 s31, s31, 7168
    buffer_load_dwordx4 v[136:139], v6, s[16:19], s31 offen
    s_add_u32 s31, s31, 7168
    buffer_load_dwordx4 v[140:143], v6, s[16:19], s31 offen
    s_add_u32 s31, s31, 7168
    buffer_load_dwordx4 v[144:147], v6, s[16:19], s31 offen
    s_add_u32 s31, s31, 7168
    buffer_load_dwordx4 v[148:151], v6, s[16:19], s31 offen
    s_add_u32 s31, s31, 7168
    buffer_load_dwordx4 v[152:155], v6, s[16:19], s31 offen
    s_add_u32 s31, s31, 7168
    buffer_load_dwordx4 v[156:159], v6, s[16:19], s31 offen
    s_add_u32 s31, s31, 7168
    buffer_load_dwordx4 v[160:163], v6, s[16:19], s31 offen
    s_add_u32 s31, s31, 7168
    buffer_load_dwordx4 v[164:167], v6, s[16:19], s31 offen
    s_add_u32 s31, s31, 7168
    buffer_load_dwordx4 v[168:171], v6, s[16:19], s31 offen
    s_add_u32 s31, s31, 7168
    buffer_load_dwordx4 v[172:175], v6, s[16:19], s31 offen
    s_add_u32 s31, s31, 7168
    buffer_load_dwordx4 v[176:179], v6, s[16:19], s31 offen
    s_add_u32 s31, s31, 7168
    buffer_load_dwordx4 v[180:183], v6, s[16:19], s31 offen
    s_add_u32 s31, s31, 7168
    buffer_load_dwordx4 v[184:187], v6, s[16:19], s31 offen
    s_add_u32 s31, s31, 7168
    buffer_load_dwordx4 v[188:191], v6, s[16:19], s31 offen
    s_add_u32 s31, s31, 7168
    buffer_load_dwordx4 v[192:195], v6, s[16:19], s31 offen
    s_add_u32 s31, s31, 7168
    buffer_load_dwordx4 v[196:199], v6, s[16:19], s31 offen
    s_add_u32 s31, s31, 7168
    buffer_load_dwordx4 v[200:203], v6, s[16:19], s31 offen
    s_add_u32 s31, s31, 7168
    buffer_load_dwordx4 v[204:207], v6, s[16:19], s31 offen
    s_add_u32 s31, s31, 7168
    buffer_load_dwordx4 v[208:211], v6, s[16:19], s31 offen
    s_add_u32 s31, s31, 7168
    buffer_load_dwordx4 v[212:215], v6, s[16:19], s31 offen
    s_add_u32 s31, s31, 7168
    buffer_load_dwordx4 v[216:219], v6, s[16:19], s31 offen
    s_add_u32 s31, s31, 7168
    buffer_load_dwordx4 v[220:223], v6, s[16:19], s31 offen
    s_add_u32 s31, s31, 7168
    buffer_load_dwordx4 v[224:227], v6, s[16:19], s31 offen
    s_add_u32 s31, s31, 7168
    buffer_load_dwordx4 v[228:231], v6, s[16:19], s31 offen
    s_add_u32 s31, s31, 7168
    buffer_load_dwordx4 v[232:235], v6, s[16:19], s31 offen
    s_add_u32 s31, s31, 7168
    buffer_load_dwordx4 v[236:239], v6, s[16:19], s31 offen
    s_waitcnt vmcnt(28)
    ds_write_b128 v7, v[16:19] offset:0
    ds_write_b128 v7, v[20:23] offset:1152
    ds_write_b128 v7, v[24:27] offset:2304
    ds_write_b128 v7, v[28:31] offset:3456
    ds_write_b128 v7, v[32:35] offset:4608
    ds_write_b128 v7, v[36:39] offset:5760
    ds_write_b128 v7, v[40:43] offset:6912
    ds_write_b128 v7, v[44:47] offset:8064
    ds_write_b128 v7, v[48:51] offset:9216
    ds_write_b128 v7, v[52:55] offset:10368
    ds_write_b128 v7, v[56:59] offset:11520
    ds_write_b128 v7, v[60:63] offset:12672
    ds_write_b128 v7, v[64:67] offset:13824
    ds_write_b128 v7, v[68:71] offset:14976
    ds_write_b128 v7, v[72:75] offset:16128
    ds_write_b128 v7, v[76:79] offset:17280
    ds_write_b128 v7, v[80:83] offset:18432
    ds_write_b128 v7, v[84:87] offset:19584
    ds_write_b128 v7, v[88:91] offset:20736
    ds_write_b128 v7, v[92:95] offset:21888
    ds_write_b128 v7, v[96:99] offset:23040
    ds_write_b128 v7, v[100:103] offset:24192
    ds_write_b128 v7, v[104:107] offset:25344
    ds_write_b128 v7, v[108:111] offset:26496
    ds_write_b128 v7, v[112:115] offset:27648
    ds_write_b128 v7, v[116:119] offset:28800
    ds_write_b128 v7, v[120:123] offset:29952
    ds_write_b128 v7, v[124:127] offset:31104
    ds_read_b64_tr_b16 a[0:1], v8 offset:0
    ds_read_b64_tr_b16 a[2:3], v8 offset:576
    ds_read_b64_tr_b16 a[4:5], v8 offset:32
    ds_read_b64_tr_b16 a[6:7], v8 offset:608
    ds_read_b64_tr_b16 a[8:9], v8 offset:64
    ds_read_b64_tr_b16 a[10:11], v8 offset:640
    ds_read_b64_tr_b16 a[12:13], v8 offset:96
    ds_read_b64_tr_b16 a[14:15], v8 offset:672
    s_waitcnt lgkmcnt(0)
    ds_read_b64_tr_b16 a[16:17], v8 offset:4608
    ds_read_b64_tr_b16 a[18:19], v8 offset:5184
    ds_read_b64_tr_b16 a[20:21], v8 offset:4640
    ds_read_b64_tr_b16 a[22:23], v8 offset:5216
    ds_read_b64_tr_b16 a[24:25], v8 offset:4672
    ds_read_b64_tr_b16 a[26:27], v8 offset:5248
    ds_read_b64_tr_b16 a[28:29], v8 offset:4704
    ds_read_b64_tr_b16 a[30:31], v8 offset:5280
    s_waitcnt lgkmcnt(0)
    ds_read_b64_tr_b16 a[32:33], v8 offset:9216
    ds_read_b64_tr_b16 a[34:35], v8 offset:9792
    ds_read_b64_tr_b16 a[36:37], v8 offset:9248
    ds_read_b64_tr_b16 a[38:39], v8 offset:9824
    ds_read_b64_tr_b16 a[40:41], v8 offset:9280
    ds_read_b64_tr_b16 a[42:43], v8 offset:9856
    ds_read_b64_tr_b16 a[44:45], v8 offset:9312
    ds_read_b64_tr_b16 a[46:47], v8 offset:9888
    s_waitcnt lgkmcnt(0)
    ds_read_b64_tr_b16 a[48:49], v8 offset:13824
    ds_read_b64_tr_b16 a[50:51], v8 offset:14400
    ds_read_b64_tr_b16 a[52:53], v8 offset:13856
    ds_read_b64_tr_b16 a[54:55], v8 offset:14432
    ds_read_b64_tr_b16 a[56:57], v8 offset:13888
    ds_read_b64_tr_b16 a[58:59], v8 offset:14464
    ds_read_b64_tr_b16 a[60:61], v8 offset:13920
    ds_read_b64_tr_b16 a[62:63], v8 offset:14496
    s_waitcnt lgkmcnt(0)
    ds_read_b64_tr_b16 a[64:65], v8 offset:18432
    ds_read_b64_tr_b16 a[66:67], v8 offset:19008
    ds_read_b64_tr_b16 a[68:69], v8 offset:18464
    ds_read_b64_tr_b16 a[70:71], v8 offset:19040
    ds_read_b64_tr_b16 a[72:73], v8 offset:18496
    ds_read_b64_tr_b16 a[74:75], v8 offset:19072
    ds_read_b64_tr_b16 a[76:77], v8 offset:18528
    ds_read_b64_tr_b16 a[78:79], v8 offset:19104
    s_waitcnt lgkmcnt(0)
    ds_read_b64_tr_b16 a[80:81], v8 offset:23040
    ds_read_b64_tr_b16 a[82:83], v8 offset:23616
    ds_read_b64_tr_b16 a[84:85], v8 offset:23072
    ds_read_b64_tr_b16 a[86:87], v8 offset:23648
    ds_read_b64_tr_b16 a[88:89], v8 offset:23104
    ds_read_b64_tr_b16 a[90:91], v8 offset:23680
    ds_read_b64_tr_b16 a[92:93], v8 offset:23136
    ds_read_b64_tr_b16 a[94:95], v8 offset:23712
    s_waitcnt lgkmcnt(0)
    ds_read_b64_tr_b16 a[96:97], v8 offset:27648
    ds_read_b64_tr_b16 a[98:99], v8 offset:28224
    ds_read_b64_tr_b16 a[100:101], v8 offset:27680
    ds_read_b64_tr_b16 a[102:103], v8 offset:28256
    ds_read_b64_tr_b16 a[104:105], v8 offset:27712
    ds_read_b64_tr_b16 a[106:107], v8 offset:28288
    ds_read_b64_tr_b16 a[108:109], v8 offset:27744
    ds_read_b64_tr_b16 a[110:111], v8 offset:28320
    s_waitcnt lgkmcnt(0)
    s_waitcnt vmcnt(0)
    ds_write_b128 v7, v[128:131] offset:0
    ds_write_b128 v7, v[132:135] offset:1152
    ds_write_b128 v7, v[136:139] offset:2304
    ds_write_b128 v7, v[140:143] offset:3456
    ds_write_b128 v7, v[144:147] offset:4608
    ds_write_b128 v7, v[148:151] offset:5760
    ds_write_b128 v7, v[152:155] offset:6912
    ds_write_b128 v7, v[156:159] offset:8064
    ds_write_b128 v7, v[160:163] offset:9216
    ds_write_b128 v7, v[164:167] offset:10368
    ds_write_b128 v7, v[168:171] offset:11520
    ds_write_b128 v7, v[172:175] offset:12672
    ds_write_b128 v7, v[176:179] offset:13824
    ds_write_b128 v7, v[180:183] offset:14976
    ds_write_b128 v7, v[184:187] offset:16128
    ds_write_b128 v7, v[188:191] offset:17280
    ds_write_b128 v7, v[192:195] offset:18432
    ds_write_b128 v7, v[196:199] offset:19584
    ds_write_b128 v7, v[200:203] offset:20736
    ds_write_b128 v7, v[204:207] offset:21888
    ds_write_b128 v7, v[208:211] offset:23040
    ds_write_b128 v7, v[212:215] offset:24192
    ds_write_b128 v7, v[216:219] offset:25344
    ds_write_b128 v7, v[220:223] offset:26496
    ds_write_b128 v7, v[224:227] offset:27648
    ds_write_b128 v7, v[228:231] offset:28800
    ds_write_b128 v7, v[232:235] offset:29952
    ds_write_b128 v7, v[236:239] offset:31104
    ds_read_b64_tr_b16 a[112:113], v8 offset:0
    ds_read_b64_tr_b16 a[114:115], v8 offset:576
    ds_read_b64_tr_b16 a[116:117], v8 offset:32
    ds_read_b64_tr_b16 a[118:119], v8 offset:608
    ds_read_b64_tr_b16 a[120:121], v8 offset:64
    ds_read_b64_tr_b16 a[122:123], v8 offset:640
    ds_read_b64_tr_b16 a[124:125], v8 offset:96
    ds_read_b64_tr_b16 a[126:127], v8 offset:672
    s_waitcnt lgkmcnt(0)
    ds_read_b64_tr_b16 a[128:129], v8 offset:4608
    ds_read_b64_tr_b16 a[130:131], v8 offset:5184
    ds_read_b64_tr_b16 a[132:133], v8 offset:4640
    ds_read_b64_tr_b16 a[134:135], v8 offset:5216
    ds_read_b64_tr_b16 a[136:137], v8 offset:4672
    ds_read_b64_tr_b16 a[138:139], v8 offset:5248
    ds_read_b64_tr_b16 a[140:141], v8 offset:4704
    ds_read_b64_tr_b16 a[142:143], v8 offset:5280
    s_waitcnt lgkmcnt(0)
    ds_read_b64_tr_b16 a[144:145], v8 offset:9216
    ds_read_b64_tr_b16 a[146:147], v8 offset:9792
    ds_read_b64_tr_b16 a[148:149], v8 offset:9248
    ds_read_b64_tr_b16 a[150:151], v8 offset:9824
    ds_read_b64_tr_b16 a[152:153], v8 offset:9280
    ds_read_b64_tr_b16 a[154:155], v8 offset:9856
    ds_read_b64_tr_b16 a[156:157], v8 offset:9312
    ds_read_b64_tr_b16 a[158:159], v8 offset:9888
    s_waitcnt lgkmcnt(0)
    ds_read_b64_tr_b16 a[160:161], v8 offset:13824
    ds_read_b64_tr_b16 a[162:163], v8 offset:14400
    ds_read_b64_tr_b16 a[164:165], v8 offset:13856
    ds_read_b64_tr_b16 a[166:167], v8 offset:14432
    ds_read_b64_tr_b16 a[168:169], v8 offset:13888
    ds_read_b64_tr_b16 a[170:171], v8 offset:14464
    ds_read_b64_tr_b16 a[172:173], v8 offset:13920
    ds_read_b64_tr_b16 a[174:175], v8 offset:14496
    s_waitcnt lgkmcnt(0)
    ds_read_b64_tr_b16 a[176:177], v8 offset:18432
    ds_read_b64_tr_b16 a[178:179], v8 offset:19008
    ds_read_b64_tr_b16 a[180:181], v8 offset:18464
    ds_read_b64_tr_b16 a[182:183], v8 offset:19040
    ds_read_b64_tr_b16 a[184:185], v8 offset:18496
    ds_read_b64_tr_b16 a[186:187], v8 offset:19072
    ds_read_b64_tr_b16 a[188:189], v8 offset:18528
    ds_read_b64_tr_b16 a[190:191], v8 offset:19104
    s_waitcnt lgkmcnt(0)
    ds_read_b64_tr_b16 a[192:193], v8 offset:23040
    ds_read_b64_tr_b16 a[194:195], v8 offset:23616
    ds_read_b64_tr_b16 a[196:197], v8 offset:23072
    ds_read_b64_tr_b16 a[198:199], v8 offset:23648
    ds_read_b64_tr_b16 a[200:201], v8 offset:23104
    ds_read_b64_tr_b16 a[202:203], v8 offset:23680
    ds_read_b64_tr_b16 a[204:205], v8 offset:23136
    ds_read_b64_tr_b16 a[206:207], v8 offset:23712
    s_waitcnt lgkmcnt(0)
    ds_read_b64_tr_b16 a[208:209], v8 offset:27648
    ds_read_b64_tr_b16 a[210:211], v8 offset:28224
    ds_read_b64_tr_b16 a[212:213], v8 offset:27680
    ds_read_b64_tr_b16 a[214:215], v8 offset:28256
    ds_read_b64_tr_b16 a[216:217], v8 offset:27712
    ds_read_b64_tr_b16 a[218:219], v8 offset:28288
    ds_read_b64_tr_b16 a[220:221], v8 offset:27744
    ds_read_b64_tr_b16 a[222:223], v8 offset:28320
    s_waitcnt lgkmcnt(0)
    s_barrier
    v_lshlrev_b32 v4, 2, v0
    s_lshl_b32 s31, s6, 4
    s_sub_u32 s31, s31, 56
    v_add_u32 v5, s31, v4
    v_add_u32 v4, 256, v4
    v_cmp_gt_u32 vcc, 14, v0
    s_nop 1
    v_cndmask_b32 v4, v5, v4, vcc
    v_cmp_gt_u32 vcc, 18, v0
    v_mov_b32 v5, 256
    s_nop 0
    v_cndmask_b32 v4, v5, v4, vcc
    v_and_b32 v5, 7, v0
    v_lshlrev_b32 v5, 2, v5
    s_lshl_b32 s31, s3, 5
    s_add_u32 s31, s31, 512
    v_add_u32 v5, s31, v5
    v_and_b32 v6, 3, v0
    v_lshlrev_b32 v6, 4, v6
    s_lshl_b32 s31, s3, 2
    s_lshl_b32 s32, s6, 6
    s_add_u32 s31, s31, s32
    s_add_u32 s31, s31, 1024
    v_add_u32 v6, s31, v6
    v_cmp_gt_u32 s[60:61], 8, v2
    v_lshlrev_b32 v8, 2, v2
    s_lshl_b32 s31, s3, 5
    v_add_u32 v9, s31, v2
    s_movk_i32 s30, 272
    v_mul_u32_u24 v9, s30, v9
    v_lshl_add_u32 v9, v3, 4, v9
    v_lshrrev_b32 v12, 3, v0
    s_lshl_b32 s31, s3, 3
    v_add_u32 v12, s31, v12
    v_mul_u32_u24 v10, s30, v12
    v_and_b32 v13, 7, v0
    v_lshl_add_u32 v10, v13, 5, v10
    s_movk_i32 s30, 896
    v_mul_u32_u24 v11, s30, v12
    v_lshl_add_u32 v11, v13, 4, v11
    s_mov_b32 s50, 34816
ro_loop:
    s_and_b32 s30, s12, 1
    s_lshl_b32 s30, s30, 7
    s_add_u32 s30, s30, 0xf80000
    s_lshr_b32 s31, s12, 1
    s_add_u32 s31, s31, 1
    v_mov_b32 v12, s31
    s_mov_b32 s14, 0
pl_136:
    buffer_load_dword v13, v4, s[8:11], s30 offen sc1
    s_waitcnt vmcnt(0)
    v_cmp_lt_u32 vcc, v13, v12
    s_cbranch_vccz pk_137
    v_add_u32 v13, 1, v13
    v_cmp_lt_u32 vcc, v13, v12
    s_cbranch_vccz pn_138
    s_sleep 24
pn_138:
    s_sleep 1
    s_add_u32 s14, s14, 1
    s_cmp_lt_u32 s14, 400000
    s_cbranch_scc1 pl_136
    s_endpgm
pk_137:
    s_mul_i32 s30, s12, 114688
    s_mul_i32 s31, s3, 14336
    s_add_u32 s30, s30, s31
    s_add_u32 s30, s30, 0x1700000
    s_add_u32 s32, s30, 0
    s_add_u32 s33, s30, 57344
    buffer_load_dwordx4 v[16:19], v1, s[8:11], s32 offen offset:0 sc1
    buffer_load_dwordx4 v[20:23], v1, s[8:11], s33 offen offset:0 sc1
    buffer_load_dwordx4 v[24:27], v1, s[8:11], s32 offen offset:1024 sc1
    buffer_load_dwordx4 v[28:31], v1, s[8:11], s33 offen offset:1024 sc1
    buffer_load_dwordx4 v[32:35], v1, s[8:11], s32 offen offset:2048 sc1
    buffer_load_dwordx4 v[36:39], v1, s[8:11], s33 offen offset:2048 sc1
    buffer_load_dwordx4 v[40:43], v1, s[8:11], s32 offen offset:3072 sc1
    buffer_load_dwordx4 v[44:47], v1, s[8:11], s33 offen offset:3072 sc1
    s_add_u32 s32, s30, 4096
    s_add_u32 s33, s30, 61440
    buffer_load_dwordx4 v[48:51], v1, s[8:11], s32 offen offset:0 sc1
    buffer_load_dwordx4 v[52:55], v1, s[8:11], s33 offen offset:0 sc1
    buffer_load_dwordx4 v[56:59], v1, s[8:11], s32 offen offset:1024 sc1
    buffer_load_dwordx4 v[60:63], v1, s[8:11], s33 offen offset:1024 sc1
    buffer_load_dwordx4 v[64:67], v1, s[8:11], s32 offen offset:2048 sc1
    buffer_load_dwordx4 v[68:71], v1, s[8:11], s33 offen offset:2048 sc1
    buffer_load_dwordx4 v[72:75], v1, s[8:11], s32 offen offset:3072 sc1
    buffer_load_dwordx4 v[76:79], v1, s[8:11], s33 offen offset:3072 sc1
    s_add_u32 s32, s30, 8192
    s_add_u32 s33, s30, 65536
    buffer_load_dwordx4 v[80:83], v1, s[8:11], s32 offen offset:0 sc1
    buffer_load_dwordx4 v[84:87], v1, s[8:11], s33 offen offset:0 sc1
    buffer_load_dwordx4 v[88:91], v1, s[8:11], s32 offen offset:1024 sc1
    buffer_load_dwordx4 v[92:95], v1, s[8:11], s33 offen offset:1024 sc1
    buffer_load_dwordx4 v[96:99], v1, s[8:11], s32 offen offset:2048 sc1
    buffer_load_dwordx4 v[100:103], v1, s[8:11], s33 offen offset:2048 sc1
    buffer_load_dwordx4 v[104:107], v1, s[8:11], s32 offen offset:3072 sc1
    buffer_load_dwordx4 v[108:111], v1, s[8:11], s33 offen offset:3072 sc1
    s_add_u32 s32, s30, 12288
    s_add_u32 s33, s30, 69632
    buffer_load_dwordx4 v[112:115], v1, s[8:11], s32 offen offset:0 sc1
    buffer_load_dwordx4 v[116:119], v1, s[8:11], s33 offen offset:0 sc1
    buffer_load_dwordx4 v[120:123], v1, s[8:11], s32 offen offset:1024 sc1
    buffer_load_dwordx4 v[124:127], v1, s[8:11], s33 offen offset:1024 sc1
    s_mul_i32 s30, s12, 458752
    s_lshl_b32 s31, s6, 16
    s_add_u32 s30, s30, s31
    s_lshl_b32 s31, s3, 12
    s_add_u32 s30, s30, s31
    s_add_u32 s30, s30, 0x2100000
    buffer_load_dwordx4 v[128:131], v1, s[8:11], s30 offen offset:0 sc1
    buffer_load_dwordx4 v[132:135], v1, s[8:11], s30 offen offset:1024 sc1
    buffer_load_dwordx4 v[136:139], v1, s[8:11], s30 offen offset:2048 sc1
    buffer_load_dwordx4 v[140:143], v1, s[8:11], s30 offen offset:3072 sc1
    s_add_u32 s30, s30, 16384
    buffer_load_dwordx4 v[144:147], v1, s[8:11], s30 offen offset:0 sc1
    buffer_load_dwordx4 v[148:151], v1, s[8:11], s30 offen offset:1024 sc1
    buffer_load_dwordx4 v[152:155], v1, s[8:11], s30 offen offset:2048 sc1
    buffer_load_dwordx4 v[156:159], v1, s[8:11], s30 offen offset:3072 sc1
    s_add_u32 s30, s30, 16384
    buffer_load_dwordx4 v[160:163], v1, s[8:11], s30 offen offset:0 sc1
    buffer_load_dwordx4 v[164:167], v1, s[8:11], s30 offen offset:1024 sc1
    buffer_load_dwordx4 v[168:171], v1, s[8:11], s30 offen offset:2048 sc1
    buffer_load_dwordx4 v[172:175], v1, s[8:11], s30 offen offset:3072 sc1
    s_add_u32 s30, s30, 16384
    buffer_load_dwordx4 v[176:179], v1, s[8:11], s30 offen offset:0 sc1
    buffer_load_dwordx4 v[180:183], v1, s[8:11], s30 offen offset:1024 sc1
    buffer_load_dwordx4 v[184:187], v1, s[8:11], s30 offen offset:2048 sc1
    buffer_load_dwordx4 v[188:191], v1, s[8:11], s30 offen offset:3072 sc1
    s_lshl_b32 s30, s12, 7
    s_add_u32 s30, s30, 0xe10000
    buffer_load_dword v14, v8, s[8:11], s30 offen offset:0 sc1
    buffer_load_dword v15, v8, s[8:11], s30 offen offset:64 sc1
    s_waitcnt vmcnt(44)
    v_mfma_f32_16x16x32_bf16 v[192:195], a[0:3], v[16:19], 0
    v_mfma_f32_16x16x32_bf16 v[200:203], a[4:7], v[16:19], 0
    v_mfma_f32_16x16x32_bf16 v[208:211], a[8:11], v[16:19], 0
    v_mfma_f32_16x16x32_bf16 v[216:219], a[12:15], v[16:19], 0
    v_mfma_f32_16x16x32_bf16 v[196:199], a[0:3], v[20:23], 0
    v_mfma_f32_16x16x32_bf16 v[204:207], a[4:7], v[20:23], 0
    v_mfma_f32_16x16x32_bf16 v[212:215], a[8:11], v[20:23], 0
    v_mfma_f32_16x16x32_bf16 v[220:223], a[12:15], v[20:23], 0
    s_waitcnt vmcnt(42)
    v_mfma_f32_16x16x32_bf16 v[192:195], a[16:19], v[24:27], v[192:195]
    v_mfma_f32_16x16x32_bf16 v[200:203], a[20:23], v[24:27], v[200:203]
    v_mfma_f32_16x16x32_bf16 v[208:211], a[24:27], v[24:27], v[208:211]
    v_mfma_f32_16x16x32_bf16 v[216:219], a[28:31], v[24:27], v[216:219]
    v_mfma_f32_16x16x32_bf16 v[196:199], a[16:19], v[28:31], v[196:199]
    v_mfma_f32_16x16x32_bf16 v[204:207], a[20:23], v[28:31], v[204:207]
    v_mfma_f32_16x16x32_bf16 v[212:215], a[24:27], v[28:31], v[212:215]
    v_mfma_f32_16x16x32_bf16 v[220:223], a[28:31], v[28:31], v[220:223]
    s_waitcnt vmcnt(40)
    v_mfma_f32_16x16x32_bf16 v[192:195], a[32:35], v[32:35], v[192:195]
    v_mfma_f32_16x16x32_bf16 v[200:203], a[36:39], v[32:35], v[200:203]
    v_mfma_f32_16x16x32_bf16 v[208:211], a[40:43], v[32:35], v[208:211]
    v_mfma_f32_16x16x32_bf16 v[216:219], a[44:47], v[32:35], v[216:219]
    v_mfma_f32_16x16x32_bf16 v[196:199], a[32:35], v[36:39], v[196:199]
    v_mfma_f32_16x16x32_bf16 v[204:207], a[36:39], v[36:39], v[204:207]
    v_mfma_f32_16x16x32_bf16 v[212:215], a[40:43], v[36:39], v[212:215]
    v_mfma_f32_16x16x32_bf16 v[220:223], a[44:47], v[36:39], v[220:223]
    s_waitcnt vmcnt(38)
    v_mfma_f32_16x16x32_bf16 v[192:195], a[48:51], v[40:43], v[192:195]
    v_mfma_f32_16x16x32_bf16 v[200:203], a[52:55], v[40:43], v[200:203]
    v_mfma_f32_16x16x32_bf16 v[208:211], a[56:59], v[40:43], v[208:211]
    v_mfma_f32_16x16x32_bf16 v[216:219], a[60:63], v[40:43], v[216:219]
    v_mfma_f32_16x16x32_bf16 v[196:199], a[48:51], v[44:47], v[196:199]
    v_mfma_f32_16x16x32_bf16 v[204:207], a[52:55], v[44:47], v[204:207]
    v_mfma_f32_16x16x32_bf16 v[212:215], a[56:59], v[44:47], v[212:215]
    v_mfma_f32_16x16x32_bf16 v[220:223], a[60:63], v[44:47], v[220:223]
    s_waitcnt vmcnt(36)
    v_mfma_f32_16x16x32_bf16 v[192:195], a[64:67], v[48:51], v[192:195]
    v_mfma_f32_16x16x32_bf16 v[200:203], a[68:71], v[48:51], v[200:203]
    v_mfma_f32_16x16x32_bf16 v[208:211], a[72:75], v[48:51], v[208:211]
    v_mfma_f32_16x16x32_bf16 v[216:219], a[76:79], v[48:51], v[216:219]
    v_mfma_f32_16x16x32_bf16 v[196:199], a[64:67], v[52:55], v[196:199]
    v_mfma_f32_16x16x32_bf16 v[204:207], a[68:71], v[52:55], v[204:207]
    v_mfma_f32_16x16x32_bf16 v[212:215], a[72:75], v[52:55], v[212:215]
    v_mfma_f32_16x16x32_bf16 v[220:223], a[76:79], v[52:55], v[220:223]
    s_waitcnt vmcnt(34)
    v_mfma_f32_16x16x32_bf16 v[192:195], a[80:83], v[56:59], v[192:195]
    v_mfma_f32_16x16x32_bf16 v[200:203], a[84:87], v[56:59], v[200:203]
    v_mfma_f32_16x16x32_bf16 v[208:211], a[88:91], v[56:59], v[208:211]
    v_mfma_f32_16x16x32_bf16 v[216:219], a[92:95], v[56:59], v[216:219]
    v_mfma_f32_16x16x32_bf16 v[196:199], a[80:83], v[60:63], v[196:199]
    v_mfma_f32_16x16x32_bf16 v[204:207], a[84:87], v[60:63], v[204:207]
    v_mfma_f32_16x16x32_bf16 v[212:215], a[88:91], v[60:63], v[212:215]
    v_mfma_f32_16x16x32_bf16 v[220:223], a[92:95], v[60:63], v[220:223]
    s_waitcnt vmcnt(32)
    v_mfma_f32_16x16x32_bf16 v[192:195], a[96:99], v[64:67], v[192:195]
    v_mfma_f32_16x16x32_bf16 v[200:203], a[100:103], v[64:67], v[200:203]
    v_mfma_f32_16x16x32_bf16 v[208:211], a[104:107], v[64:67], v[208:211]
    v_mfma_f32_16x16x32_bf16 v[216:219], a[108:111], v[64:67], v[216:219]
    v_mfma_f32_16x16x32_bf16 v[196:199], a[96:99], v[68:71], v[196:199]
    v_mfma_f32_16x16x32_bf16 v[204:207], a[100:103], v[68:71], v[204:207]
    v_mfma_f32_16x16x32_bf16 v[212:215], a[104:107], v[68:71], v[212:215]
    v_mfma_f32_16x16x32_bf16 v[220:223], a[108:111], v[68:71], v[220:223]
    s_waitcnt vmcnt(30)
    v_mfma_f32_16x16x32_bf16 v[192:195], a[112:115], v[72:75], v[192:195]
    v_mfma_f32_16x16x32_bf16 v[200:203], a[116:119], v[72:75], v[200:203]
    v_mfma_f32_16x16x32_bf16 v[208:211], a[120:123], v[72:75], v[208:211]
    v_mfma_f32_16x16x32_bf16 v[216:219], a[124:127], v[72:75], v[216:219]
    v_mfma_f32_16x16x32_bf16 v[196:199], a[112:115], v[76:79], v[196:199]
    v_mfma_f32_16x16x32_bf16 v[204:207], a[116:119], v[76:79], v[204:207]
    v_mfma_f32_16x16x32_bf16 v[212:215], a[120:123], v[76:79], v[212:215]
    v_mfma_f32_16x16x32_bf16 v[220:223], a[124:127], v[76:79], v[220:223]
    s_waitcnt vmcnt(28)
    v_mfma_f32_16x16x32_bf16 v[192:195], a[128:131], v[80:83], v[192:195]
    v_mfma_f32_16x16x32_bf16 v[200:203], a[132:135], v[80:83], v[200:203]
    v_mfma_f32_16x16x32_bf16 v[208:211], a[136:139], v[80:83], v[208:211]
    v_mfma_f32_16x16x32_bf16 v[216:219], a[140:143], v[80:83], v[216:219]
    v_mfma_f32_16x16x32_bf16 v[196:199], a[128:131], v[84:87], v[196:199]
    v_mfma_f32_16x16x32_bf16 v[204:207], a[132:135], v[84:87], v[204:207]
    v_mfma_f32_16x16x32_bf16 v[212:215], a[136:139], v[84:87], v[212:215]
    v_mfma_f32_16x16x32_bf16 v[220:223], a[140:143], v[84:87], v[220:223]
    s_waitcnt vmcnt(26)
    v_mfma_f32_16x16x32_bf16 v[192:195], a[144:147], v[88:91], v[192:195]
    v_mfma_f32_16x16x32_bf16 v[200:203], a[148:151], v[88:91], v[200:203]
    v_mfma_f32_16x16x32_bf16 v[208:211], a[152:155], v[88:91], v[208:211]
    v_mfma_f32_16x16x32_bf16 v[216:219], a[156:159], v[88:91], v[216:219]
    v_mfma_f32_16x16x32_bf16 v[196:199], a[144:147], v[92:95], v[196:199]
    v_mfma_f32_16x16x32_bf16 v[204:207], a[148:151], v[92:95], v[204:207]
    v_mfma_f32_16x16x32_bf16 v[212:215], a[152:155], v[92:95], v[212:215]
    v_mfma_f32_16x16x32_bf16 v[220:223], a[156:159], v[92:95], v[220:223]
    s_waitcnt vmcnt(24)
    v_mfma_f32_16x16x32_bf16 v[192:195], a[160:163], v[96:99], v[192:195]
    v_mfma_f32_16x16x32_bf16 v[200:203], a[164:167], v[96:99], v[200:203]
    v_mfma_f32_16x16x32_bf16 v[208:211], a[168:171], v[96:99], v[208:211]
    v_mfma_f32_16x16x32_bf16 v[216:219], a[172:175], v[96:99], v[216:219]
    v_mfma_f32_16x16x32_bf16 v[196:199], a[160:163], v[100:103], v[196:199]
    v_mfma_f32_16x16x32_bf16 v[204:207], a[164:167], v[100:103], v[204:207]
    v_mfma_f32_16x16x32_bf16 v[212:215], a[168:171], v[100:103], v[212:215]
    v_mfma_f32_16x16x32_bf16 v[220:223], a[172:175], v[100:103], v[220:223]
    s_waitcnt vmcnt(22)
    v_mfma_f32_16x16x32_bf16 v[192:195], a[176:179], v[104:107], v[192:195]
    v_mfma_f32_16x16x32_bf16 v[200:203], a[180:183], v[104:107], v[200:203]
    v_mfma_f32_16x16x32_bf16 v[208:211], a[184:187], v[104:107], v[208:211]
    v_mfma_f32_16x16x32_bf16 v[216:219], a[188:191], v[104:107], v[216:219]
    v_mfma_f32_16x16x32_bf16 v[196:199], a[176:179], v[108:111], v[196:199]
    v_mfma_f32_16x16x32_bf16 v[204:207], a[180:183], v[108:111], v[204:207]
    v_mfma_f32_16x16x32_bf16 v[212:215], a[184:187], v[108:111], v[212:215]
    v_mfma_f32_16x16x32_bf16 v[220:223], a[188:191], v[108:111], v[220:223]
    s_waitcnt vmcnt(20)
    v_mfma_f32_16x16x32_bf16 v[192:195], a[192:195], v[112:115], v[192:195]
    v_mfma_f32_16x16x32_bf16 v[200:203], a[196:199], v[112:115], v[200:203]
    v_mfma_f32_16x16x32_bf16 v[208:211], a[200:203], v[112:115], v[208:211]
    v_mfma_f32_16x16x32_bf16 v[216:219], a[204:207], v[112:115], v[216:219]
    v_mfma_f32_16x16x32_bf16 v[196:199], a[192:195], v[116:119], v[196:199]
    v_mfma_f32_16x16x32_bf16 v[204:207], a[196:199], v[116:119], v[204:207]
    v_mfma_f32_16x16x32_bf16 v[212:215], a[200:203], v[116:119], v[212:215]
    v_mfma_f32_16x16x32_bf16 v[220:223], a[204:207], v[116:119], v[220:223]
    s_waitcnt vmcnt(18)
    v_mfma_f32_16x16x32_bf16 v[192:195], a[208:211], v[120:123], v[192:195]
    v_mfma_f32_16x16x32_bf16 v[200:203], a[212:215], v[120:123], v[200:203]
    v_mfma_f32_16x16x32_bf16 v[208:211], a[216:219], v[120:123], v[208:211]
    v_mfma_f32_16x16x32_bf16 v[216:219], a[220:223], v[120:123], v[216:219]
    v_mfma_f32_16x16x32_bf16 v[196:199], a[208:211], v[124:127], v[196:199]
    v_mfma_f32_16x16x32_bf16 v[204:207], a[212:215], v[124:127], v[204:207]
    v_mfma_f32_16x16x32_bf16 v[212:215], a[216:219], v[124:127], v[212:215]
    v_mfma_f32_16x16x32_bf16 v[220:223], a[220:223], v[124:127], v[220:223]
    s_mul_i32 s31, s12, 16385
    s_lshr_b32 s31, s31, 16
    s_mul_i32 s32, s31, 4
    s_sub_u32 s32, s12, s32
    s_lshl_b32 s32, s32, 7
    v_add_u32 v12, s32, v5
    s_and_b32 s32, s12, 1
    s_lshl_b32 s32, s32, 9
    v_add_u32 v13, s32, v6
    v_cndmask_b32 v16, v13, v12, s[60:61]
    s_add_u32 s31, s31, 1
    s_lshr_b32 s32, s12, 1
    s_add_u32 s32, s32, 1
    v_mov_b32 v12, s31
    v_mov_b32 v13, s32
    v_cndmask_b32 v12, v13, v12, s[60:61]
    s_mov_b32 s30, 0xf80000
    s_mov_b32 s14, 0
pl_139:
    buffer_load_dword v13, v16, s[8:11], s30 offen sc1
    s_waitcnt vmcnt(0)
    v_cmp_lt_u32 vcc, v13, v12
    s_cbranch_vccz pk_140
    v_add_u32 v13, 1, v13
    v_cmp_lt_u32 vcc, v13, v12
    s_cbranch_vccz pn_141
    s_sleep 24
pn_141:
    s_sleep 1
    s_add_u32 s14, s14, 1
    s_cmp_lt_u32 s14, 400000
    s_cbranch_scc1 pl_139
    s_endpgm
pk_140:
    s_mul_i32 s30, s12, 40960
    s_add_u32 s30, s30, 0x1e00000
    s_lshl_b32 s31, s3, 13
    s_add_u32 s31, s31, s30
    s_add_u32 s32, s31, 4096
    buffer_load_dwordx4 v[20:23], v1, s[8:11], s31 offen offset:0 sc1
    buffer_load_dwordx4 v[24:27], v1, s[8:11], s31 offen offset:1024 sc1
    buffer_load_dwordx4 v[28:31], v1, s[8:11], s31 offen offset:2048 sc1
    buffer_load_dwordx4 v[32:35], v1, s[8:11], s31 offen offset:3072 sc1
    buffer_load_dwordx4 v[36:39], v1, s[8:11], s32 offen offset:0 sc1
    buffer_load_dwordx4 v[40:43], v1, s[8:11], s32 offen offset:1024 sc1
    buffer_load_dwordx4 v[44:47], v1, s[8:11], s32 offen offset:2048 sc1
    buffer_load_dwordx4 v[48:51], v1, s[8:11], s32 offen offset:3072 sc1
    s_lshl_b32 s31, s3, 11
    s_add_u32 s31, s31, s30
    s_add_u32 s31, s31, 32768
    buffer_load_dwordx4 v[52:55], v1, s[8:11], s31 offen offset:0 sc1
    buffer_load_dwordx4 v[56:59], v1, s[8:11], s31 offen offset:1024 sc1
    s_mul_i32 s30, s12, 114688
    s_lshl_b32 s31, s3, 10
    s_add_u32 s30, s30, s31
    s_lshl_b32 s31, s6, 14
    s_add_u32 s30, s30, s31
    s_add_u32 s30, s30, 0x1000000
    buffer_load_dwordx4 v[60:63], v1, s[8:11], s30 offen sc1
    s_add_u32 s30, s30, 4096
    buffer_load_dwordx4 v[64:67], v1, s[8:11], s30 offen sc1
    s_add_u32 s30, s30, 4096
    buffer_load_dwordx4 v[68:71], v1, s[8:11], s30 offen sc1
    s_add_u32 s30, s30, 4096
    buffer_load_dwordx4 v[72:75], v1, s[8:11], s30 offen sc1
    s_waitcnt vmcnt(12)
    v_mfma_f32_16x16x32_bf16 v[224:227], v[128:131], v[20:23], 0
    v_mfma_f32_16x16x32_bf16 v[232:235], v[144:147], v[20:23], 0
    v_mfma_f32_16x16x32_bf16 v[240:243], v[160:163], v[20:23], 0
    v_mfma_f32_16x16x32_bf16 v[248:251], v[176:179], v[20:23], 0
    v_mfma_f32_16x16x32_bf16 v[228:231], v[128:131], v[24:27], 0
    v_mfma_f32_16x16x32_bf16 v[236:239], v[144:147], v[24:27], 0
    v_mfma_f32_16x16x32_bf16 v[244:247], v[160:163], v[24:27], 0
    v_mfma_f32_16x16x32_bf16 v[252:255], v[176:179], v[24:27], 0
    s_waitcnt vmcnt(10)
    v_mfma_f32_16x16x32_bf16 v[224:227], v[132:135], v[28:31], v[224:227]
    v_mfma_f32_16x16x32_bf16 v[232:235], v[148:151], v[28:31], v[232:235]
    v_mfma_f32_16x16x32_bf16 v[240:243], v[164:167], v[28:31], v[240:243]
    v_mfma_f32_16x16x32_bf16 v[248:251], v[180:183], v[28:31], v[248:251]
    v_mfma_f32_16x16x32_bf16 v[228:231], v[132:135], v[32:35], v[228:231]
    v_mfma_f32_16x16x32_bf16 v[236:239], v[148:151], v[32:35], v[236:239]
    v_mfma_f32_16x16x32_bf16 v[244:247], v[164:167], v[32:35], v[244:247]
    v_mfma_f32_16x16x32_bf16 v[252:255], v[180:183], v[32:35], v[252:255]
    s_waitcnt vmcnt(8)
    v_mfma_f32_16x16x32_bf16 v[224:227], v[136:139], v[36:39], v[224:227]
    v_mfma_f32_16x16x32_bf16 v[232:235], v[152:155], v[36:39], v[232:235]
    v_mfma_f32_16x16x32_bf16 v[240:243], v[168:171], v[36:39], v[240:243]
    v_mfma_f32_16x16x32_bf16 v[248:251], v[184:187], v[36:39], v[248:251]
    v_mfma_f32_16x16x32_bf16 v[228:231], v[136:139], v[40:43], v[228:231]
    v_mfma_f32_16x16x32_bf16 v[236:239], v[152:155], v[40:43], v[236:239]
    v_mfma_f32_16x16x32_bf16 v[244:247], v[168:171], v[40:43], v[244:247]
    v_mfma_f32_16x16x32_bf16 v[252:255], v[184:187], v[40:43], v[252:255]
    s_waitcnt vmcnt(6)
    v_mfma_f32_16x16x32_bf16 v[224:227], v[140:143], v[44:47], v[224:227]
    v_mfma_f32_16x16x32_bf16 v[232:235], v[156:159], v[44:47], v[232:235]
    v_mfma_f32_16x16x32_bf16 v[240:243], v[172:175], v[44:47], v[240:243]
    v_mfma_f32_16x16x32_bf16 v[248:251], v[188:191], v[44:47], v[248:251]
    v_mfma_f32_16x16x32_bf16 v[228:231], v[140:143], v[48:51], v[228:231]
    v_mfma_f32_16x16x32_bf16 v[236:239], v[156:159], v[48:51], v[236:239]
    v_mfma_f32_16x16x32_bf16 v[244:247], v[172:175], v[48:51], v[244:247]
    v_mfma_f32_16x16x32_bf16 v[252:255], v[188:191], v[48:51], v[252:255]
    s_waitcnt vmcnt(0)
    v_mfma_f32_16x16x32_bf16 v[224:227], v[60:63], v[52:55], v[224:227]
    v_mfma_f32_16x16x32_bf16 v[228:231], v[60:63], v[56:59], v[228:231]
    v_mfma_f32_16x16x32_bf16 v[232:235], v[64:67], v[52:55], v[232:235]
    v_mfma_f32_16x16x32_bf16 v[236:239], v[64:67], v[56:59], v[236:239]
    v_mfma_f32_16x16x32_bf16 v[240:243], v[68:71], v[52:55], v[240:243]
    v_mfma_f32_16x16x32_bf16 v[244:247], v[68:71], v[56:59], v[244:247]
    v_mfma_f32_16x16x32_bf16 v[248:251], v[72:75], v[52:55], v[248:251]
    v_mfma_f32_16x16x32_bf16 v[252:255], v[72:75], v[56:59], v[252:255]
    s_mul_i32 s30, s12, 28672
    s_lshl_b32 s31, s6, 7
    s_add_u32 s30, s30, s31
    v_sub_f32 v224, v224, v192
    v_sub_f32 v225, v225, v193
    v_sub_f32 v226, v226, v194
    v_sub_f32 v227, v227, v195
    v_fmac_f32 v192, v14, v224
    v_fmac_f32 v193, v14, v225
    v_fmac_f32 v194, v14, v226
    v_fmac_f32 v195, v14, v227
    ds_write_b128 v9, v[192:195] offset:0
    v_sub_f32 v228, v228, v196
    v_sub_f32 v229, v229, v197
    v_sub_f32 v230, v230, v198
    v_sub_f32 v231, v231, v199
    v_fmac_f32 v196, v15, v228
    v_fmac_f32 v197, v15, v229
    v_fmac_f32 v198, v15, v230
    v_fmac_f32 v199, v15, v231
    ds_write_b128 v9, v[196:199] offset:4352
    v_sub_f32 v232, v232, v200
    v_sub_f32 v233, v233, v201
    v_sub_f32 v234, v234, v202
    v_sub_f32 v235, v235, v203
    v_fmac_f32 v200, v14, v232
    v_fmac_f32 v201, v14, v233
    v_fmac_f32 v202, v14, v234
    v_fmac_f32 v203, v14, v235
    ds_write_b128 v9, v[200:203] offset:64
    v_sub_f32 v236, v236, v204
    v_sub_f32 v237, v237, v205
    v_sub_f32 v238, v238, v206
    v_sub_f32 v239, v239, v207
    v_fmac_f32 v204, v15, v236
    v_fmac_f32 v205, v15, v237
    v_fmac_f32 v206, v15, v238
    v_fmac_f32 v207, v15, v239
    ds_write_b128 v9, v[204:207] offset:4416
    v_sub_f32 v240, v240, v208
    v_sub_f32 v241, v241, v209
    v_sub_f32 v242, v242, v210
    v_sub_f32 v243, v243, v211
    v_fmac_f32 v208, v14, v240
    v_fmac_f32 v209, v14, v241
    v_fmac_f32 v210, v14, v242
    v_fmac_f32 v211, v14, v243
    ds_write_b128 v9, v[208:211] offset:128
    v_sub_f32 v244, v244, v212
    v_sub_f32 v245, v245, v213
    v_sub_f32 v246, v246, v214
    v_sub_f32 v247, v247, v215
    v_fmac_f32 v212, v15, v244
    v_fmac_f32 v213, v15, v245
    v_fmac_f32 v214, v15, v246
    v_fmac_f32 v215, v15, v247
    ds_write_b128 v9, v[212:215] offset:4480
    v_sub_f32 v248, v248, v216
    v_sub_f32 v249, v249, v217
    v_sub_f32 v250, v250, v218
    v_sub_f32 v251, v251, v219
    v_fmac_f32 v216, v14, v248
    v_fmac_f32 v217, v14, v249
    v_fmac_f32 v218, v14, v250
    v_fmac_f32 v219, v14, v251
    ds_write_b128 v9, v[216:219] offset:192
    v_sub_f32 v252, v252, v220
    v_sub_f32 v253, v253, v221
    v_sub_f32 v254, v254, v222
    v_sub_f32 v255, v255, v223
    v_fmac_f32 v220, v15, v252
    v_fmac_f32 v221, v15, v253
    v_fmac_f32 v222, v15, v254
    v_fmac_f32 v223, v15, v255
    ds_write_b128 v9, v[220:223] offset:4544
    s_waitcnt lgkmcnt(0)
    s_barrier
    ds_read_b128 v[20:23], v10 offset:0
    ds_read_b128 v[24:27], v10 offset:16
    ds_read_b128 v[28:31], v10 offset:8704
    ds_read_b128 v[32:35], v10 offset:8720
    ds_read_b128 v[36:39], v10 offset:17408
    ds_read_b128 v[40:43], v10 offset:17424
    ds_read_b128 v[44:47], v10 offset:26112
    ds_read_b128 v[48:51], v10 offset:26128
    v_add_u32 v9, s50, v9
    v_add_u32 v10, s50, v10
    s_sub_u32 s50, 0, s50
    s_waitcnt lgkmcnt(4)
    v_pk_add_f32 v[20:21], v[20:21], v[28:29]
    v_pk_add_f32 v[22:23], v[22:23], v[30:31]
    v_pk_add_f32 v[24:25], v[24:25], v[32:33]
    v_pk_add_f32 v[26:27], v[26:27], v[34:35]
    s_waitcnt lgkmcnt(2)
    v_pk_add_f32 v[20:21], v[20:21], v[36:37]
    v_pk_add_f32 v[22:23], v[22:23], v[38:39]
    v_pk_add_f32 v[24:25], v[24:25], v[40:41]
    v_pk_add_f32 v[26:27], v[26:27], v[42:43]
    s_waitcnt lgkmcnt(0)
    v_pk_add_f32 v[20:21], v[20:21], v[44:45]
    v_pk_add_f32 v[22:23], v[22:23], v[46:47]
    v_pk_add_f32 v[24:25], v[24:25], v[48:49]
    v_pk_add_f32 v[26:27], v[26:27], v[50:51]
    v_cvt_pk_bf16_f32 v56, v20, v21
    v_cvt_pk_bf16_f32 v57, v22, v23
    v_cvt_pk_bf16_f32 v58, v24, v25
    v_cvt_pk_bf16_f32 v59, v26, v27
    buffer_store_dwordx4 v[56:59], v11, s[20:23], s30 offen sc1
    s_add_u32 s12, s12, 6
    s_cmp_lt_u32 s12, 64
    s_cbranch_scc1 ro_loop
    s_endpgm
codeend:
.section .rodata,"a"
.p2align 6
.amdhsa_kernel gated_mix__memory_aug_recurrent_mem_tr__swiglu_ffn__prompt_kernel
  .amdhsa_next_free_vgpr 512
  .amdhsa_next_free_sgpr 100
  .amdhsa_accum_offset 256
  .amdhsa_group_segment_fixed_size 0
  .amdhsa_kernarg_size 120
  .amdhsa_user_sgpr_count 2
  .amdhsa_user_sgpr_kernarg_segment_ptr 1
  .amdhsa_system_sgpr_workgroup_id_x 1
.end_amdhsa_kernel
```
